```python
import torch

def _softmax(x, axis=-1):
    return torch.softmax(x, dim=axis)
def _gelu(x):
    return torch.nn.functional.gelu(x, approximate="tanh")
def _silu(x):
    return torch.nn.functional.silu(x)
def _sigmoid(x):
    return torch.sigmoid(x)
def _layernorm(x, axis=-1, eps=1e-5):
    m = x.mean(dim=axis, keepdim=True)
    v = x.var(dim=axis, keepdim=True, unbiased=False)
    return (x - m) / torch.sqrt(v + eps)
def _scatter_add(tgt, idx, src, axis=0):
    return tgt.clone().index_add_(axis, idx, src)
def _segment_sum(src, seg, n):
    out = torch.zeros((n,) + src.shape[1:], dtype=src.dtype)
    return out.index_add_(0, seg, src)
def _pad(x, pw):
    flat = tuple(v for pair in reversed(pw) for v in pair)
    return torch.nn.functional.pad(x, flat)

kernel_name = 'interleave_layers__gqa_block_cached__dense_activation_silu__decode'

def setup_inputs():

    _w = (lambda a: (lambda t: t.to(torch.bfloat16) if t.is_floating_point() else t)(torch.as_tensor(a)))
    def _A_setup():
        B, Sq, D = 8, 1, 512
        Hq, Hkv, Sk, Dh = 32, 8, 8192, 128
        assert Hq % Hkv == 0, (Hq, Hkv)
        return {
            "x": _w((lambda *s: torch.randn(*s, dtype=torch.bfloat16) * 0.1)(B, Sq, D)),
            "k_cache": _w((lambda *s: torch.randn(*s, dtype=torch.bfloat16) * 0.8)(B, Hkv, Sk, Dh)),
            "v_cache": _w((lambda *s: torch.randn(*s, dtype=torch.bfloat16) * 3.2)(B, Hkv, Sk, Dh)),
            "wq": _w((lambda *s: torch.randn(*s, dtype=torch.bfloat16) * 0.8)(D, Hq * Dh) * (D ** -0.5)),
            "wo": _w((lambda *s: torch.randn(*s, dtype=torch.bfloat16) * 3.2)(Hq * Dh, D) * ((Hq * Dh) ** -0.5)),
        }
    _A_in = _A_setup()

    def _B_setup():
        B, S, D, F = 8, 1, 512, 1792
        return {
            "x": _w((lambda *s: torch.randn(*s, dtype=torch.bfloat16) * 0.1)(B, S, D)),
            "w1": _w((lambda *s: torch.randn(*s, dtype=torch.bfloat16) * 1.6)(D, F) * (D ** -0.5)),
            "w2": _w((lambda *s: torch.randn(*s, dtype=torch.bfloat16) * 0.4)(F, D) * (F ** -0.5)),
        }
    _B_in = _B_setup()

    return {
        "A_x": _A_in["x"],
        "A_k_cache": _A_in["k_cache"],
        "A_v_cache": _A_in["v_cache"],
        "A_wq": _A_in["wq"],
        "A_wo": _A_in["wo"],
        "B_x": _B_in["x"],
        "B_w1": _B_in["w1"],
        "B_w2": _B_in["w2"],
    }

def reference(A_x, A_k_cache, A_v_cache, A_wq, A_wo, B_x, B_w1, B_w2):
    def _A_ref(x, k_cache, v_cache, wq, wo):
        B, Sq, D = x.shape
        Hq, Dh = 32, 128
        Hkv = k_cache.shape[1]
        rep = Hq // Hkv
        q = (lambda x, *d: x.permute(*d))((x @ wq).reshape(B, Sq, Hq, Dh), 0, 2, 1, 3)
        k = (lambda x, n, axis: torch.repeat_interleave(x, n, dim=axis))(k_cache, rep, axis=1)
        v = (lambda x, n, axis: torch.repeat_interleave(x, n, dim=axis))(v_cache, rep, axis=1)
        scores = torch.einsum("bhqd,bhkd->bhqk", q, k) * (Dh ** -0.5)
        p = _softmax(scores, axis=-1)
        o = torch.einsum("bhqk,bhkd->bhqd", p, v)
        return (lambda x, *d: x.permute(*d))(o, 0, 2, 1, 3).reshape(B, Sq, Hq * Dh) @ wo

    def _B_ref(x, w1, w2):
        h = torch.einsum("bsd,df->bsf", x, w1)
        h = _silu(h)
        out = torch.einsum("bsf,fd->bsd", h, w2)
        return out

    x = A_x
    x = x + _A_ref(_layernorm(x, axis=-1), A_k_cache, A_v_cache, A_wq, A_wo)
    x = x + _B_ref(_layernorm(x, axis=-1), B_w1, B_w2)
    x = x + _A_ref(_layernorm(x, axis=-1), A_k_cache, A_v_cache, A_wq, A_wo)
    x = x + _B_ref(_layernorm(x, axis=-1), B_w1, B_w2)
    return x
```

```asm
; @launch grid=(256,1,1) block=(256,1,1) lds=163840
.amdgcn_target "amdgcn-amd-amdhsa--gfx950"
.text
.globl interleave_layers__gqa_block_cached__dense_activation_silu__decode_kernel
.p2align 8
.type interleave_layers__gqa_block_cached__dense_activation_silu__decode_kernel,@function
interleave_layers__gqa_block_cached__dense_activation_silu__decode_kernel:
s_cmp_ge_u32 s2,0x100
s_cbranch_scc1 L_end
s_load_dwordx16 s[44:59],s[0:1],0
s_load_dwordx4 s[60:63],s[0:1],64
s_load_dwordx2 s[64:65],s[0:1],80
v_lshrrev_b32 v1,6,v0
v_and_b32 v0,63,v0
v_readfirstlane_b32 s68,v1
s_and_b32 s66,s2,7
s_lshr_b32 s67,s2,3
v_and_b32 v1,15,v0
v_lshrrev_b32 v2,4,v0
v_lshlrev_b32 v3,4,v0
v_lshlrev_b32 v4,4,v2
s_getreg_b32 s84,hwreg(HW_REG_XCC_ID)
s_and_b32 s84,s84,15
s_mul_i32 s97,s84,s84
s_lshl_b32 s97,s97,16
s_lshl_b32 s73,s84,8
s_add_u32 s97,s97,s73
s_add_u32 s97,s97,1
s_mov_b32 s70,0xc350
s_mov_b32 s69,0
s_lshl_b32 s80,s66,10
s_waitcnt lgkmcnt(0)
s_mov_b32 s12,s64
s_mov_b32 s13,s65
s_mov_b32 s14,0x20000000
s_mov_b32 s15,0x20000
s_mov_b32 s40,s62
s_mov_b32 s41,s63
s_mov_b32 s42,0x100
s_mov_b32 s43,0x20000
s_cmp_ge_u32 s67,24
s_cbranch_scc1 L_chain
s_nop 3
s_cmp_eq_u32 s68,0
s_cbranch_scc0 Lw_1
v_mov_b32 v40,s97
s_lshl_b32 s72,s66,2
s_and_b32 s73,s66,4
s_mul_i32 s73,s73,28
s_add_u32 s72,s72,s73
v_mov_b32 v41,s72
s_mov_b32 exec_lo,1
s_mov_b32 exec_hi,0
buffer_atomic_add v40,v41,s[40:43],0 offen sc1
s_mov_b64 exec,-1
Lw_1:
s_and_b32 s72,s67,7
s_lshl_b32 s72,s72,2
s_add_u32 s72,s72,s68
s_lshr_b32 s94,s67,3
s_mul_i32 s73,s94,0xa0000
s_mov_b32 s4,s46
s_mov_b32 s5,s47
s_mov_b32 s6,0x8000000
s_mov_b32 s7,0x20000
s_mov_b32 s8,s48
s_mov_b32 s9,s49
s_mov_b32 s10,0x8000000
s_mov_b32 s11,0x20000
s_mov_b32 s16,s50
s_mov_b32 s17,s51
s_mov_b32 s18,0x400000
s_mov_b32 s19,0x20000
s_mul_i32 s44,s72,0x6000
s_add_u32 s44,s44,s73
s_mul_i32 s45,s72,0x5000
s_add_u32 s45,s45,s73
s_mov_b32 s46,s45
s_cmp_eq_u32 s94,2
s_cselect_b32 s73,0x20000,0
s_add_u32 s45,s45,s73
s_cmp_ge_u32 s94,1
s_cselect_b32 s73,0x20000,0
s_add_u32 s46,s46,s73
s_lshl_b32 s72,s66,21
v_lshlrev_b32 v37,6,v2
v_xor_b32 v37,v37,v3
v_add_u32 v5,s72,v37
s_mul_i32 s82,s68,0x9360
s_add_u32 s82,s82,0x2200
v_lshlrev_b32 v38,20,v1
v_and_b32 v38,0x100000,v38
v_lshrrev_b32 v39,1,v1
v_lshl_add_u32 v38,v39,24,v38
s_lshl_b32 s73,s67,2
s_add_u32 s73,s73,s68
s_cmp_eq_u32 s73,0x41
s_cbranch_scc0 Lw_2
s_mov_b32 exec_lo,0xffff
s_mov_b32 exec_hi,0
buffer_load_dword v44,v38,s[8:11],s72 offen nt
buffer_load_dword v45,v38,s[4:7],s72 offen nt
s_mov_b64 exec,-1
Lw_2:
s_lshl_b32 s72,s67,2
s_add_u32 s72,s72,s68
s_lshl_b32 s72,s72,13
s_add_u32 s72,s72,s80
buffer_load_dwordx4 v[44:47],v3,s[16:19],s72 offen
s_add_u32 s72,s72,0xc0000
buffer_load_dwordx4 v[44:47],v3,s[16:19],s72 offen
s_add_u32 s72,s72,0xc0000
buffer_load_dwordx4 v[44:47],v3,s[16:19],s72 offen
s_add_u32 s72,s72,0xc0000
buffer_load_dwordx4 v[44:47],v3,s[16:19],s72 offen
s_add_u32 s72,s72,0xc0000
buffer_load_dwordx4 v[44:47],v3,s[16:19],s72 offen
s_add_u32 s72,s72,0xc0000
buffer_load_dwordx4 v[44:47],v3,s[16:19],s72 offen
s_mov_b32 s20,s52
s_mov_b32 s21,s53
s_mov_b32 s22,0x400000
s_mov_b32 s23,0x20000
s_mov_b32 s24,s56
s_mov_b32 s25,s57
s_mov_b32 s26,0x1c0000
s_mov_b32 s27,0x20000
s_mov_b32 s28,s58
s_mov_b32 s29,s59
s_mov_b32 s30,0x1c0000
s_mov_b32 s31,0x20000
s_lshl_b32 s94,s67,2
s_add_u32 s94,s94,s68
s_lshl_b32 s72,s66,9
s_add_u32 s72,s72,s94
s_lshl_b32 s72,s72,10
buffer_load_dwordx4 v[44:47],v3,s[20:23],s72 offen
s_add_u32 s72,s72,0x18000
buffer_load_dwordx4 v[44:47],v3,s[20:23],s72 offen
s_add_u32 s72,s72,0x18000
buffer_load_dwordx4 v[44:47],v3,s[20:23],s72 offen
s_add_u32 s72,s72,0x18000
buffer_load_dwordx4 v[44:47],v3,s[20:23],s72 offen
s_add_u32 s72,s72,0x18000
buffer_load_dwordx4 v[44:47],v3,s[20:23],s72 offen
s_add_u32 s72,s72,0x18000
s_cmp_lt_u32 s94,32
s_cbranch_scc0 Lw_3
buffer_load_dwordx4 v[44:47],v3,s[20:23],s72 offen
Lw_3:
s_mul_i32 s72,s66,0xe0
s_add_u32 s72,s72,s94
s_lshl_b32 s72,s72,10
buffer_load_dwordx4 v[44:47],v3,s[28:31],s72 offen
s_add_u32 s72,s72,0x18000
buffer_load_dwordx4 v[44:47],v3,s[28:31],s72 offen
s_add_u32 s72,s72,0x18000
s_cmp_lt_u32 s94,32
s_cbranch_scc0 Lw_4
buffer_load_dwordx4 v[44:47],v3,s[28:31],s72 offen
Lw_4:
v_lshrrev_b32 v38,5,v0
v_mul_u32_u24 v38,0xe00,v38
v_and_b32 v39,31,v0
v_min_u32 v39,27,v39
v_lshl_add_u32 v38,v39,4,v38
s_mul_i32 s72,s94,0x1c00
s_mul_i32 s73,s66,0x1c0
s_add_u32 s72,s72,s73
buffer_load_dwordx4 v[44:47],v38,s[24:27],s72 offen
s_add_u32 s72,s72,0xa8000
buffer_load_dwordx4 v[44:47],v38,s[24:27],s72 offen
s_add_u32 s72,s72,0xa8000
buffer_load_dwordx4 v[44:47],v38,s[24:27],s72 offen
s_getpc_b64 s[90:91]
L_pc:
s_sub_u32 s90,s90,L_pc-interleave_layers__gqa_block_cached__dense_activation_silu__decode_kernel
s_subb_u32 s91,s91,0
s_lshl_b32 s72,s67,2
s_add_u32 s72,s72,s68
s_lshl_b32 s72,s72,10
v_add_u32 v37,s72,v3
v_min_u32 v37,L_codeend-interleave_layers__gqa_block_cached__dense_activation_silu__decode_kernel-16,v37
global_load_dwordx4 v[44:47],v37,s[90:91]
s_add_u32 s72,s72,0x18000
s_mov_b32 s74,0x3e0293ee
v_mov_b32 v16,0x3f803f80
v_mov_b32 v17,0x3f803f80
v_mov_b32 v18,0x3f803f80
v_mov_b32 v19,0x3f803f80
v_mov_b32 v20,0
v_mov_b32 v21,0
v_mov_b32 v22,0
v_mov_b32 v23,0
v_mov_b32 v24,0
v_mov_b32 v25,0
v_mov_b32 v26,0
v_mov_b32 v27,0
v_mov_b32 v28,0
v_mov_b32 v29,0
v_mov_b32 v30,0
v_mov_b32 v31,0
v_mov_b32 v32,0
v_mov_b32 v33,0
v_mov_b32 v34,0
v_mov_b32 v35,0
v_lshrrev_b32 v37,2,v1
v_and_b32 v38,3,v1
v_mul_u32_u24 v39,0x420,v37
v_lshl_add_u32 v39,v38,8,v39
v_add_u32 v39,v39,v4
v_add_u32 v39,s82,v39
v_xor_b32 v8,0,v38
v_lshl_add_u32 v8,v8,6,v39
v_xor_b32 v9,1,v38
v_lshl_add_u32 v9,v9,6,v39
v_xor_b32 v10,2,v38
v_lshl_add_u32 v10,v10,6,v39
v_xor_b32 v11,3,v38
v_lshl_add_u32 v11,v11,6,v39
v_mul_u32_u24 v39,0x420,v2
v_lshl_add_u32 v39,v37,8,v39
v_lshl_add_u32 v39,v38,3,v39
v_add_u32 v39,s82,v39
v_xor_b32 v12,0,v37
v_lshl_add_u32 v12,v12,6,v39
v_xor_b32 v13,1,v37
v_lshl_add_u32 v13,v13,6,v39
v_xor_b32 v14,2,v37
v_lshl_add_u32 v14,v14,6,v39
v_xor_b32 v15,3,v37
v_lshl_add_u32 v15,v15,6,v39
s_lshl_b32 s73,s68,10
s_add_u32 s73,s73,0x26f80
v_lshl_add_u32 v6,v38,8,v4
v_add_u32 v6,s73,v6
v_add_u32 v43,s73,v3
s_mul_i32 s73,s68,0x840
v_mul_u32_u24 v39,0x210,v38
v_lshl_add_u32 v39,v2,5,v39
v_lshl_add_u32 v39,v37,7,v39
v_add_u32 v7,s73,v39
s_mul_i32 s73,s68,0x210
v_lshlrev_b32 v39,3,v0
v_add_u32 v40,s73,v39
s_lshl_b32 s73,s68,5
s_add_u32 s73,s73,0x2100
v_lshlrev_b32 v39,3,v38
v_add_u32 v41,s73,v39
s_lshl_b32 s73,s68,3
s_add_u32 s73,s73,0x2100
v_lshlrev_b32 v39,5,v38
v_add_u32 v42,s73,v39
s_mul_i32 s72,s66,0x6200
s_lshl_b32 s73,s68,7
s_add_u32 s76,s72,s73
s_lshl_b32 s73,s67,2
s_add_u32 s76,s76,s73
s_add_u32 s76,s76,0x6000
s_mul_i32 s73,s68,0x1800
s_add_u32 s72,s72,s73
s_lshl_b32 s73,s67,4
s_add_u32 s72,s72,s73
s_cmp_ge_u32 s67,16
s_cselect_b32 s73,0xf00,0
s_cselect_b32 s94,1,0
s_add_u32 s72,s72,s73
v_lshlrev_b32 v39,10,v2
v_lshl_add_u32 v39,v37,8,v39
v_lshrrev_b32 v39,s94,v39
v_lshl_add_u32 v39,v38,2,v39
v_add_u32 v36,s72,v39
s_lshr_b32 s94,s67,3
s_mov_b32 s50,0x1b7000
s_cmp_eq_u32 s94,1
s_cselect_b32 s50,0xc2000,s50
s_cmp_eq_u32 s94,2
s_cselect_b32 s50,0xf3000,s50
s_mov_b32 s51,0xc2000
s_cmp_eq_u32 s94,1
s_cselect_b32 s51,0xf3000,s51
s_cmp_eq_u32 s94,2
s_cselect_b32 s51,0x1b7000,s51
s_mov_b32 s52,0xf3000
s_cmp_eq_u32 s94,1
s_cselect_b32 s52,0x1b7000,s52
s_cmp_eq_u32 s94,2
s_cselect_b32 s52,0xc2000,s52
s_mov_b32 s53,0x124000
s_cmp_eq_u32 s94,1
s_cselect_b32 s53,0x155000,s53
s_cmp_eq_u32 s94,2
s_cselect_b32 s53,0x186000,s53
s_mov_b32 s54,0x155000
s_cmp_eq_u32 s94,1
s_cselect_b32 s54,0x186000,s54
s_cmp_eq_u32 s94,2
s_cselect_b32 s54,0x124000,s54
s_mov_b32 s55,0x186000
s_cmp_eq_u32 s94,1
s_cselect_b32 s55,0x124000,s55
s_cmp_eq_u32 s94,2
s_cselect_b32 s55,0x155000,s55
s_mov_b32 s72,s68
s_add_u32 s73,s72,0
s_and_b32 s73,s73,3
s_lshl_b32 s16,s73,10
s_add_u32 s73,s72,1
s_and_b32 s73,s73,3
s_lshl_b32 s17,s73,10
s_add_u32 s73,s72,2
s_and_b32 s73,s73,3
s_lshl_b32 s18,s73,10
s_add_u32 s73,s72,3
s_and_b32 s73,s73,3
s_lshl_b32 s19,s73,10
s_mov_b32 s85,-1
s_mov_b32 s96,0x40000000
s_mov_b32 s48,0x40000000
s_mov_b32 s49,0x40000000
v_mov_b32 v0,v40
v_mov_b32 v1,v41
v_mov_b32 v2,v42
v_mov_b32 v4,v43
s_cmp_lt_u32 s67,8
s_cbranch_scc1 L_cut0
s_cmp_lt_u32 s67,16
s_cbranch_scc1 L_cut2
s_branch L_cut1
.p2align 6
L_cut0:
s_add_u32 s85,s85,1
s_lshl_b32 s98,s85,24
s_add_u32 s98,s98,s44
s_waitcnt lgkmcnt(8)
s_add_u32 s71,s98,0
s_add_u32 m0,s82,0
s_nop 0
buffer_load_dwordx4 v5,s[4:7],s71 offen offset:0 nt lds
s_add_u32 m0,s82,32
s_nop 0
buffer_load_dwordx4 v5,s[4:7],s71 offen offset:1024 nt lds
s_waitcnt vmcnt(11)
s_waitcnt vmcnt(10)
ds_read_b64_tr_b16 v[208:209],v12 offset:8384
ds_read_b64_tr_b16 v[212:213],v12 offset:8416
ds_read_b64_tr_b16 v[216:217],v13 offset:8384
ds_read_b64_tr_b16 v[220:221],v13 offset:8416
ds_read_b64_tr_b16 v[224:225],v14 offset:8384
ds_read_b64_tr_b16 v[228:229],v14 offset:8416
ds_read_b64_tr_b16 v[232:233],v15 offset:8384
ds_read_b64_tr_b16 v[236:237],v15 offset:8416
s_add_u32 m0,s82,64
s_nop 0
buffer_load_dwordx4 v5,s[4:7],s71 offen offset:2048 nt lds
s_add_u32 m0,s82,0x60
s_nop 0
buffer_load_dwordx4 v5,s[4:7],s71 offen offset:3072 nt lds
s_waitcnt vmcnt(11)
s_waitcnt lgkmcnt(8)
s_add_u32 s71,s98,0x1000
s_add_u32 m0,s82,0x1060
s_nop 0
buffer_load_dwordx4 v5,s[4:7],s71 offen offset:0 nt lds
s_waitcnt vmcnt(11)
s_add_u32 m0,s82,0x1080
s_nop 0
buffer_load_dwordx4 v5,s[4:7],s71 offen offset:1024 nt lds
s_waitcnt vmcnt(11)
s_waitcnt vmcnt(10)
ds_read_b64_tr_b16 v[210:211],v12 offset:12576
ds_read_b64_tr_b16 v[214:215],v12 offset:12608
ds_read_b64_tr_b16 v[218:219],v13 offset:12576
ds_read_b64_tr_b16 v[222:223],v13 offset:12608
ds_read_b64_tr_b16 v[226:227],v14 offset:12576
ds_read_b64_tr_b16 v[230:231],v14 offset:12608
ds_read_b64_tr_b16 v[234:235],v15 offset:12576
ds_read_b64_tr_b16 v[238:239],v15 offset:12608
s_add_u32 m0,s82,0x10a0
s_nop 0
buffer_load_dwordx4 v5,s[4:7],s71 offen offset:2048 nt lds
s_cmp_ge_i32 s85,2
s_cbranch_scc0 Lw_149
v_mov_b32_dpp v20,v40 row_shl:8 row_mask:0xf bank_mask:0x1
v_mov_b32_dpp v21,v41 row_shl:8 row_mask:0xf bank_mask:0x1
v_mov_b32_dpp v22,v40 row_shl:12 row_mask:0xf bank_mask:0x1
v_mov_b32_dpp v23,v41 row_shl:12 row_mask:0xf bank_mask:0x1
s_waitcnt lgkmcnt(8)
s_waitcnt lgkmcnt(0)
v_mfma_f32_16x16x32_bf16 v[52:55],v[16:19],v[20:23],v[52:55]
v_mov_b32_dpp v24,v40 row_shl:4 row_mask:0xf bank_mask:0x2
v_mov_b32_dpp v25,v41 row_shl:4 row_mask:0xf bank_mask:0x2
v_mfma_f32_16x16x32_bf16 v[44:47],v[208:211],v[20:23],v[44:47]
v_mov_b32_dpp v26,v40 row_shl:8 row_mask:0xf bank_mask:0x2
v_mov_b32_dpp v27,v41 row_shl:8 row_mask:0xf bank_mask:0x2
v_mfma_f32_16x16x32_bf16 v[48:51],v[224:227],v[20:23],v[48:51]
v_mov_b32_dpp v28,v40 quad_perm:[0,1,2,3] row_mask:0xf bank_mask:0x4
v_mov_b32_dpp v29,v41 quad_perm:[0,1,2,3] row_mask:0xf bank_mask:0x4
v_mfma_f32_16x16x32_bf16 v[44:47],v[212:215],v[24:27],v[44:47]
v_mov_b32_dpp v30,v40 row_shl:4 row_mask:0xf bank_mask:0x4
v_mov_b32_dpp v31,v41 row_shl:4 row_mask:0xf bank_mask:0x4
v_mfma_f32_16x16x32_bf16 v[48:51],v[228:231],v[24:27],v[48:51]
v_mov_b32_dpp v32,v40 row_shr:4 row_mask:0xf bank_mask:0x8
v_mov_b32_dpp v33,v41 row_shr:4 row_mask:0xf bank_mask:0x8
v_mfma_f32_16x16x32_bf16 v[44:47],v[216:219],v[28:31],v[44:47]
v_mov_b32_dpp v34,v40 quad_perm:[0,1,2,3] row_mask:0xf bank_mask:0x8
v_mov_b32_dpp v35,v41 quad_perm:[0,1,2,3] row_mask:0xf bank_mask:0x8
v_mfma_f32_16x16x32_bf16 v[48:51],v[232:235],v[28:31],v[48:51]
s_nop 0
v_mfma_f32_16x16x32_bf16 v[44:47],v[220:223],v[32:35],v[44:47]
v_mfma_f32_16x16x32_bf16 v[48:51],v[236:239],v[32:35],v[48:51]
Lw_149:
s_add_u32 m0,s82,0x10c0
s_nop 0
buffer_load_dwordx4 v5,s[4:7],s71 offen offset:3072 nt lds
s_waitcnt vmcnt(11)
s_waitcnt lgkmcnt(8)
s_add_u32 s71,s98,0x2000
s_add_u32 m0,s82,0x20c0
s_nop 0
buffer_load_dwordx4 v5,s[4:7],s71 offen offset:0 nt lds
s_sub_u32 s49,s85,3
s_lshl_b32 s49,s49,13
s_add_u32 s49,s49,0x10000
s_add_u32 s49,s49,s80
s_cmp_ge_i32 s85,3
s_cselect_b32 s49,s49,s96
buffer_load_dwordx4 v[56:59],v3,s[12:15],s49 offen offset:0 sc1
s_waitcnt vmcnt(12)
s_add_u32 m0,s82,0x20e0
s_nop 0
buffer_load_dwordx4 v5,s[4:7],s71 offen offset:1024 nt lds
s_waitcnt vmcnt(12)
s_waitcnt vmcnt(11)
ds_read_b64_tr_b16 v[240:241],v12 offset:16768
ds_read_b64_tr_b16 v[242:243],v12 offset:16800
ds_read_b64_tr_b16 v[244:245],v13 offset:16768
ds_read_b64_tr_b16 v[246:247],v13 offset:16800
ds_read_b64_tr_b16 v[248:249],v14 offset:16768
ds_read_b64_tr_b16 v[250:251],v14 offset:16800
ds_read_b64_tr_b16 v[252:253],v15 offset:16768
ds_read_b64_tr_b16 v[254:255],v15 offset:16800
s_add_u32 m0,s82,0x2100
s_nop 0
buffer_load_dwordx4 v5,s[4:7],s71 offen offset:2048 nt lds
s_cmp_eq_u32 s85,1
s_cbranch_scc1 Lf_150
Lf_151:
s_cmp_ge_i32 s85,2
s_cbranch_scc0 Lw_154
ds_write_b32 v1,v38
s_waitcnt lgkmcnt(0)
s_barrier
ds_read_b32 v38,v2
v_mov_b32_dpp v20,v42 quad_perm:[0,1,2,3] row_mask:0xf bank_mask:0x1
v_mov_b32_dpp v21,v43 quad_perm:[0,1,2,3] row_mask:0xf bank_mask:0x1
s_waitcnt lgkmcnt(1)
s_nop 0
v_mfma_f32_16x16x16_bf16 v[52:55],v[16:17],v[20:21],v[52:55]
v_mov_b32_dpp v24,v42 row_shr:4 row_mask:0xf bank_mask:0x2
v_mov_b32_dpp v25,v43 row_shr:4 row_mask:0xf bank_mask:0x2
v_mfma_f32_16x16x16_bf16 v[44:47],v[240:241],v[20:21],v[44:47]
v_mov_b32_dpp v28,v42 row_shr:8 row_mask:0xf bank_mask:0x4
v_mov_b32_dpp v29,v43 row_shr:8 row_mask:0xf bank_mask:0x4
v_mfma_f32_16x16x16_bf16 v[48:51],v[248:249],v[20:21],v[48:51]
v_mov_b32_dpp v32,v42 row_shr:12 row_mask:0xf bank_mask:0x8
v_mov_b32_dpp v33,v43 row_shr:12 row_mask:0xf bank_mask:0x8
v_mfma_f32_16x16x16_bf16 v[44:47],v[242:243],v[24:25],v[44:47]
v_mfma_f32_16x16x16_bf16 v[48:51],v[250:251],v[24:25],v[48:51]
v_mfma_f32_16x16x16_bf16 v[44:47],v[244:245],v[28:29],v[44:47]
s_waitcnt lgkmcnt(0)
v_max_f32_dpp v60,v38,v38 quad_perm:[1,0,3,2] row_mask:15 bank_mask:15
v_mfma_f32_16x16x16_bf16 v[48:51],v[252:253],v[28:29],v[48:51]
v_mfma_f32_16x16x16_bf16 v[44:47],v[246:247],v[32:33],v[44:47]
v_max_f32_dpp v60,v60,v60 quad_perm:[2,3,0,1] row_mask:15 bank_mask:15
v_sub_f32 v61,v38,v60
v_mfma_f32_16x16x16_bf16 v[48:51],v[254:255],v[32:33],v[48:51]
v_exp_f32 v61,v61
Lw_154:
s_add_u32 m0,s82,0x2120
s_nop 0
buffer_load_dwordx4 v5,s[4:7],s71 offen offset:3072 nt lds
s_waitcnt lgkmcnt(8)
s_add_u32 s71,s98,0x3000
s_add_u32 m0,s82,0x3120
s_nop 0
buffer_load_dwordx4 v5,s[4:7],s71 offen offset:0 nt lds
s_cmp_ge_i32 s85,2
s_cbranch_scc0 Lw_155
s_mov_b32 exec_lo,0xf000f
s_mov_b32 exec_hi,0xf000f
ds_write_b32 v1,v52 offset:4
s_mov_b64 exec,-1
ds_write_b128 v7,v[44:47] offset:0
ds_write_b128 v7,v[48:51] offset:16
s_waitcnt lgkmcnt(0)
s_barrier
ds_read_b32 v39,v2 offset:4
ds_read_b64 v[44:45],v0 offset:0
ds_read_b64 v[46:47],v0 offset:2112
ds_read_b64 v[48:49],v0 offset:4224
ds_read_b64 v[50:51],v0 offset:6336
s_waitcnt lgkmcnt(4)
v_mul_f32 v54,v61,v39
s_waitcnt lgkmcnt(0)
v_mul_f32_dpp v40,v61,v44 quad_perm:[0,0,0,0] row_mask:15 bank_mask:15
v_mul_f32_dpp v41,v61,v45 quad_perm:[0,0,0,0] row_mask:15 bank_mask:15
v_add_f32_dpp v54,v54,v54 quad_perm:[1,0,3,2] row_mask:15 bank_mask:15
v_fmac_f32_dpp v40,v61,v46 quad_perm:[1,1,1,1] row_mask:15 bank_mask:15
v_fmac_f32_dpp v41,v61,v47 quad_perm:[1,1,1,1] row_mask:15 bank_mask:15
v_add_f32_dpp v54,v54,v54 quad_perm:[2,3,0,1] row_mask:15 bank_mask:15
v_rcp_f32 v38,v54
v_log_f32 v54,v54
v_fmac_f32_dpp v40,v61,v48 quad_perm:[2,2,2,2] row_mask:15 bank_mask:15
v_fmac_f32_dpp v41,v61,v49 quad_perm:[2,2,2,2] row_mask:15 bank_mask:15
v_fmac_f32_dpp v40,v61,v50 quad_perm:[3,3,3,3] row_mask:15 bank_mask:15
v_fmac_f32_dpp v41,v61,v51 quad_perm:[3,3,3,3] row_mask:15 bank_mask:15
v_add_f32 v60,v60,v54
v_mul_f32 v40,v40,v38
v_mul_f32 v41,v41,v38
v_cvt_pk_bf16_f32 v40,v40,v41
Lw_155:
s_cmp_ge_i32 s85,2
s_cselect_b32 s94,s52,s96
s_add_u32 s95,s94,s76
s_cmp_lg_u32 s69,0
s_cbranch_scc0 Ls_156
buffer_store_dword v40,v36,s[12:15],s94 offen
s_mov_b32 exec_lo,1
s_mov_b32 exec_hi,0
buffer_store_dword v60,v3,s[12:15],s95 offen
Ls_157:
s_mov_b64 exec,-1
s_add_u32 m0,s82,0x3140
s_nop 0
buffer_load_dwordx4 v5,s[4:7],s71 offen offset:1024 nt lds
s_add_u32 m0,s82,0x3160
s_nop 0
buffer_load_dwordx4 v5,s[4:7],s71 offen offset:2048 nt lds
s_add_u32 m0,s82,0x3180
s_nop 0
buffer_load_dwordx4 v5,s[4:7],s71 offen offset:3072 nt lds
s_sub_u32 s48,s85,0
s_lshl_b32 s48,s48,13
s_add_u32 s48,s48,0
s_add_u32 s48,s48,s80
s_cmp_ge_i32 s85,1
s_cselect_b32 s48,s48,s96
buffer_load_dwordx4 v[40:43],v3,s[12:15],s48 offen offset:0 sc1
s_waitcnt vmcnt(10)
s_cmp_ge_i32 s85,3
s_cbranch_scc0 Lw_158
Lc_159:
v_cmp_u_f32 vcc,v56,v57
s_cbranch_vccnz Lr_161
v_cmp_u_f32 vcc,v58,v59
s_cbranch_vccnz Lr_161
Lo_160:
ds_write_b128 v4,v[56:59]
ds_read_b128 v[20:23],v6 offset:0
ds_read_b128 v[24:27],v6 offset:64
ds_read_b128 v[28:31],v6 offset:128
ds_read_b128 v[32:35],v6 offset:192
s_waitcnt lgkmcnt(0)
v_mfma_f32_16x16x32_bf16 v[44:47],a[0:3],v[20:23],0
v_mfma_f32_16x16x32_bf16 v[44:47],a[4:7],v[24:27],v[44:47]
v_mfma_f32_16x16x32_bf16 v[44:47],a[8:11],v[28:31],v[44:47]
v_mfma_f32_16x16x32_bf16 v[44:47],a[12:15],v[32:35],v[44:47]
ds_read_b128 a[0:3],v8 offset:20960
ds_read_b128 a[4:7],v9 offset:20960
ds_read_b128 a[8:11],v10 offset:20960
ds_read_b128 a[12:15],v11 offset:20960
v_mfma_f32_16x16x32_bf16 v[52:55],a[16:19],v[20:23],0
v_mfma_f32_16x16x32_bf16 v[52:55],a[20:23],v[24:27],v[52:55]
v_mfma_f32_16x16x32_bf16 v[52:55],a[24:27],v[28:31],v[52:55]
v_mfma_f32_16x16x32_bf16 v[52:55],a[28:31],v[32:35],v[52:55]
ds_read_b128 a[16:19],v8 offset:25152
ds_read_b128 a[20:23],v9 offset:25152
ds_read_b128 a[24:27],v10 offset:25152
ds_read_b128 a[28:31],v11 offset:25152
v_mfma_f32_16x16x32_bf16 v[56:59],a[32:35],v[20:23],0
v_mfma_f32_16x16x32_bf16 v[56:59],a[36:39],v[24:27],v[56:59]
v_mfma_f32_16x16x32_bf16 v[56:59],a[40:43],v[28:31],v[56:59]
v_mfma_f32_16x16x32_bf16 v[56:59],a[44:47],v[32:35],v[56:59]
v_mfma_f32_16x16x32_bf16 v[60:63],a[48:51],v[20:23],0
v_mfma_f32_16x16x32_bf16 v[60:63],a[52:55],v[24:27],v[60:63]
v_mfma_f32_16x16x32_bf16 v[60:63],a[56:59],v[28:31],v[60:63]
v_mfma_f32_16x16x32_bf16 v[60:63],a[60:63],v[32:35],v[60:63]
v_mov_b32_dpp v44,v52 quad_perm:[0,1,2,3] row_mask:0xf bank_mask:0x2
v_mov_b32_dpp v45,v53 quad_perm:[0,1,2,3] row_mask:0xf bank_mask:0x2
s_waitcnt lgkmcnt(4)
v_mfma_f32_16x16x32_bf16 v[48:51],a[0:3],v[20:23],0
v_mov_b32_dpp v46,v54 quad_perm:[0,1,2,3] row_mask:0xf bank_mask:0x2
v_mov_b32_dpp v47,v55 quad_perm:[0,1,2,3] row_mask:0xf bank_mask:0x2
v_mfma_f32_16x16x32_bf16 v[48:51],a[4:7],v[24:27],v[48:51]
v_mov_b32_dpp v44,v56 quad_perm:[0,1,2,3] row_mask:0xf bank_mask:0x4
v_mov_b32_dpp v45,v57 quad_perm:[0,1,2,3] row_mask:0xf bank_mask:0x4
v_mfma_f32_16x16x32_bf16 v[48:51],a[8:11],v[28:31],v[48:51]
v_mov_b32_dpp v46,v58 quad_perm:[0,1,2,3] row_mask:0xf bank_mask:0x4
v_mov_b32_dpp v47,v59 quad_perm:[0,1,2,3] row_mask:0xf bank_mask:0x4
v_mfma_f32_16x16x32_bf16 v[48:51],a[12:15],v[32:35],v[48:51]
s_waitcnt lgkmcnt(0)
v_mfma_f32_16x16x32_bf16 v[52:55],a[16:19],v[20:23],0
v_mfma_f32_16x16x32_bf16 v[52:55],a[20:23],v[24:27],v[52:55]
v_mov_b32_dpp v44,v60 quad_perm:[0,1,2,3] row_mask:0xf bank_mask:0x8
v_mov_b32_dpp v45,v61 quad_perm:[0,1,2,3] row_mask:0xf bank_mask:0x8
v_mfma_f32_16x16x32_bf16 v[52:55],a[24:27],v[28:31],v[52:55]
v_mov_b32_dpp v46,v62 quad_perm:[0,1,2,3] row_mask:0xf bank_mask:0x8
v_mov_b32_dpp v47,v63 quad_perm:[0,1,2,3] row_mask:0xf bank_mask:0x8
v_mfma_f32_16x16x32_bf16 v[52:55],a[28:31],v[32:35],v[52:55]
v_mov_b64 v[20:21],0
v_mov_b64 v[22:23],0
v_mov_b64 v[24:25],0
v_mov_b64 v[26:27],0
v_mov_b64 v[28:29],0
v_mov_b64 v[30:31],0
v_mov_b64 v[32:33],0
v_mov_b64 v[34:35],0
v_mov_b32_dpp v48,v52 quad_perm:[0,1,2,3] row_mask:0xf bank_mask:0x2
v_mov_b32_dpp v49,v53 quad_perm:[0,1,2,3] row_mask:0xf bank_mask:0x2
v_mov_b32_dpp v50,v54 quad_perm:[0,1,2,3] row_mask:0xf bank_mask:0x2
v_mov_b32_dpp v51,v55 quad_perm:[0,1,2,3] row_mask:0xf bank_mask:0x2
Lw_158:
ds_read_b128 a[0:3],v8 offset:0
ds_read_b128 a[4:7],v9 offset:0
ds_read_b128 a[8:11],v10 offset:0
ds_read_b128 a[12:15],v11 offset:0
s_add_u32 s71,s98,0x4000
s_add_u32 m0,s82,0x51e0
s_nop 0
buffer_load_dwordx4 v5,s[4:7],s71 offen offset:0 nt lds
s_add_u32 m0,s82,0x5200
s_nop 0
buffer_load_dwordx4 v5,s[4:7],s71 offen offset:1024 nt lds
ds_read_b128 a[16:19],v8 offset:4192
ds_read_b128 a[20:23],v9 offset:4192
ds_read_b128 a[24:27],v10 offset:4192
ds_read_b128 a[28:31],v11 offset:4192
s_add_u32 m0,s82,0x5220
s_nop 0
buffer_load_dwordx4 v5,s[4:7],s71 offen offset:2048 nt lds
s_add_u32 m0,s82,0x5240
s_nop 0
buffer_load_dwordx4 v5,s[4:7],s71 offen offset:3072 nt lds
s_add_u32 s71,s98,0x5000
s_add_u32 m0,s82,0x6240
s_nop 0
buffer_load_dwordx4 v5,s[4:7],s71 offen offset:0 nt lds
s_add_u32 m0,s82,0x6260
s_nop 0
buffer_load_dwordx4 v5,s[4:7],s71 offen offset:1024 nt lds
s_cmp_ge_i32 s85,3
s_cbranch_scc0 Lw_162
v_max3_f32 v38,v44,v45,v46
v_max3_f32 v38,v38,v47,v48
v_max3_f32 v38,v38,v49,v50
v_max_f32 v38,v38,v51
s_nop 1
v_max_f32_dpp v38,v38,v38 row_ror:4 row_mask:15 bank_mask:15
s_nop 1
v_max_f32_dpp v38,v38,v38 row_ror:8 row_mask:15 bank_mask:15
v_mov_b32 v37,v38
s_nop 1
v_permlane16_swap_b32 v38,v37
v_max_f32 v38,v38,v37
v_mov_b32 v37,v38
s_nop 1
v_permlane32_swap_b32 v38,v37
v_max_f32 v38,v38,v37
v_mul_f32 v38,s74,v38
v_fma_f32 v44,v44,s74,-v38
v_fma_f32 v45,v45,s74,-v38
v_fma_f32 v46,v46,s74,-v38
v_fma_f32 v47,v47,s74,-v38
v_fma_f32 v48,v48,s74,-v38
v_fma_f32 v49,v49,s74,-v38
v_fma_f32 v50,v50,s74,-v38
v_fma_f32 v51,v51,s74,-v38
v_exp_f32 v44,v44
v_exp_f32 v45,v45
v_exp_f32 v46,v46
v_exp_f32 v47,v47
v_exp_f32 v48,v48
v_exp_f32 v49,v49
v_exp_f32 v50,v50
v_exp_f32 v51,v51
v_cvt_pk_bf16_f32 v52,v44,v45
v_cvt_pk_bf16_f32 v53,v46,v47
v_cvt_pk_bf16_f32 v54,v48,v49
v_cvt_pk_bf16_f32 v55,v50,v51
Lw_162:
s_waitcnt vmcnt(13)
ds_read_b128 a[32:35],v8 offset:8384
ds_read_b128 a[36:39],v9 offset:8384
ds_read_b128 a[40:43],v10 offset:8384
ds_read_b128 a[44:47],v11 offset:8384
s_add_u32 m0,s82,0x6280
s_nop 0
buffer_load_dwordx4 v5,s[4:7],s71 offen offset:2048 nt lds
s_add_u32 m0,s82,0x62a0
s_nop 0
buffer_load_dwordx4 v5,s[4:7],s71 offen offset:3072 nt lds
s_cmp_eq_u32 s85,1
s_cbranch_scc1 Lf_163
L_back2:
s_cmp_ge_i32 s85,3
s_cbranch_scc0 Lw_165
v_mov_b32_dpp v20,v52 quad_perm:[0,1,2,3] row_mask:0xf bank_mask:0x1
v_mov_b32_dpp v21,v53 quad_perm:[0,1,2,3] row_mask:0xf bank_mask:0x1
v_mov_b32_dpp v22,v52 row_shl:4 row_mask:0xf bank_mask:0x1
v_mov_b32_dpp v23,v53 row_shl:4 row_mask:0xf bank_mask:0x1
s_nop 1
v_mfma_f32_16x16x32_bf16 v[56:59],v[16:19],v[20:23],0
v_mov_b32_dpp v24,v52 row_shr:4 row_mask:0xf bank_mask:0x2
v_mov_b32_dpp v25,v53 row_shr:4 row_mask:0xf bank_mask:0x2
v_mfma_f32_16x16x32_bf16 v[44:47],a[192:195],v[20:23],0
v_mov_b32_dpp v26,v52 quad_perm:[0,1,2,3] row_mask:0xf bank_mask:0x2
v_mov_b32_dpp v27,v53 quad_perm:[0,1,2,3] row_mask:0xf bank_mask:0x2
v_mfma_f32_16x16x32_bf16 v[48:51],a[208:211],v[20:23],0
v_mov_b32_dpp v28,v52 row_shr:8 row_mask:0xf bank_mask:0x4
v_mov_b32_dpp v29,v53 row_shr:8 row_mask:0xf bank_mask:0x4
v_mfma_f32_16x16x32_bf16 v[44:47],a[196:199],v[24:27],v[44:47]
v_mov_b32_dpp v30,v52 row_shr:4 row_mask:0xf bank_mask:0x4
v_mov_b32_dpp v31,v53 row_shr:4 row_mask:0xf bank_mask:0x4
v_mfma_f32_16x16x32_bf16 v[48:51],a[212:215],v[24:27],v[48:51]
v_mov_b32_dpp v32,v52 row_shr:12 row_mask:0xf bank_mask:0x8
v_mov_b32_dpp v33,v53 row_shr:12 row_mask:0xf bank_mask:0x8
v_mfma_f32_16x16x32_bf16 v[44:47],a[200:203],v[28:31],v[44:47]
v_mov_b32_dpp v34,v52 row_shr:8 row_mask:0xf bank_mask:0x8
v_mov_b32_dpp v35,v53 row_shr:8 row_mask:0xf bank_mask:0x8
v_mfma_f32_16x16x32_bf16 v[48:51],a[216:219],v[28:31],v[48:51]
v_mov_b32_dpp v20,v52 row_shl:8 row_mask:0xf bank_mask:0x1
v_mov_b32_dpp v21,v53 row_shl:8 row_mask:0xf bank_mask:0x1
v_mfma_f32_16x16x32_bf16 v[44:47],a[204:207],v[32:35],v[44:47]
v_mov_b32_dpp v22,v52 row_shl:12 row_mask:0xf bank_mask:0x1
v_mov_b32_dpp v23,v53 row_shl:12 row_mask:0xf bank_mask:0x1
v_mfma_f32_16x16x32_bf16 v[48:51],a[220:223],v[32:35],v[48:51]
Lw_165:
s_waitcnt lgkmcnt(4)
s_add_u32 s71,s98,0
s_add_u32 m0,s82,0x1060
s_nop 0
buffer_load_dwordx4 v5,s[8:11],s71 offen offset:0 nt lds
s_cmp_ge_i32 s85,3
s_cbranch_scc0 Lw_166
v_mfma_f32_16x16x32_bf16 v[56:59],v[16:19],v[20:23],v[56:59]
v_mov_b32_dpp v24,v52 row_shl:4 row_mask:0xf bank_mask:0x2
v_mov_b32_dpp v25,v53 row_shl:4 row_mask:0xf bank_mask:0x2
v_mfma_f32_16x16x32_bf16 v[44:47],a[224:227],v[20:23],v[44:47]
v_mov_b32_dpp v26,v52 row_shl:8 row_mask:0xf bank_mask:0x2
v_mov_b32_dpp v27,v53 row_shl:8 row_mask:0xf bank_mask:0x2
v_mfma_f32_16x16x32_bf16 v[48:51],a[240:243],v[20:23],v[48:51]
v_mov_b32_dpp v28,v52 quad_perm:[0,1,2,3] row_mask:0xf bank_mask:0x4
v_mov_b32_dpp v29,v53 quad_perm:[0,1,2,3] row_mask:0xf bank_mask:0x4
v_mfma_f32_16x16x32_bf16 v[44:47],a[228:231],v[24:27],v[44:47]
v_mov_b32_dpp v30,v52 row_shl:4 row_mask:0xf bank_mask:0x4
v_mov_b32_dpp v31,v53 row_shl:4 row_mask:0xf bank_mask:0x4
v_mfma_f32_16x16x32_bf16 v[48:51],a[244:247],v[24:27],v[48:51]
v_mov_b32_dpp v32,v52 row_shr:4 row_mask:0xf bank_mask:0x8
v_mov_b32_dpp v33,v53 row_shr:4 row_mask:0xf bank_mask:0x8
v_mfma_f32_16x16x32_bf16 v[44:47],a[232:235],v[28:31],v[44:47]
v_mov_b32_dpp v34,v52 quad_perm:[0,1,2,3] row_mask:0xf bank_mask:0x8
v_mov_b32_dpp v35,v53 quad_perm:[0,1,2,3] row_mask:0xf bank_mask:0x8
v_mfma_f32_16x16x32_bf16 v[48:51],a[248:251],v[28:31],v[48:51]
v_mov_b32_dpp v20,v54 quad_perm:[0,1,2,3] row_mask:0xf bank_mask:0x1
v_mov_b32_dpp v21,v55 quad_perm:[0,1,2,3] row_mask:0xf bank_mask:0x1
v_mfma_f32_16x16x32_bf16 v[44:47],a[236:239],v[32:35],v[44:47]
v_mov_b32_dpp v22,v54 row_shl:4 row_mask:0xf bank_mask:0x1
v_mov_b32_dpp v23,v55 row_shl:4 row_mask:0xf bank_mask:0x1
v_mfma_f32_16x16x32_bf16 v[48:51],a[252:255],v[32:35],v[48:51]
Lw_166:
s_add_u32 m0,s82,0x1080
s_nop 0
buffer_load_dwordx4 v5,s[8:11],s71 offen offset:1024 nt lds
s_cmp_ge_i32 s85,3
s_cbranch_scc0 Lw_167
ds_write_b32 v1,v38
s_waitcnt lgkmcnt(0)
s_barrier
ds_read_b32 v38,v2
v_mfma_f32_16x16x32_bf16 v[56:59],v[16:19],v[20:23],v[56:59]
v_mov_b32_dpp v24,v54 row_shr:4 row_mask:0xf bank_mask:0x2
v_mov_b32_dpp v25,v55 row_shr:4 row_mask:0xf bank_mask:0x2
v_mfma_f32_16x16x32_bf16 v[44:47],v[64:67],v[20:23],v[44:47]
v_mov_b32_dpp v26,v54 quad_perm:[0,1,2,3] row_mask:0xf bank_mask:0x2
v_mov_b32_dpp v27,v55 quad_perm:[0,1,2,3] row_mask:0xf bank_mask:0x2
v_mfma_f32_16x16x32_bf16 v[48:51],v[80:83],v[20:23],v[48:51]
v_mov_b32_dpp v28,v54 row_shr:8 row_mask:0xf bank_mask:0x4
v_mov_b32_dpp v29,v55 row_shr:8 row_mask:0xf bank_mask:0x4
v_mfma_f32_16x16x32_bf16 v[44:47],v[68:71],v[24:27],v[44:47]
v_mov_b32_dpp v30,v54 row_shr:4 row_mask:0xf bank_mask:0x4
v_mov_b32_dpp v31,v55 row_shr:4 row_mask:0xf bank_mask:0x4
v_mfma_f32_16x16x32_bf16 v[48:51],v[84:87],v[24:27],v[48:51]
v_mov_b32_dpp v32,v54 row_shr:12 row_mask:0xf bank_mask:0x8
v_mov_b32_dpp v33,v55 row_shr:12 row_mask:0xf bank_mask:0x8
v_mfma_f32_16x16x32_bf16 v[44:47],v[72:75],v[28:31],v[44:47]
v_mov_b32_dpp v34,v54 row_shr:8 row_mask:0xf bank_mask:0x8
v_mov_b32_dpp v35,v55 row_shr:8 row_mask:0xf bank_mask:0x8
v_mfma_f32_16x16x32_bf16 v[48:51],v[88:91],v[28:31],v[48:51]
s_waitcnt lgkmcnt(0)
v_max_f32_dpp v60,v38,v38 quad_perm:[1,0,3,2] row_mask:15 bank_mask:15
v_mfma_f32_16x16x32_bf16 v[44:47],v[76:79],v[32:35],v[44:47]
s_nop 0
v_max_f32_dpp v60,v60,v60 quad_perm:[2,3,0,1] row_mask:15 bank_mask:15
v_sub_f32 v61,v38,v60
v_mfma_f32_16x16x32_bf16 v[48:51],v[92:95],v[32:35],v[48:51]
v_exp_f32 v61,v61
Lw_167:
s_waitcnt vmcnt(11)
ds_read_b128 a[48:51],v8 offset:12576
ds_read_b128 a[52:55],v9 offset:12576
ds_read_b128 a[56:59],v10 offset:12576
ds_read_b128 a[60:63],v11 offset:12576
s_add_u32 m0,s82,0x10a0
s_nop 0
buffer_load_dwordx4 v5,s[8:11],s71 offen offset:2048 nt lds
s_add_u32 m0,s82,0x10c0
s_nop 0
buffer_load_dwordx4 v5,s[8:11],s71 offen offset:3072 nt lds
s_waitcnt lgkmcnt(4)
s_add_u32 s71,s98,0x1000
s_add_u32 m0,s82,0x20c0
s_nop 0
buffer_load_dwordx4 v5,s[8:11],s71 offen offset:0 nt lds
s_cmp_ge_i32 s85,3
s_cbranch_scc0 Lw_168
s_mov_b32 exec_lo,0xf000f
s_mov_b32 exec_hi,0xf000f
ds_write_b32 v1,v56 offset:4
s_mov_b64 exec,-1
ds_write_b128 v7,v[44:47] offset:0
ds_write_b128 v7,v[48:51] offset:16
s_waitcnt lgkmcnt(0)
s_barrier
ds_read_b32 v39,v2 offset:4
ds_read_b64 v[44:45],v0 offset:0
ds_read_b64 v[46:47],v0 offset:2112
ds_read_b64 v[48:49],v0 offset:4224
ds_read_b64 v[50:51],v0 offset:6336
s_waitcnt lgkmcnt(4)
v_mul_f32 v58,v61,v39
s_waitcnt lgkmcnt(0)
v_mul_f32_dpp v52,v61,v44 quad_perm:[0,0,0,0] row_mask:15 bank_mask:15
v_mul_f32_dpp v53,v61,v45 quad_perm:[0,0,0,0] row_mask:15 bank_mask:15
v_add_f32_dpp v58,v58,v58 quad_perm:[1,0,3,2] row_mask:15 bank_mask:15
v_fmac_f32_dpp v52,v61,v46 quad_perm:[1,1,1,1] row_mask:15 bank_mask:15
v_fmac_f32_dpp v53,v61,v47 quad_perm:[1,1,1,1] row_mask:15 bank_mask:15
v_add_f32_dpp v58,v58,v58 quad_perm:[2,3,0,1] row_mask:15 bank_mask:15
v_rcp_f32 v38,v58
v_log_f32 v58,v58
v_fmac_f32_dpp v52,v61,v48 quad_perm:[2,2,2,2] row_mask:15 bank_mask:15
v_fmac_f32_dpp v53,v61,v49 quad_perm:[2,2,2,2] row_mask:15 bank_mask:15
v_fmac_f32_dpp v52,v61,v50 quad_perm:[3,3,3,3] row_mask:15 bank_mask:15
v_fmac_f32_dpp v53,v61,v51 quad_perm:[3,3,3,3] row_mask:15 bank_mask:15
v_add_f32 v60,v60,v58
v_mul_f32 v52,v52,v38
v_mul_f32 v53,v53,v38
v_cvt_pk_bf16_f32 v52,v52,v53
Lw_168:
s_cmp_ge_i32 s85,3
s_cselect_b32 s94,s53,s96
s_add_u32 s95,s94,s76
s_cmp_lg_u32 s69,0
s_cbranch_scc0 Ls_169
buffer_store_dword v52,v36,s[12:15],s94 offen
s_mov_b32 exec_lo,1
s_mov_b32 exec_hi,0
buffer_store_dword v60,v3,s[12:15],s95 offen
Ls_170:
s_mov_b64 exec,-1
s_add_u32 m0,s82,0x20e0
s_nop 0
buffer_load_dwordx4 v5,s[8:11],s71 offen offset:1024 nt lds
s_waitcnt vmcnt(12)
s_add_u32 m0,s82,0x2100
s_nop 0
buffer_load_dwordx4 v5,s[8:11],s71 offen offset:2048 nt lds
s_add_u32 m0,s82,0x2120
s_nop 0
buffer_load_dwordx4 v5,s[8:11],s71 offen offset:3072 nt lds
s_cmp_eq_u32 s85,8
s_cbranch_scc1 L_exit1
s_waitcnt vmcnt(13)
s_waitcnt lgkmcnt(0)
s_add_u32 s71,s98,0x2000
s_add_u32 m0,s82,0x3120
s_nop 0
buffer_load_dwordx4 v5,s[8:11],s71 offen offset:0 nt lds
s_waitcnt vmcnt(13)
s_add_u32 m0,s82,0x3140
s_nop 0
buffer_load_dwordx4 v5,s[8:11],s71 offen offset:1024 nt lds
s_waitcnt vmcnt(13)
s_waitcnt vmcnt(12)
s_add_u32 m0,s82,0x3160
s_nop 0
buffer_load_dwordx4 v5,s[8:11],s71 offen offset:2048 nt lds
s_cmp_eq_u32 s85,1
s_cbranch_scc1 Lg_171
Lg_172:
s_cmp_ge_i32 s85,1
s_cbranch_scc0 Lw_175
Lc_176:
v_cmp_u_f32 vcc,v40,v41
s_cbranch_vccnz Lr_178
v_cmp_u_f32 vcc,v42,v43
s_cbranch_vccnz Lr_178
Lo_177:
ds_write_b128 v4,v[40:43]
ds_read_b128 v[20:23],v6 offset:0
ds_read_b128 v[24:27],v6 offset:64
ds_read_b128 v[28:31],v6 offset:128
ds_read_b128 v[32:35],v6 offset:192
ds_read_b128 v[64:67],v8 offset:20960
ds_read_b128 v[68:71],v9 offset:20960
ds_read_b128 v[72:75],v10 offset:20960
ds_read_b128 v[76:79],v11 offset:20960
ds_read_b128 v[80:83],v8 offset:25152
ds_read_b128 v[84:87],v9 offset:25152
ds_read_b128 v[88:91],v10 offset:25152
ds_read_b128 v[92:95],v11 offset:25152
s_waitcnt lgkmcnt(8)
v_mfma_f32_16x16x32_bf16 v[44:47],a[0:3],v[20:23],0
v_mfma_f32_16x16x32_bf16 v[44:47],a[4:7],v[24:27],v[44:47]
v_mfma_f32_16x16x32_bf16 v[44:47],a[8:11],v[28:31],v[44:47]
v_mfma_f32_16x16x32_bf16 v[44:47],a[12:15],v[32:35],v[44:47]
v_mfma_f32_16x16x32_bf16 v[52:55],a[16:19],v[20:23],0
v_mfma_f32_16x16x32_bf16 v[52:55],a[20:23],v[24:27],v[52:55]
v_mfma_f32_16x16x32_bf16 v[52:55],a[24:27],v[28:31],v[52:55]
v_mfma_f32_16x16x32_bf16 v[52:55],a[28:31],v[32:35],v[52:55]
v_mfma_f32_16x16x32_bf16 v[40:43],a[32:35],v[20:23],0
v_mfma_f32_16x16x32_bf16 v[40:43],a[36:39],v[24:27],v[40:43]
v_mfma_f32_16x16x32_bf16 v[40:43],a[40:43],v[28:31],v[40:43]
v_mfma_f32_16x16x32_bf16 v[40:43],a[44:47],v[32:35],v[40:43]
v_mfma_f32_16x16x32_bf16 v[56:59],a[48:51],v[20:23],0
v_mfma_f32_16x16x32_bf16 v[56:59],a[52:55],v[24:27],v[56:59]
v_mfma_f32_16x16x32_bf16 v[56:59],a[56:59],v[28:31],v[56:59]
v_mfma_f32_16x16x32_bf16 v[56:59],a[60:63],v[32:35],v[56:59]
v_mov_b32_dpp v44,v52 quad_perm:[0,1,2,3] row_mask:0xf bank_mask:0x2
v_mov_b32_dpp v45,v53 quad_perm:[0,1,2,3] row_mask:0xf bank_mask:0x2
s_waitcnt lgkmcnt(4)
v_mfma_f32_16x16x32_bf16 v[48:51],v[64:67],v[20:23],0
v_mov_b32_dpp v46,v54 quad_perm:[0,1,2,3] row_mask:0xf bank_mask:0x2
v_mov_b32_dpp v47,v55 quad_perm:[0,1,2,3] row_mask:0xf bank_mask:0x2
v_mfma_f32_16x16x32_bf16 v[48:51],v[68:71],v[24:27],v[48:51]
v_mov_b32_dpp v44,v40 quad_perm:[0,1,2,3] row_mask:0xf bank_mask:0x4
v_mov_b32_dpp v45,v41 quad_perm:[0,1,2,3] row_mask:0xf bank_mask:0x4
v_mfma_f32_16x16x32_bf16 v[48:51],v[72:75],v[28:31],v[48:51]
v_mov_b32_dpp v46,v42 quad_perm:[0,1,2,3] row_mask:0xf bank_mask:0x4
v_mov_b32_dpp v47,v43 quad_perm:[0,1,2,3] row_mask:0xf bank_mask:0x4
v_mfma_f32_16x16x32_bf16 v[48:51],v[76:79],v[32:35],v[48:51]
s_waitcnt lgkmcnt(0)
v_mfma_f32_16x16x32_bf16 v[52:55],v[80:83],v[20:23],0
v_mfma_f32_16x16x32_bf16 v[52:55],v[84:87],v[24:27],v[52:55]
v_mov_b32_dpp v44,v56 quad_perm:[0,1,2,3] row_mask:0xf bank_mask:0x8
v_mov_b32_dpp v45,v57 quad_perm:[0,1,2,3] row_mask:0xf bank_mask:0x8
v_mfma_f32_16x16x32_bf16 v[52:55],v[88:91],v[28:31],v[52:55]
v_mov_b32_dpp v46,v58 quad_perm:[0,1,2,3] row_mask:0xf bank_mask:0x8
v_mov_b32_dpp v47,v59 quad_perm:[0,1,2,3] row_mask:0xf bank_mask:0x8
v_mfma_f32_16x16x32_bf16 v[52:55],v[92:95],v[32:35],v[52:55]
v_mov_b64 v[20:21],0
v_mov_b64 v[22:23],0
v_mov_b64 v[24:25],0
v_mov_b64 v[26:27],0
v_mov_b64 v[28:29],0
v_mov_b64 v[30:31],0
v_mov_b64 v[32:33],0
v_mov_b64 v[34:35],0
v_mov_b32_dpp v48,v52 quad_perm:[0,1,2,3] row_mask:0xf bank_mask:0x2
v_mov_b32_dpp v49,v53 quad_perm:[0,1,2,3] row_mask:0xf bank_mask:0x2
v_mov_b32_dpp v50,v54 quad_perm:[0,1,2,3] row_mask:0xf bank_mask:0x2
v_mov_b32_dpp v51,v55 quad_perm:[0,1,2,3] row_mask:0xf bank_mask:0x2
Lw_175:
s_add_u32 m0,s82,0x3180
s_nop 0
buffer_load_dwordx4 v5,s[8:11],s71 offen offset:3072 nt lds
s_add_u32 s71,s98,0x3000
s_add_u32 m0,s82,0x4180
s_nop 0
buffer_load_dwordx4 v5,s[8:11],s71 offen offset:0 nt lds
s_add_u32 m0,s82,0x41a0
s_nop 0
buffer_load_dwordx4 v5,s[8:11],s71 offen offset:1024 nt lds
s_waitcnt vmcnt(12)
ds_read_b64_tr_b16 a[192:193],v12 offset:4192
ds_read_b64_tr_b16 a[196:197],v12 offset:4224
ds_read_b64_tr_b16 a[200:201],v13 offset:4192
ds_read_b64_tr_b16 a[204:205],v13 offset:4224
ds_read_b64_tr_b16 a[208:209],v14 offset:4192
ds_read_b64_tr_b16 a[212:213],v14 offset:4224
ds_read_b64_tr_b16 a[216:217],v15 offset:4192
ds_read_b64_tr_b16 a[220:221],v15 offset:4224
s_add_u32 m0,s82,0x41c0
s_nop 0
buffer_load_dwordx4 v5,s[8:11],s71 offen offset:2048 nt lds
s_add_u32 m0,s82,0x41e0
s_nop 0
buffer_load_dwordx4 v5,s[8:11],s71 offen offset:3072 nt lds
s_cmp_ge_i32 s85,1
s_cbranch_scc0 Lw_179
v_max3_f32 v38,v44,v45,v46
v_max3_f32 v38,v38,v47,v48
v_max3_f32 v38,v38,v49,v50
v_max_f32 v38,v38,v51
s_nop 1
v_max_f32_dpp v38,v38,v38 row_ror:4 row_mask:15 bank_mask:15
s_nop 1
v_max_f32_dpp v38,v38,v38 row_ror:8 row_mask:15 bank_mask:15
v_mov_b32 v37,v38
s_nop 1
v_permlane16_swap_b32 v38,v37
v_max_f32 v38,v38,v37
v_mov_b32 v37,v38
s_nop 1
v_permlane32_swap_b32 v38,v37
v_max_f32 v38,v38,v37
v_mul_f32 v38,s74,v38
v_fma_f32 v44,v44,s74,-v38
v_fma_f32 v45,v45,s74,-v38
v_fma_f32 v46,v46,s74,-v38
v_fma_f32 v47,v47,s74,-v38
v_fma_f32 v48,v48,s74,-v38
v_fma_f32 v49,v49,s74,-v38
v_fma_f32 v50,v50,s74,-v38
v_fma_f32 v51,v51,s74,-v38
v_exp_f32 v44,v44
v_exp_f32 v45,v45
v_exp_f32 v46,v46
v_exp_f32 v47,v47
v_exp_f32 v48,v48
v_exp_f32 v49,v49
v_exp_f32 v50,v50
v_exp_f32 v51,v51
v_cvt_pk_bf16_f32 v40,v44,v45
v_cvt_pk_bf16_f32 v41,v46,v47
v_cvt_pk_bf16_f32 v42,v48,v49
v_cvt_pk_bf16_f32 v43,v50,v51
Lw_179:
s_add_u32 s71,s98,0x4000
s_add_u32 m0,s82,0
s_nop 0
buffer_load_dwordx4 v5,s[8:11],s71 offen offset:0 nt lds
s_add_u32 m0,s82,32
s_nop 0
buffer_load_dwordx4 v5,s[8:11],s71 offen offset:1024 nt lds
s_waitcnt vmcnt(11)
s_waitcnt vmcnt(10)
ds_read_b64_tr_b16 a[194:195],v12 offset:8384
ds_read_b64_tr_b16 a[198:199],v12 offset:8416
ds_read_b64_tr_b16 a[202:203],v13 offset:8384
ds_read_b64_tr_b16 a[206:207],v13 offset:8416
ds_read_b64_tr_b16 a[210:211],v14 offset:8384
ds_read_b64_tr_b16 a[214:215],v14 offset:8416
ds_read_b64_tr_b16 a[218:219],v15 offset:8384
ds_read_b64_tr_b16 a[222:223],v15 offset:8416
s_add_u32 m0,s82,64
s_nop 0
buffer_load_dwordx4 v5,s[8:11],s71 offen offset:2048 nt lds
s_cmp_ge_i32 s85,1
s_cbranch_scc0 Lw_180
v_mov_b32_dpp v20,v40 quad_perm:[0,1,2,3] row_mask:0xf bank_mask:0x1
v_mov_b32_dpp v21,v41 quad_perm:[0,1,2,3] row_mask:0xf bank_mask:0x1
v_mov_b32_dpp v22,v40 row_shl:4 row_mask:0xf bank_mask:0x1
v_mov_b32_dpp v23,v41 row_shl:4 row_mask:0xf bank_mask:0x1
s_waitcnt lgkmcnt(8)
s_waitcnt lgkmcnt(0)
v_mfma_f32_16x16x32_bf16 v[52:55],v[16:19],v[20:23],0
v_mov_b32_dpp v24,v40 row_shr:4 row_mask:0xf bank_mask:0x2
v_mov_b32_dpp v25,v41 row_shr:4 row_mask:0xf bank_mask:0x2
v_mfma_f32_16x16x32_bf16 v[44:47],a[192:195],v[20:23],0
v_mov_b32_dpp v26,v40 quad_perm:[0,1,2,3] row_mask:0xf bank_mask:0x2
v_mov_b32_dpp v27,v41 quad_perm:[0,1,2,3] row_mask:0xf bank_mask:0x2
v_mfma_f32_16x16x32_bf16 v[48:51],a[208:211],v[20:23],0
v_mov_b32_dpp v28,v40 row_shr:8 row_mask:0xf bank_mask:0x4
v_mov_b32_dpp v29,v41 row_shr:8 row_mask:0xf bank_mask:0x4
v_mfma_f32_16x16x32_bf16 v[44:47],a[196:199],v[24:27],v[44:47]
v_mov_b32_dpp v30,v40 row_shr:4 row_mask:0xf bank_mask:0x4
v_mov_b32_dpp v31,v41 row_shr:4 row_mask:0xf bank_mask:0x4
v_mfma_f32_16x16x32_bf16 v[48:51],a[212:215],v[24:27],v[48:51]
v_mov_b32_dpp v32,v40 row_shr:12 row_mask:0xf bank_mask:0x8
v_mov_b32_dpp v33,v41 row_shr:12 row_mask:0xf bank_mask:0x8
v_mfma_f32_16x16x32_bf16 v[44:47],a[200:203],v[28:31],v[44:47]
v_mov_b32_dpp v34,v40 row_shr:8 row_mask:0xf bank_mask:0x8
v_mov_b32_dpp v35,v41 row_shr:8 row_mask:0xf bank_mask:0x8
v_mfma_f32_16x16x32_bf16 v[48:51],a[216:219],v[28:31],v[48:51]
s_nop 0
v_mfma_f32_16x16x32_bf16 v[44:47],a[204:207],v[32:35],v[44:47]
v_mfma_f32_16x16x32_bf16 v[48:51],a[220:223],v[32:35],v[48:51]
Lw_180:
s_add_u32 m0,s82,0x60
s_nop 0
buffer_load_dwordx4 v5,s[8:11],s71 offen offset:3072 nt lds
s_waitcnt vmcnt(11)
s_waitcnt lgkmcnt(8)
s_add_u32 s71,s98,0x5000
s_add_u32 m0,s82,0x1060
s_nop 0
buffer_load_dwordx4 v5,s[8:11],s71 offen offset:0 nt lds
s_waitcnt vmcnt(11)
s_add_u32 m0,s82,0x1080
s_nop 0
buffer_load_dwordx4 v5,s[8:11],s71 offen offset:1024 nt lds
s_waitcnt vmcnt(11)
s_waitcnt vmcnt(10)
ds_read_b64_tr_b16 a[224:225],v12 offset:12576
ds_read_b64_tr_b16 a[228:229],v12 offset:12608
ds_read_b64_tr_b16 a[232:233],v13 offset:12576
ds_read_b64_tr_b16 a[236:237],v13 offset:12608
ds_read_b64_tr_b16 a[240:241],v14 offset:12576
ds_read_b64_tr_b16 a[244:245],v14 offset:12608
ds_read_b64_tr_b16 a[248:249],v15 offset:12576
ds_read_b64_tr_b16 a[252:253],v15 offset:12608
s_add_u32 m0,s82,0x10a0
s_nop 0
buffer_load_dwordx4 v5,s[8:11],s71 offen offset:2048 nt lds
s_add_u32 m0,s82,0x10c0
s_nop 0
buffer_load_dwordx4 v5,s[8:11],s71 offen offset:3072 nt lds
s_waitcnt vmcnt(11)
L_cut1:
s_add_u32 s85,s85,1
s_lshl_b32 s98,s85,24
s_add_u32 s98,s98,s45
s_waitcnt lgkmcnt(8)
s_add_u32 s71,s98,0
s_add_u32 m0,s82,0x20c0
s_nop 0
buffer_load_dwordx4 v5,s[4:7],s71 offen offset:0 nt lds
s_waitcnt vmcnt(11)
s_add_u32 m0,s82,0x20e0
s_nop 0
buffer_load_dwordx4 v5,s[4:7],s71 offen offset:1024 nt lds
s_waitcnt vmcnt(11)
s_waitcnt vmcnt(10)
ds_read_b64_tr_b16 a[226:227],v12 offset:16768
ds_read_b64_tr_b16 a[230:231],v12 offset:16800
ds_read_b64_tr_b16 a[234:235],v13 offset:16768
ds_read_b64_tr_b16 a[238:239],v13 offset:16800
ds_read_b64_tr_b16 a[242:243],v14 offset:16768
ds_read_b64_tr_b16 a[246:247],v14 offset:16800
ds_read_b64_tr_b16 a[250:251],v15 offset:16768
ds_read_b64_tr_b16 a[254:255],v15 offset:16800
s_add_u32 m0,s82,0x2100
s_nop 0
buffer_load_dwordx4 v5,s[4:7],s71 offen offset:2048 nt lds
s_cmp_ge_i32 s85,2
s_cbranch_scc0 Lw_181
v_mov_b32_dpp v20,v40 row_shl:8 row_mask:0xf bank_mask:0x1
v_mov_b32_dpp v21,v41 row_shl:8 row_mask:0xf bank_mask:0x1
v_mov_b32_dpp v22,v40 row_shl:12 row_mask:0xf bank_mask:0x1
v_mov_b32_dpp v23,v41 row_shl:12 row_mask:0xf bank_mask:0x1
s_waitcnt lgkmcnt(8)
s_waitcnt lgkmcnt(0)
v_mfma_f32_16x16x32_bf16 v[52:55],v[16:19],v[20:23],v[52:55]
v_mov_b32_dpp v24,v40 row_shl:4 row_mask:0xf bank_mask:0x2
v_mov_b32_dpp v25,v41 row_shl:4 row_mask:0xf bank_mask:0x2
v_mfma_f32_16x16x32_bf16 v[44:47],a[224:227],v[20:23],v[44:47]
v_mov_b32_dpp v26,v40 row_shl:8 row_mask:0xf bank_mask:0x2
v_mov_b32_dpp v27,v41 row_shl:8 row_mask:0xf bank_mask:0x2
v_mfma_f32_16x16x32_bf16 v[48:51],a[240:243],v[20:23],v[48:51]
v_mov_b32_dpp v28,v40 quad_perm:[0,1,2,3] row_mask:0xf bank_mask:0x4
v_mov_b32_dpp v29,v41 quad_perm:[0,1,2,3] row_mask:0xf bank_mask:0x4
v_mfma_f32_16x16x32_bf16 v[44:47],a[228:231],v[24:27],v[44:47]
v_mov_b32_dpp v30,v40 row_shl:4 row_mask:0xf bank_mask:0x4
v_mov_b32_dpp v31,v41 row_shl:4 row_mask:0xf bank_mask:0x4
v_mfma_f32_16x16x32_bf16 v[48:51],a[244:247],v[24:27],v[48:51]
v_mov_b32_dpp v32,v40 row_shr:4 row_mask:0xf bank_mask:0x8
v_mov_b32_dpp v33,v41 row_shr:4 row_mask:0xf bank_mask:0x8
v_mfma_f32_16x16x32_bf16 v[44:47],a[232:235],v[28:31],v[44:47]
v_mov_b32_dpp v34,v40 quad_perm:[0,1,2,3] row_mask:0xf bank_mask:0x8
v_mov_b32_dpp v35,v41 quad_perm:[0,1,2,3] row_mask:0xf bank_mask:0x8
v_mfma_f32_16x16x32_bf16 v[48:51],a[248:251],v[28:31],v[48:51]
s_nop 0
v_mfma_f32_16x16x32_bf16 v[44:47],a[236:239],v[32:35],v[44:47]
v_mfma_f32_16x16x32_bf16 v[48:51],a[252:255],v[32:35],v[48:51]
Lw_181:
s_add_u32 m0,s82,0x2120
s_nop 0
buffer_load_dwordx4 v5,s[4:7],s71 offen offset:3072 nt lds
s_waitcnt vmcnt(11)
s_waitcnt lgkmcnt(8)
s_add_u32 s71,s98,0x1000
s_add_u32 m0,s82,0x3120
s_nop 0
buffer_load_dwordx4 v5,s[4:7],s71 offen offset:0 nt lds
s_waitcnt vmcnt(11)
s_add_u32 m0,s82,0x3140
s_nop 0
buffer_load_dwordx4 v5,s[4:7],s71 offen offset:1024 nt lds
s_waitcnt vmcnt(11)
s_waitcnt vmcnt(10)
ds_read_b64_tr_b16 v[64:65],v12 offset:0
ds_read_b64_tr_b16 v[68:69],v12 offset:32
ds_read_b64_tr_b16 v[72:73],v13 offset:0
ds_read_b64_tr_b16 v[76:77],v13 offset:32
ds_read_b64_tr_b16 v[80:81],v14 offset:0
ds_read_b64_tr_b16 v[84:85],v14 offset:32
ds_read_b64_tr_b16 v[88:89],v15 offset:0
ds_read_b64_tr_b16 v[92:93],v15 offset:32
s_add_u32 m0,s82,0x3160
s_nop 0
buffer_load_dwordx4 v5,s[4:7],s71 offen offset:2048 nt lds
s_add_u32 m0,s82,0x3180
s_nop 0
buffer_load_dwordx4 v5,s[4:7],s71 offen offset:3072 nt lds
s_waitcnt vmcnt(11)
s_waitcnt lgkmcnt(8)
s_add_u32 s71,s98,0x2000
s_add_u32 m0,s82,0x4180
s_nop 0
buffer_load_dwordx4 v5,s[4:7],s71 offen offset:0 nt lds
s_sub_u32 s49,s85,3
s_lshl_b32 s49,s49,13
s_add_u32 s49,s49,0x10000
s_add_u32 s49,s49,s80
s_cmp_ge_i32 s85,3
s_cselect_b32 s49,s49,s96
buffer_load_dwordx4 v[56:59],v3,s[12:15],s49 offen offset:0 sc1
s_waitcnt vmcnt(12)
s_add_u32 m0,s82,0x41a0
s_nop 0
buffer_load_dwordx4 v5,s[4:7],s71 offen offset:1024 nt lds
s_waitcnt vmcnt(12)
s_waitcnt vmcnt(11)
ds_read_b64_tr_b16 v[66:67],v12 offset:4192
ds_read_b64_tr_b16 v[70:71],v12 offset:4224
ds_read_b64_tr_b16 v[74:75],v13 offset:4192
ds_read_b64_tr_b16 v[78:79],v13 offset:4224
ds_read_b64_tr_b16 v[82:83],v14 offset:4192
ds_read_b64_tr_b16 v[86:87],v14 offset:4224
ds_read_b64_tr_b16 v[90:91],v15 offset:4192
ds_read_b64_tr_b16 v[94:95],v15 offset:4224
s_add_u32 m0,s82,0x41c0
s_nop 0
buffer_load_dwordx4 v5,s[4:7],s71 offen offset:2048 nt lds
s_cmp_eq_u32 s85,1
s_cbranch_scc1 Lf_182
Lf_183:
s_cmp_ge_i32 s85,2
s_cbranch_scc0 Lw_186
ds_write_b32 v1,v38
s_waitcnt lgkmcnt(0)
s_barrier
ds_read_b32 v38,v2
v_mov_b32_dpp v20,v42 quad_perm:[0,1,2,3] row_mask:0xf bank_mask:0x1
v_mov_b32_dpp v21,v43 quad_perm:[0,1,2,3] row_mask:0xf bank_mask:0x1
v_mov_b32_dpp v22,v42 row_shl:4 row_mask:0xf bank_mask:0x1
v_mov_b32_dpp v23,v43 row_shl:4 row_mask:0xf bank_mask:0x1
s_waitcnt lgkmcnt(9)
s_waitcnt lgkmcnt(1)
v_mfma_f32_16x16x32_bf16 v[52:55],v[16:19],v[20:23],v[52:55]
v_mov_b32_dpp v24,v42 row_shr:4 row_mask:0xf bank_mask:0x2
v_mov_b32_dpp v25,v43 row_shr:4 row_mask:0xf bank_mask:0x2
v_mfma_f32_16x16x32_bf16 v[44:47],v[64:67],v[20:23],v[44:47]
v_mov_b32_dpp v26,v42 quad_perm:[0,1,2,3] row_mask:0xf bank_mask:0x2
v_mov_b32_dpp v27,v43 quad_perm:[0,1,2,3] row_mask:0xf bank_mask:0x2
v_mfma_f32_16x16x32_bf16 v[48:51],v[80:83],v[20:23],v[48:51]
v_mov_b32_dpp v28,v42 row_shr:8 row_mask:0xf bank_mask:0x4
v_mov_b32_dpp v29,v43 row_shr:8 row_mask:0xf bank_mask:0x4
v_mfma_f32_16x16x32_bf16 v[44:47],v[68:71],v[24:27],v[44:47]
v_mov_b32_dpp v30,v42 row_shr:4 row_mask:0xf bank_mask:0x4
v_mov_b32_dpp v31,v43 row_shr:4 row_mask:0xf bank_mask:0x4
v_mfma_f32_16x16x32_bf16 v[48:51],v[84:87],v[24:27],v[48:51]
v_mov_b32_dpp v32,v42 row_shr:12 row_mask:0xf bank_mask:0x8
v_mov_b32_dpp v33,v43 row_shr:12 row_mask:0xf bank_mask:0x8
v_mfma_f32_16x16x32_bf16 v[44:47],v[72:75],v[28:31],v[44:47]
v_mov_b32_dpp v34,v42 row_shr:8 row_mask:0xf bank_mask:0x8
v_mov_b32_dpp v35,v43 row_shr:8 row_mask:0xf bank_mask:0x8
v_mfma_f32_16x16x32_bf16 v[48:51],v[88:91],v[28:31],v[48:51]
s_waitcnt lgkmcnt(0)
v_max_f32_dpp v60,v38,v38 quad_perm:[1,0,3,2] row_mask:15 bank_mask:15
v_mfma_f32_16x16x32_bf16 v[44:47],v[76:79],v[32:35],v[44:47]
s_nop 0
v_max_f32_dpp v60,v60,v60 quad_perm:[2,3,0,1] row_mask:15 bank_mask:15
v_sub_f32 v61,v38,v60
v_mfma_f32_16x16x32_bf16 v[48:51],v[92:95],v[32:35],v[48:51]
v_exp_f32 v61,v61
Lw_186:
s_add_u32 m0,s82,0x41e0
s_nop 0
buffer_load_dwordx4 v5,s[4:7],s71 offen offset:3072 nt lds
s_waitcnt lgkmcnt(8)
s_add_u32 s71,s98,0x3000
s_add_u32 m0,s82,0
s_nop 0
buffer_load_dwordx4 v5,s[4:7],s71 offen offset:0 nt lds
s_cmp_ge_i32 s85,2
s_cbranch_scc0 Lw_187
s_mov_b32 exec_lo,0xf000f
s_mov_b32 exec_hi,0xf000f
ds_write_b32 v1,v52 offset:4
s_mov_b64 exec,-1
ds_write_b128 v7,v[44:47] offset:0
ds_write_b128 v7,v[48:51] offset:16
s_waitcnt lgkmcnt(0)
s_barrier
ds_read_b32 v39,v2 offset:4
ds_read_b64 v[44:45],v0 offset:0
ds_read_b64 v[46:47],v0 offset:2112
ds_read_b64 v[48:49],v0 offset:4224
ds_read_b64 v[50:51],v0 offset:6336
s_waitcnt lgkmcnt(4)
v_mul_f32 v54,v61,v39
s_waitcnt lgkmcnt(0)
v_mul_f32_dpp v40,v61,v44 quad_perm:[0,0,0,0] row_mask:15 bank_mask:15
v_mul_f32_dpp v41,v61,v45 quad_perm:[0,0,0,0] row_mask:15 bank_mask:15
v_add_f32_dpp v54,v54,v54 quad_perm:[1,0,3,2] row_mask:15 bank_mask:15
v_fmac_f32_dpp v40,v61,v46 quad_perm:[1,1,1,1] row_mask:15 bank_mask:15
v_fmac_f32_dpp v41,v61,v47 quad_perm:[1,1,1,1] row_mask:15 bank_mask:15
v_add_f32_dpp v54,v54,v54 quad_perm:[2,3,0,1] row_mask:15 bank_mask:15
v_rcp_f32 v38,v54
v_log_f32 v54,v54
v_fmac_f32_dpp v40,v61,v48 quad_perm:[2,2,2,2] row_mask:15 bank_mask:15
v_fmac_f32_dpp v41,v61,v49 quad_perm:[2,2,2,2] row_mask:15 bank_mask:15
v_fmac_f32_dpp v40,v61,v50 quad_perm:[3,3,3,3] row_mask:15 bank_mask:15
v_fmac_f32_dpp v41,v61,v51 quad_perm:[3,3,3,3] row_mask:15 bank_mask:15
v_add_f32 v60,v60,v54
v_mul_f32 v40,v40,v38
v_mul_f32 v41,v41,v38
v_cvt_pk_bf16_f32 v40,v40,v41
Lw_187:
s_cmp_ge_i32 s85,2
s_cselect_b32 s94,s50,s96
s_add_u32 s95,s94,s76
s_cmp_lg_u32 s69,0
s_cbranch_scc0 Ls_188
buffer_store_dword v40,v36,s[12:15],s94 offen
s_mov_b32 exec_lo,1
s_mov_b32 exec_hi,0
buffer_store_dword v60,v3,s[12:15],s95 offen
Ls_189:
s_mov_b64 exec,-1
s_add_u32 m0,s82,32
s_nop 0
buffer_load_dwordx4 v5,s[4:7],s71 offen offset:1024 nt lds
s_add_u32 m0,s82,64
s_nop 0
buffer_load_dwordx4 v5,s[4:7],s71 offen offset:2048 nt lds
s_add_u32 m0,s82,0x60
s_nop 0
buffer_load_dwordx4 v5,s[4:7],s71 offen offset:3072 nt lds
s_sub_u32 s48,s85,0
s_lshl_b32 s48,s48,13
s_add_u32 s48,s48,0
s_add_u32 s48,s48,s80
s_cmp_ge_i32 s85,1
s_cselect_b32 s48,s48,s96
buffer_load_dwordx4 v[40:43],v3,s[12:15],s48 offen offset:0 sc1
s_waitcnt vmcnt(10)
s_cmp_ge_i32 s85,3
s_cbranch_scc0 Lw_190
Lc_191:
v_cmp_u_f32 vcc,v56,v57
s_cbranch_vccnz Lr_193
v_cmp_u_f32 vcc,v58,v59
s_cbranch_vccnz Lr_193
Lo_192:
ds_write_b128 v4,v[56:59]
ds_read_b128 v[20:23],v6 offset:0
ds_read_b128 v[24:27],v6 offset:64
ds_read_b128 v[28:31],v6 offset:128
ds_read_b128 v[32:35],v6 offset:192
s_waitcnt lgkmcnt(0)
v_mfma_f32_16x16x32_bf16 v[44:47],a[64:67],v[20:23],0
v_mfma_f32_16x16x32_bf16 v[44:47],a[68:71],v[24:27],v[44:47]
v_mfma_f32_16x16x32_bf16 v[44:47],a[72:75],v[28:31],v[44:47]
v_mfma_f32_16x16x32_bf16 v[44:47],a[76:79],v[32:35],v[44:47]
ds_read_b128 a[64:67],v8 offset:29344
ds_read_b128 a[68:71],v9 offset:29344
ds_read_b128 a[72:75],v10 offset:29344
ds_read_b128 a[76:79],v11 offset:29344
v_mfma_f32_16x16x32_bf16 v[52:55],a[80:83],v[20:23],0
v_mfma_f32_16x16x32_bf16 v[52:55],a[84:87],v[24:27],v[52:55]
v_mfma_f32_16x16x32_bf16 v[52:55],a[88:91],v[28:31],v[52:55]
v_mfma_f32_16x16x32_bf16 v[52:55],a[92:95],v[32:35],v[52:55]
v_mfma_f32_16x16x32_bf16 v[56:59],a[96:99],v[20:23],0
v_mfma_f32_16x16x32_bf16 v[56:59],a[100:103],v[24:27],v[56:59]
v_mfma_f32_16x16x32_bf16 v[56:59],a[104:107],v[28:31],v[56:59]
v_mfma_f32_16x16x32_bf16 v[56:59],a[108:111],v[32:35],v[56:59]
v_mfma_f32_16x16x32_bf16 v[60:63],a[112:115],v[20:23],0
v_mfma_f32_16x16x32_bf16 v[60:63],a[116:119],v[24:27],v[60:63]
v_mfma_f32_16x16x32_bf16 v[60:63],a[120:123],v[28:31],v[60:63]
v_mfma_f32_16x16x32_bf16 v[60:63],a[124:127],v[32:35],v[60:63]
v_mov_b32_dpp v44,v52 quad_perm:[0,1,2,3] row_mask:0xf bank_mask:0x2
v_mov_b32_dpp v45,v53 quad_perm:[0,1,2,3] row_mask:0xf bank_mask:0x2
s_waitcnt lgkmcnt(0)
v_mfma_f32_16x16x32_bf16 v[48:51],a[64:67],v[20:23],0
v_mov_b32_dpp v46,v54 quad_perm:[0,1,2,3] row_mask:0xf bank_mask:0x2
v_mov_b32_dpp v47,v55 quad_perm:[0,1,2,3] row_mask:0xf bank_mask:0x2
v_mfma_f32_16x16x32_bf16 v[48:51],a[68:71],v[24:27],v[48:51]
v_mov_b32_dpp v44,v56 quad_perm:[0,1,2,3] row_mask:0xf bank_mask:0x4
v_mov_b32_dpp v45,v57 quad_perm:[0,1,2,3] row_mask:0xf bank_mask:0x4
v_mfma_f32_16x16x32_bf16 v[48:51],a[72:75],v[28:31],v[48:51]
v_mov_b32_dpp v46,v58 quad_perm:[0,1,2,3] row_mask:0xf bank_mask:0x4
v_mov_b32_dpp v47,v59 quad_perm:[0,1,2,3] row_mask:0xf bank_mask:0x4
v_mfma_f32_16x16x32_bf16 v[48:51],a[76:79],v[32:35],v[48:51]
v_mov_b32_dpp v44,v60 quad_perm:[0,1,2,3] row_mask:0xf bank_mask:0x8
v_mov_b32_dpp v45,v61 quad_perm:[0,1,2,3] row_mask:0xf bank_mask:0x8
v_mov_b32_dpp v46,v62 quad_perm:[0,1,2,3] row_mask:0xf bank_mask:0x8
v_mov_b32_dpp v47,v63 quad_perm:[0,1,2,3] row_mask:0xf bank_mask:0x8
v_mov_b64 v[20:21],0
v_mov_b64 v[22:23],0
v_mov_b64 v[24:25],0
v_mov_b64 v[26:27],0
v_mov_b64 v[28:29],0
v_mov_b64 v[30:31],0
v_mov_b64 v[32:33],0
v_mov_b64 v[34:35],0
Lw_190:
ds_read_b128 a[64:67],v8 offset:8384
ds_read_b128 a[68:71],v9 offset:8384
ds_read_b128 a[72:75],v10 offset:8384
ds_read_b128 a[76:79],v11 offset:8384
s_add_u32 s71,s98,0x4000
s_add_u32 m0,s82,0x72a0
s_nop 0
buffer_load_dwordx4 v5,s[4:7],s71 offen offset:0 nt lds
s_add_u32 m0,s82,0x72c0
s_nop 0
buffer_load_dwordx4 v5,s[4:7],s71 offen offset:1024 nt lds
ds_read_b128 a[80:83],v8 offset:12576
ds_read_b128 a[84:87],v9 offset:12576
ds_read_b128 a[88:91],v10 offset:12576
ds_read_b128 a[92:95],v11 offset:12576
s_add_u32 m0,s82,0x72e0
s_nop 0
buffer_load_dwordx4 v5,s[4:7],s71 offen offset:2048 nt lds
s_add_u32 m0,s82,0x7300
s_nop 0
buffer_load_dwordx4 v5,s[4:7],s71 offen offset:3072 nt lds
s_waitcnt lgkmcnt(8)
s_add_u32 s71,s98,0
s_add_u32 m0,s82,0x1060
s_nop 0
buffer_load_dwordx4 v5,s[8:11],s71 offen offset:0 nt lds
s_cmp_ge_i32 s85,3
s_cbranch_scc0 Lw_194
v_max3_f32 v38,v44,v45,v46
v_max3_f32 v38,v38,v47,v48
v_max3_f32 v38,v38,v49,v50
v_max_f32 v38,v38,v51
s_nop 1
v_max_f32_dpp v38,v38,v38 row_ror:4 row_mask:15 bank_mask:15
s_nop 1
v_max_f32_dpp v38,v38,v38 row_ror:8 row_mask:15 bank_mask:15
v_mov_b32 v37,v38
s_nop 1
v_permlane16_swap_b32 v38,v37
v_max_f32 v38,v38,v37
v_mov_b32 v37,v38
s_nop 1
v_permlane32_swap_b32 v38,v37
v_max_f32 v38,v38,v37
v_mul_f32 v38,s74,v38
v_fma_f32 v44,v44,s74,-v38
v_fma_f32 v45,v45,s74,-v38
v_fma_f32 v46,v46,s74,-v38
v_fma_f32 v47,v47,s74,-v38
v_fma_f32 v48,v48,s74,-v38
v_fma_f32 v49,v49,s74,-v38
v_fma_f32 v50,v50,s74,-v38
v_fma_f32 v51,v51,s74,-v38
v_exp_f32 v44,v44
v_exp_f32 v45,v45
v_exp_f32 v46,v46
v_exp_f32 v47,v47
v_exp_f32 v48,v48
v_exp_f32 v49,v49
v_exp_f32 v50,v50
v_exp_f32 v51,v51
v_cvt_pk_bf16_f32 v52,v44,v45
v_cvt_pk_bf16_f32 v53,v46,v47
v_cvt_pk_bf16_f32 v54,v48,v49
v_cvt_pk_bf16_f32 v55,v50,v51
Lw_194:
s_add_u32 m0,s82,0x1080
s_nop 0
buffer_load_dwordx4 v5,s[8:11],s71 offen offset:1024 nt lds
s_waitcnt vmcnt(13)
ds_read_b128 a[96:99],v8 offset:16768
ds_read_b128 a[100:103],v9 offset:16768
ds_read_b128 a[104:107],v10 offset:16768
ds_read_b128 a[108:111],v11 offset:16768
s_add_u32 m0,s82,0x10a0
s_nop 0
buffer_load_dwordx4 v5,s[8:11],s71 offen offset:2048 nt lds
s_cmp_eq_u32 s85,1
s_cbranch_scc1 Lf_195
L_back0:
s_cmp_ge_i32 s85,3
s_cbranch_scc0 Lw_197
v_mov_b32_dpp v20,v52 quad_perm:[0,1,2,3] row_mask:0xf bank_mask:0x1
v_mov_b32_dpp v21,v53 quad_perm:[0,1,2,3] row_mask:0xf bank_mask:0x1
v_mov_b32_dpp v22,v52 row_shl:4 row_mask:0xf bank_mask:0x1
v_mov_b32_dpp v23,v53 row_shl:4 row_mask:0xf bank_mask:0x1
s_nop 1
v_mfma_f32_16x16x32_bf16 v[56:59],v[16:19],v[20:23],0
v_mov_b32_dpp v24,v52 row_shr:4 row_mask:0xf bank_mask:0x2
v_mov_b32_dpp v25,v53 row_shr:4 row_mask:0xf bank_mask:0x2
v_mfma_f32_16x16x32_bf16 v[44:47],v[96:99],v[20:23],0
v_mov_b32_dpp v26,v52 quad_perm:[0,1,2,3] row_mask:0xf bank_mask:0x2
v_mov_b32_dpp v27,v53 quad_perm:[0,1,2,3] row_mask:0xf bank_mask:0x2
v_mfma_f32_16x16x32_bf16 v[48:51],v[112:115],v[20:23],0
v_mov_b32_dpp v28,v52 row_shr:8 row_mask:0xf bank_mask:0x4
v_mov_b32_dpp v29,v53 row_shr:8 row_mask:0xf bank_mask:0x4
v_mfma_f32_16x16x32_bf16 v[44:47],v[100:103],v[24:27],v[44:47]
v_mov_b32_dpp v30,v52 row_shr:4 row_mask:0xf bank_mask:0x4
v_mov_b32_dpp v31,v53 row_shr:4 row_mask:0xf bank_mask:0x4
v_mfma_f32_16x16x32_bf16 v[48:51],v[116:119],v[24:27],v[48:51]
v_mov_b32_dpp v32,v52 row_shr:12 row_mask:0xf bank_mask:0x8
v_mov_b32_dpp v33,v53 row_shr:12 row_mask:0xf bank_mask:0x8
v_mfma_f32_16x16x32_bf16 v[44:47],v[104:107],v[28:31],v[44:47]
v_mov_b32_dpp v34,v52 row_shr:8 row_mask:0xf bank_mask:0x8
v_mov_b32_dpp v35,v53 row_shr:8 row_mask:0xf bank_mask:0x8
v_mfma_f32_16x16x32_bf16 v[48:51],v[120:123],v[28:31],v[48:51]
v_mov_b32_dpp v20,v52 row_shl:8 row_mask:0xf bank_mask:0x1
v_mov_b32_dpp v21,v53 row_shl:8 row_mask:0xf bank_mask:0x1
v_mfma_f32_16x16x32_bf16 v[44:47],v[108:111],v[32:35],v[44:47]
v_mov_b32_dpp v22,v52 row_shl:12 row_mask:0xf bank_mask:0x1
v_mov_b32_dpp v23,v53 row_shl:12 row_mask:0xf bank_mask:0x1
v_mfma_f32_16x16x32_bf16 v[48:51],v[124:127],v[32:35],v[48:51]
Lw_197:
s_add_u32 m0,s82,0x10c0
s_nop 0
buffer_load_dwordx4 v5,s[8:11],s71 offen offset:3072 nt lds
s_waitcnt lgkmcnt(8)
s_add_u32 s71,s98,0x1000
s_add_u32 m0,s82,0x20c0
s_nop 0
buffer_load_dwordx4 v5,s[8:11],s71 offen offset:0 nt lds
s_cmp_ge_i32 s85,3
s_cbranch_scc0 Lw_198
v_mfma_f32_16x16x32_bf16 v[56:59],v[16:19],v[20:23],v[56:59]
v_mov_b32_dpp v24,v52 row_shl:4 row_mask:0xf bank_mask:0x2
v_mov_b32_dpp v25,v53 row_shl:4 row_mask:0xf bank_mask:0x2
v_mfma_f32_16x16x32_bf16 v[44:47],v[128:131],v[20:23],v[44:47]
v_mov_b32_dpp v26,v52 row_shl:8 row_mask:0xf bank_mask:0x2
v_mov_b32_dpp v27,v53 row_shl:8 row_mask:0xf bank_mask:0x2
v_mfma_f32_16x16x32_bf16 v[48:51],v[144:147],v[20:23],v[48:51]
v_mov_b32_dpp v28,v52 quad_perm:[0,1,2,3] row_mask:0xf bank_mask:0x4
v_mov_b32_dpp v29,v53 quad_perm:[0,1,2,3] row_mask:0xf bank_mask:0x4
v_mfma_f32_16x16x32_bf16 v[44:47],v[132:135],v[24:27],v[44:47]
v_mov_b32_dpp v30,v52 row_shl:4 row_mask:0xf bank_mask:0x4
v_mov_b32_dpp v31,v53 row_shl:4 row_mask:0xf bank_mask:0x4
v_mfma_f32_16x16x32_bf16 v[48:51],v[148:151],v[24:27],v[48:51]
v_mov_b32_dpp v32,v52 row_shr:4 row_mask:0xf bank_mask:0x8
v_mov_b32_dpp v33,v53 row_shr:4 row_mask:0xf bank_mask:0x8
v_mfma_f32_16x16x32_bf16 v[44:47],v[136:139],v[28:31],v[44:47]
v_mov_b32_dpp v34,v52 quad_perm:[0,1,2,3] row_mask:0xf bank_mask:0x8
v_mov_b32_dpp v35,v53 quad_perm:[0,1,2,3] row_mask:0xf bank_mask:0x8
v_mfma_f32_16x16x32_bf16 v[48:51],v[152:155],v[28:31],v[48:51]
v_mov_b32_dpp v20,v54 quad_perm:[0,1,2,3] row_mask:0xf bank_mask:0x1
v_mov_b32_dpp v21,v55 quad_perm:[0,1,2,3] row_mask:0xf bank_mask:0x1
v_mfma_f32_16x16x32_bf16 v[44:47],v[140:143],v[32:35],v[44:47]
v_mfma_f32_16x16x32_bf16 v[48:51],v[156:159],v[32:35],v[48:51]
Lw_198:
s_add_u32 m0,s82,0x20e0
s_nop 0
buffer_load_dwordx4 v5,s[8:11],s71 offen offset:1024 nt lds
s_cmp_ge_i32 s85,3
s_cbranch_scc0 Lw_199
ds_write_b32 v1,v38
s_waitcnt lgkmcnt(0)
s_barrier
ds_read_b32 v38,v2
v_mfma_f32_16x16x16_bf16 v[56:59],v[16:17],v[20:21],v[56:59]
v_mov_b32_dpp v24,v54 row_shr:4 row_mask:0xf bank_mask:0x2
v_mov_b32_dpp v25,v55 row_shr:4 row_mask:0xf bank_mask:0x2
v_mfma_f32_16x16x16_bf16 v[44:47],v[160:161],v[20:21],v[44:47]
v_mov_b32_dpp v28,v54 row_shr:8 row_mask:0xf bank_mask:0x4
v_mov_b32_dpp v29,v55 row_shr:8 row_mask:0xf bank_mask:0x4
v_mfma_f32_16x16x16_bf16 v[48:51],v[168:169],v[20:21],v[48:51]
v_mov_b32_dpp v32,v54 row_shr:12 row_mask:0xf bank_mask:0x8
v_mov_b32_dpp v33,v55 row_shr:12 row_mask:0xf bank_mask:0x8
v_mfma_f32_16x16x16_bf16 v[44:47],v[162:163],v[24:25],v[44:47]
v_mfma_f32_16x16x16_bf16 v[48:51],v[170:171],v[24:25],v[48:51]
v_mfma_f32_16x16x16_bf16 v[44:47],v[164:165],v[28:29],v[44:47]
s_waitcnt lgkmcnt(0)
v_max_f32_dpp v60,v38,v38 quad_perm:[1,0,3,2] row_mask:15 bank_mask:15
v_mfma_f32_16x16x16_bf16 v[48:51],v[172:173],v[28:29],v[48:51]
v_mfma_f32_16x16x16_bf16 v[44:47],v[166:167],v[32:33],v[44:47]
v_max_f32_dpp v60,v60,v60 quad_perm:[2,3,0,1] row_mask:15 bank_mask:15
v_sub_f32 v61,v38,v60
v_mfma_f32_16x16x16_bf16 v[48:51],v[174:175],v[32:33],v[48:51]
v_exp_f32 v61,v61
Lw_199:
s_waitcnt vmcnt(11)
ds_read_b128 a[112:115],v8 offset:0
ds_read_b128 a[116:119],v9 offset:0
ds_read_b128 a[120:123],v10 offset:0
ds_read_b128 a[124:127],v11 offset:0
s_add_u32 m0,s82,0x2100
s_nop 0
buffer_load_dwordx4 v5,s[8:11],s71 offen offset:2048 nt lds
s_add_u32 m0,s82,0x2120
s_nop 0
buffer_load_dwordx4 v5,s[8:11],s71 offen offset:3072 nt lds
s_waitcnt lgkmcnt(8)
s_add_u32 s71,s98,0x2000
s_add_u32 m0,s82,0x3120
s_nop 0
buffer_load_dwordx4 v5,s[8:11],s71 offen offset:0 nt lds
s_cmp_ge_i32 s85,3
s_cbranch_scc0 Lw_200
s_mov_b32 exec_lo,0xf000f
s_mov_b32 exec_hi,0xf000f
ds_write_b32 v1,v56 offset:4
s_mov_b64 exec,-1
ds_write_b128 v7,v[44:47] offset:0
ds_write_b128 v7,v[48:51] offset:16
s_waitcnt lgkmcnt(0)
s_barrier
ds_read_b32 v39,v2 offset:4
ds_read_b64 v[44:45],v0 offset:0
ds_read_b64 v[46:47],v0 offset:2112
ds_read_b64 v[48:49],v0 offset:4224
ds_read_b64 v[50:51],v0 offset:6336
s_waitcnt lgkmcnt(4)
v_mul_f32 v58,v61,v39
s_waitcnt lgkmcnt(0)
v_mul_f32_dpp v52,v61,v44 quad_perm:[0,0,0,0] row_mask:15 bank_mask:15
v_mul_f32_dpp v53,v61,v45 quad_perm:[0,0,0,0] row_mask:15 bank_mask:15
v_add_f32_dpp v58,v58,v58 quad_perm:[1,0,3,2] row_mask:15 bank_mask:15
v_fmac_f32_dpp v52,v61,v46 quad_perm:[1,1,1,1] row_mask:15 bank_mask:15
v_fmac_f32_dpp v53,v61,v47 quad_perm:[1,1,1,1] row_mask:15 bank_mask:15
v_add_f32_dpp v58,v58,v58 quad_perm:[2,3,0,1] row_mask:15 bank_mask:15
v_rcp_f32 v38,v58
v_log_f32 v58,v58
v_fmac_f32_dpp v52,v61,v48 quad_perm:[2,2,2,2] row_mask:15 bank_mask:15
v_fmac_f32_dpp v53,v61,v49 quad_perm:[2,2,2,2] row_mask:15 bank_mask:15
v_fmac_f32_dpp v52,v61,v50 quad_perm:[3,3,3,3] row_mask:15 bank_mask:15
v_fmac_f32_dpp v53,v61,v51 quad_perm:[3,3,3,3] row_mask:15 bank_mask:15
v_add_f32 v60,v60,v58
v_mul_f32 v52,v52,v38
v_mul_f32 v53,v53,v38
v_cvt_pk_bf16_f32 v52,v52,v53
Lw_200:
s_cmp_ge_i32 s85,3
s_cselect_b32 s94,s54,s96
s_add_u32 s95,s94,s76
s_cmp_lg_u32 s69,0
s_cbranch_scc0 Ls_201
buffer_store_dword v52,v36,s[12:15],s94 offen
s_mov_b32 exec_lo,1
s_mov_b32 exec_hi,0
buffer_store_dword v60,v3,s[12:15],s95 offen
Ls_202:
s_mov_b64 exec,-1
s_add_u32 m0,s82,0x3140
s_nop 0
buffer_load_dwordx4 v5,s[8:11],s71 offen offset:1024 nt lds
s_waitcnt vmcnt(12)
s_add_u32 m0,s82,0x3160
s_nop 0
buffer_load_dwordx4 v5,s[8:11],s71 offen offset:2048 nt lds
s_add_u32 m0,s82,0x3180
s_nop 0
buffer_load_dwordx4 v5,s[8:11],s71 offen offset:3072 nt lds
s_cmp_eq_u32 s85,8
s_cbranch_scc1 L_exit2
s_cmp_eq_u32 s85,1
s_cbranch_scc1 Lg_203
Lg_204:
s_cmp_ge_i32 s85,1
s_cbranch_scc0 Lw_207
Lc_208:
v_cmp_u_f32 vcc,v40,v41
s_cbranch_vccnz Lr_210
v_cmp_u_f32 vcc,v42,v43
s_cbranch_vccnz Lr_210
Lo_209:
ds_write_b128 v4,v[40:43]
ds_read_b128 v[20:23],v6 offset:0
ds_read_b128 v[24:27],v6 offset:64
ds_read_b128 v[28:31],v6 offset:128
ds_read_b128 v[32:35],v6 offset:192
ds_read_b128 v[160:163],v8 offset:29344
ds_read_b128 v[164:167],v9 offset:29344
ds_read_b128 v[168:171],v10 offset:29344
ds_read_b128 v[172:175],v11 offset:29344
s_waitcnt lgkmcnt(4)
v_mfma_f32_16x16x32_bf16 v[44:47],a[64:67],v[20:23],0
v_mfma_f32_16x16x32_bf16 v[44:47],a[68:71],v[24:27],v[44:47]
v_mfma_f32_16x16x32_bf16 v[44:47],a[72:75],v[28:31],v[44:47]
v_mfma_f32_16x16x32_bf16 v[44:47],a[76:79],v[32:35],v[44:47]
v_mfma_f32_16x16x32_bf16 v[52:55],a[80:83],v[20:23],0
v_mfma_f32_16x16x32_bf16 v[52:55],a[84:87],v[24:27],v[52:55]
v_mfma_f32_16x16x32_bf16 v[52:55],a[88:91],v[28:31],v[52:55]
v_mfma_f32_16x16x32_bf16 v[52:55],a[92:95],v[32:35],v[52:55]
s_waitcnt lgkmcnt(8)
v_mfma_f32_16x16x32_bf16 v[40:43],a[96:99],v[20:23],0
v_mfma_f32_16x16x32_bf16 v[40:43],a[100:103],v[24:27],v[40:43]
v_mfma_f32_16x16x32_bf16 v[40:43],a[104:107],v[28:31],v[40:43]
v_mfma_f32_16x16x32_bf16 v[40:43],a[108:111],v[32:35],v[40:43]
s_waitcnt lgkmcnt(4)
v_mfma_f32_16x16x32_bf16 v[56:59],a[112:115],v[20:23],0
v_mfma_f32_16x16x32_bf16 v[56:59],a[116:119],v[24:27],v[56:59]
v_mfma_f32_16x16x32_bf16 v[56:59],a[120:123],v[28:31],v[56:59]
v_mfma_f32_16x16x32_bf16 v[56:59],a[124:127],v[32:35],v[56:59]
v_mov_b32_dpp v44,v52 quad_perm:[0,1,2,3] row_mask:0xf bank_mask:0x2
v_mov_b32_dpp v45,v53 quad_perm:[0,1,2,3] row_mask:0xf bank_mask:0x2
s_waitcnt lgkmcnt(0)
v_mfma_f32_16x16x32_bf16 v[48:51],v[160:163],v[20:23],0
v_mov_b32_dpp v46,v54 quad_perm:[0,1,2,3] row_mask:0xf bank_mask:0x2
v_mov_b32_dpp v47,v55 quad_perm:[0,1,2,3] row_mask:0xf bank_mask:0x2
v_mfma_f32_16x16x32_bf16 v[48:51],v[164:167],v[24:27],v[48:51]
v_mov_b32_dpp v44,v40 quad_perm:[0,1,2,3] row_mask:0xf bank_mask:0x4
v_mov_b32_dpp v45,v41 quad_perm:[0,1,2,3] row_mask:0xf bank_mask:0x4
v_mfma_f32_16x16x32_bf16 v[48:51],v[168:171],v[28:31],v[48:51]
v_mov_b32_dpp v46,v42 quad_perm:[0,1,2,3] row_mask:0xf bank_mask:0x4
v_mov_b32_dpp v47,v43 quad_perm:[0,1,2,3] row_mask:0xf bank_mask:0x4
v_mfma_f32_16x16x32_bf16 v[48:51],v[172:175],v[32:35],v[48:51]
v_mov_b32_dpp v44,v56 quad_perm:[0,1,2,3] row_mask:0xf bank_mask:0x8
v_mov_b32_dpp v45,v57 quad_perm:[0,1,2,3] row_mask:0xf bank_mask:0x8
v_mov_b32_dpp v46,v58 quad_perm:[0,1,2,3] row_mask:0xf bank_mask:0x8
v_mov_b32_dpp v47,v59 quad_perm:[0,1,2,3] row_mask:0xf bank_mask:0x8
v_mov_b64 v[20:21],0
v_mov_b64 v[22:23],0
v_mov_b64 v[24:25],0
v_mov_b64 v[26:27],0
v_mov_b64 v[28:29],0
v_mov_b64 v[30:31],0
v_mov_b64 v[32:33],0
v_mov_b64 v[34:35],0
Lw_207:
s_waitcnt lgkmcnt(4)
s_add_u32 s71,s98,0x3000
s_add_u32 m0,s82,0x4180
s_nop 0
buffer_load_dwordx4 v5,s[8:11],s71 offen offset:0 nt lds
s_add_u32 m0,s82,0x41a0
s_nop 0
buffer_load_dwordx4 v5,s[8:11],s71 offen offset:1024 nt lds
s_waitcnt vmcnt(12)
ds_read_b64_tr_b16 v[96:97],v12 offset:4192
ds_read_b64_tr_b16 v[100:101],v12 offset:4224
ds_read_b64_tr_b16 v[104:105],v13 offset:4192
ds_read_b64_tr_b16 v[108:109],v13 offset:4224
ds_read_b64_tr_b16 v[112:113],v14 offset:4192
ds_read_b64_tr_b16 v[116:117],v14 offset:4224
ds_read_b64_tr_b16 v[120:121],v15 offset:4192
ds_read_b64_tr_b16 v[124:125],v15 offset:4224
s_add_u32 m0,s82,0x41c0
s_nop 0
buffer_load_dwordx4 v5,s[8:11],s71 offen offset:2048 nt lds
s_add_u32 m0,s82,0x41e0
s_nop 0
buffer_load_dwordx4 v5,s[8:11],s71 offen offset:3072 nt lds
s_waitcnt lgkmcnt(8)
s_add_u32 s71,s98,0x4000
s_add_u32 m0,s82,0
s_nop 0
buffer_load_dwordx4 v5,s[8:11],s71 offen offset:0 nt lds
s_add_u32 m0,s82,32
s_nop 0
buffer_load_dwordx4 v5,s[8:11],s71 offen offset:1024 nt lds
s_cmp_ge_i32 s85,1
s_cbranch_scc0 Lw_211
v_max3_f32 v38,v44,v45,v46
v_max3_f32 v38,v38,v47,v48
v_max3_f32 v38,v38,v49,v50
v_max_f32 v38,v38,v51
s_nop 1
v_max_f32_dpp v38,v38,v38 row_ror:4 row_mask:15 bank_mask:15
s_nop 1
v_max_f32_dpp v38,v38,v38 row_ror:8 row_mask:15 bank_mask:15
v_mov_b32 v37,v38
s_nop 1
v_permlane16_swap_b32 v38,v37
v_max_f32 v38,v38,v37
v_mov_b32 v37,v38
s_nop 1
v_permlane32_swap_b32 v38,v37
v_max_f32 v38,v38,v37
v_mul_f32 v38,s74,v38
v_fma_f32 v44,v44,s74,-v38
v_fma_f32 v45,v45,s74,-v38
v_fma_f32 v46,v46,s74,-v38
v_fma_f32 v47,v47,s74,-v38
v_fma_f32 v48,v48,s74,-v38
v_fma_f32 v49,v49,s74,-v38
v_fma_f32 v50,v50,s74,-v38
v_fma_f32 v51,v51,s74,-v38
v_exp_f32 v44,v44
v_exp_f32 v45,v45
v_exp_f32 v46,v46
v_exp_f32 v47,v47
v_exp_f32 v48,v48
v_exp_f32 v49,v49
v_exp_f32 v50,v50
v_exp_f32 v51,v51
v_cvt_pk_bf16_f32 v40,v44,v45
v_cvt_pk_bf16_f32 v41,v46,v47
v_cvt_pk_bf16_f32 v42,v48,v49
v_cvt_pk_bf16_f32 v43,v50,v51
Lw_211:
s_waitcnt vmcnt(12)
ds_read_b64_tr_b16 v[98:99],v12 offset:8384
ds_read_b64_tr_b16 v[102:103],v12 offset:8416
ds_read_b64_tr_b16 v[106:107],v13 offset:8384
ds_read_b64_tr_b16 v[110:111],v13 offset:8416
ds_read_b64_tr_b16 v[114:115],v14 offset:8384
ds_read_b64_tr_b16 v[118:119],v14 offset:8416
ds_read_b64_tr_b16 v[122:123],v15 offset:8384
ds_read_b64_tr_b16 v[126:127],v15 offset:8416
s_add_u32 m0,s82,64
s_nop 0
buffer_load_dwordx4 v5,s[8:11],s71 offen offset:2048 nt lds
s_add_u32 m0,s82,0x60
s_nop 0
buffer_load_dwordx4 v5,s[8:11],s71 offen offset:3072 nt lds
s_cmp_ge_i32 s85,1
s_cbranch_scc0 Lw_212
v_mov_b32_dpp v20,v40 quad_perm:[0,1,2,3] row_mask:0xf bank_mask:0x1
v_mov_b32_dpp v21,v41 quad_perm:[0,1,2,3] row_mask:0xf bank_mask:0x1
v_mov_b32_dpp v22,v40 row_shl:4 row_mask:0xf bank_mask:0x1
v_mov_b32_dpp v23,v41 row_shl:4 row_mask:0xf bank_mask:0x1
s_waitcnt lgkmcnt(8)
s_waitcnt lgkmcnt(0)
v_mfma_f32_16x16x32_bf16 v[52:55],v[16:19],v[20:23],0
v_mov_b32_dpp v24,v40 row_shr:4 row_mask:0xf bank_mask:0x2
v_mov_b32_dpp v25,v41 row_shr:4 row_mask:0xf bank_mask:0x2
v_mfma_f32_16x16x32_bf16 v[44:47],v[96:99],v[20:23],0
v_mov_b32_dpp v26,v40 quad_perm:[0,1,2,3] row_mask:0xf bank_mask:0x2
v_mov_b32_dpp v27,v41 quad_perm:[0,1,2,3] row_mask:0xf bank_mask:0x2
v_mfma_f32_16x16x32_bf16 v[48:51],v[112:115],v[20:23],0
v_mov_b32_dpp v28,v40 row_shr:8 row_mask:0xf bank_mask:0x4
v_mov_b32_dpp v29,v41 row_shr:8 row_mask:0xf bank_mask:0x4
v_mfma_f32_16x16x32_bf16 v[44:47],v[100:103],v[24:27],v[44:47]
v_mov_b32_dpp v30,v40 row_shr:4 row_mask:0xf bank_mask:0x4
v_mov_b32_dpp v31,v41 row_shr:4 row_mask:0xf bank_mask:0x4
v_mfma_f32_16x16x32_bf16 v[48:51],v[116:119],v[24:27],v[48:51]
v_mov_b32_dpp v32,v40 row_shr:12 row_mask:0xf bank_mask:0x8
v_mov_b32_dpp v33,v41 row_shr:12 row_mask:0xf bank_mask:0x8
v_mfma_f32_16x16x32_bf16 v[44:47],v[104:107],v[28:31],v[44:47]
v_mov_b32_dpp v34,v40 row_shr:8 row_mask:0xf bank_mask:0x8
v_mov_b32_dpp v35,v41 row_shr:8 row_mask:0xf bank_mask:0x8
v_mfma_f32_16x16x32_bf16 v[48:51],v[120:123],v[28:31],v[48:51]
s_nop 0
v_mfma_f32_16x16x32_bf16 v[44:47],v[108:111],v[32:35],v[44:47]
v_mfma_f32_16x16x32_bf16 v[48:51],v[124:127],v[32:35],v[48:51]
Lw_212:
L_cut2:
s_add_u32 s85,s85,1
s_lshl_b32 s98,s85,24
s_add_u32 s98,s98,s46
s_waitcnt lgkmcnt(8)
s_add_u32 s71,s98,0
s_add_u32 m0,s82,0x1060
s_nop 0
buffer_load_dwordx4 v5,s[4:7],s71 offen offset:0 nt lds
s_add_u32 m0,s82,0x1080
s_nop 0
buffer_load_dwordx4 v5,s[4:7],s71 offen offset:1024 nt lds
s_waitcnt vmcnt(11)
s_waitcnt vmcnt(10)
ds_read_b64_tr_b16 v[128:129],v12 offset:12576
ds_read_b64_tr_b16 v[132:133],v12 offset:12608
ds_read_b64_tr_b16 v[136:137],v13 offset:12576
ds_read_b64_tr_b16 v[140:141],v13 offset:12608
ds_read_b64_tr_b16 v[144:145],v14 offset:12576
ds_read_b64_tr_b16 v[148:149],v14 offset:12608
ds_read_b64_tr_b16 v[152:153],v15 offset:12576
ds_read_b64_tr_b16 v[156:157],v15 offset:12608
s_add_u32 m0,s82,0x10a0
s_nop 0
buffer_load_dwordx4 v5,s[4:7],s71 offen offset:2048 nt lds
s_add_u32 m0,s82,0x10c0
s_nop 0
buffer_load_dwordx4 v5,s[4:7],s71 offen offset:3072 nt lds
s_waitcnt vmcnt(11)
s_waitcnt lgkmcnt(8)
s_add_u32 s71,s98,0x1000
s_add_u32 m0,s82,0x20c0
s_nop 0
buffer_load_dwordx4 v5,s[4:7],s71 offen offset:0 nt lds
s_waitcnt vmcnt(11)
s_add_u32 m0,s82,0x20e0
s_nop 0
buffer_load_dwordx4 v5,s[4:7],s71 offen offset:1024 nt lds
s_waitcnt vmcnt(11)
s_waitcnt vmcnt(10)
ds_read_b64_tr_b16 v[130:131],v12 offset:16768
ds_read_b64_tr_b16 v[134:135],v12 offset:16800
ds_read_b64_tr_b16 v[138:139],v13 offset:16768
ds_read_b64_tr_b16 v[142:143],v13 offset:16800
ds_read_b64_tr_b16 v[146:147],v14 offset:16768
ds_read_b64_tr_b16 v[150:151],v14 offset:16800
ds_read_b64_tr_b16 v[154:155],v15 offset:16768
ds_read_b64_tr_b16 v[158:159],v15 offset:16800
s_add_u32 m0,s82,0x2100
s_nop 0
buffer_load_dwordx4 v5,s[4:7],s71 offen offset:2048 nt lds
s_cmp_ge_i32 s85,2
s_cbranch_scc0 Lw_213
v_mov_b32_dpp v20,v40 row_shl:8 row_mask:0xf bank_mask:0x1
v_mov_b32_dpp v21,v41 row_shl:8 row_mask:0xf bank_mask:0x1
v_mov_b32_dpp v22,v40 row_shl:12 row_mask:0xf bank_mask:0x1
v_mov_b32_dpp v23,v41 row_shl:12 row_mask:0xf bank_mask:0x1
s_waitcnt lgkmcnt(8)
s_waitcnt lgkmcnt(0)
v_mfma_f32_16x16x32_bf16 v[52:55],v[16:19],v[20:23],v[52:55]
v_mov_b32_dpp v24,v40 row_shl:4 row_mask:0xf bank_mask:0x2
v_mov_b32_dpp v25,v41 row_shl:4 row_mask:0xf bank_mask:0x2
v_mfma_f32_16x16x32_bf16 v[44:47],v[128:131],v[20:23],v[44:47]
v_mov_b32_dpp v26,v40 row_shl:8 row_mask:0xf bank_mask:0x2
v_mov_b32_dpp v27,v41 row_shl:8 row_mask:0xf bank_mask:0x2
v_mfma_f32_16x16x32_bf16 v[48:51],v[144:147],v[20:23],v[48:51]
v_mov_b32_dpp v28,v40 quad_perm:[0,1,2,3] row_mask:0xf bank_mask:0x4
v_mov_b32_dpp v29,v41 quad_perm:[0,1,2,3] row_mask:0xf bank_mask:0x4
v_mfma_f32_16x16x32_bf16 v[44:47],v[132:135],v[24:27],v[44:47]
v_mov_b32_dpp v30,v40 row_shl:4 row_mask:0xf bank_mask:0x4
v_mov_b32_dpp v31,v41 row_shl:4 row_mask:0xf bank_mask:0x4
v_mfma_f32_16x16x32_bf16 v[48:51],v[148:151],v[24:27],v[48:51]
v_mov_b32_dpp v32,v40 row_shr:4 row_mask:0xf bank_mask:0x8
v_mov_b32_dpp v33,v41 row_shr:4 row_mask:0xf bank_mask:0x8
v_mfma_f32_16x16x32_bf16 v[44:47],v[136:139],v[28:31],v[44:47]
v_mov_b32_dpp v34,v40 quad_perm:[0,1,2,3] row_mask:0xf bank_mask:0x8
v_mov_b32_dpp v35,v41 quad_perm:[0,1,2,3] row_mask:0xf bank_mask:0x8
v_mfma_f32_16x16x32_bf16 v[48:51],v[152:155],v[28:31],v[48:51]
s_nop 0
v_mfma_f32_16x16x32_bf16 v[44:47],v[140:143],v[32:35],v[44:47]
v_mfma_f32_16x16x32_bf16 v[48:51],v[156:159],v[32:35],v[48:51]
Lw_213:
s_add_u32 m0,s82,0x2120
s_nop 0
buffer_load_dwordx4 v5,s[4:7],s71 offen offset:3072 nt lds
s_waitcnt vmcnt(11)
s_waitcnt lgkmcnt(8)
s_add_u32 s71,s98,0x2000
s_add_u32 m0,s82,0x3120
s_nop 0
buffer_load_dwordx4 v5,s[4:7],s71 offen offset:0 nt lds
s_sub_u32 s49,s85,3
s_lshl_b32 s49,s49,13
s_add_u32 s49,s49,0x10000
s_add_u32 s49,s49,s80
s_cmp_ge_i32 s85,3
s_cselect_b32 s49,s49,s96
buffer_load_dwordx4 v[56:59],v3,s[12:15],s49 offen offset:0 sc1
s_waitcnt vmcnt(12)
s_add_u32 m0,s82,0x3140
s_nop 0
buffer_load_dwordx4 v5,s[4:7],s71 offen offset:1024 nt lds
s_waitcnt vmcnt(12)
s_waitcnt vmcnt(11)
ds_read_b64_tr_b16 v[160:161],v12 offset:0
ds_read_b64_tr_b16 v[162:163],v12 offset:32
ds_read_b64_tr_b16 v[164:165],v13 offset:0
ds_read_b64_tr_b16 v[166:167],v13 offset:32
ds_read_b64_tr_b16 v[168:169],v14 offset:0
ds_read_b64_tr_b16 v[170:171],v14 offset:32
ds_read_b64_tr_b16 v[172:173],v15 offset:0
ds_read_b64_tr_b16 v[174:175],v15 offset:32
s_add_u32 m0,s82,0x3160
s_nop 0
buffer_load_dwordx4 v5,s[4:7],s71 offen offset:2048 nt lds
s_cmp_eq_u32 s85,1
s_cbranch_scc1 Lf_214
Lf_215:
s_cmp_ge_i32 s85,2
s_cbranch_scc0 Lw_218
ds_write_b32 v1,v38
s_waitcnt lgkmcnt(0)
s_barrier
ds_read_b32 v38,v2
v_mov_b32_dpp v20,v42 quad_perm:[0,1,2,3] row_mask:0xf bank_mask:0x1
v_mov_b32_dpp v21,v43 quad_perm:[0,1,2,3] row_mask:0xf bank_mask:0x1
s_waitcnt lgkmcnt(1)
s_nop 0
v_mfma_f32_16x16x16_bf16 v[52:55],v[16:17],v[20:21],v[52:55]
v_mov_b32_dpp v24,v42 row_shr:4 row_mask:0xf bank_mask:0x2
v_mov_b32_dpp v25,v43 row_shr:4 row_mask:0xf bank_mask:0x2
v_mfma_f32_16x16x16_bf16 v[44:47],v[160:161],v[20:21],v[44:47]
v_mov_b32_dpp v28,v42 row_shr:8 row_mask:0xf bank_mask:0x4
v_mov_b32_dpp v29,v43 row_shr:8 row_mask:0xf bank_mask:0x4
v_mfma_f32_16x16x16_bf16 v[48:51],v[168:169],v[20:21],v[48:51]
v_mov_b32_dpp v32,v42 row_shr:12 row_mask:0xf bank_mask:0x8
v_mov_b32_dpp v33,v43 row_shr:12 row_mask:0xf bank_mask:0x8
v_mfma_f32_16x16x16_bf16 v[44:47],v[162:163],v[24:25],v[44:47]
v_mfma_f32_16x16x16_bf16 v[48:51],v[170:171],v[24:25],v[48:51]
v_mfma_f32_16x16x16_bf16 v[44:47],v[164:165],v[28:29],v[44:47]
s_waitcnt lgkmcnt(0)
v_max_f32_dpp v60,v38,v38 quad_perm:[1,0,3,2] row_mask:15 bank_mask:15
v_mfma_f32_16x16x16_bf16 v[48:51],v[172:173],v[28:29],v[48:51]
v_mfma_f32_16x16x16_bf16 v[44:47],v[166:167],v[32:33],v[44:47]
v_max_f32_dpp v60,v60,v60 quad_perm:[2,3,0,1] row_mask:15 bank_mask:15
v_sub_f32 v61,v38,v60
v_mfma_f32_16x16x16_bf16 v[48:51],v[174:175],v[32:33],v[48:51]
v_exp_f32 v61,v61
Lw_218:
s_add_u32 m0,s82,0x3180
s_nop 0
buffer_load_dwordx4 v5,s[4:7],s71 offen offset:3072 nt lds
s_waitcnt lgkmcnt(8)
s_add_u32 s71,s98,0x3000
s_add_u32 m0,s82,0x4180
s_nop 0
buffer_load_dwordx4 v5,s[4:7],s71 offen offset:0 nt lds
s_cmp_ge_i32 s85,2
s_cbranch_scc0 Lw_219
s_mov_b32 exec_lo,0xf000f
s_mov_b32 exec_hi,0xf000f
ds_write_b32 v1,v52 offset:4
s_mov_b64 exec,-1
ds_write_b128 v7,v[44:47] offset:0
ds_write_b128 v7,v[48:51] offset:16
s_waitcnt lgkmcnt(0)
s_barrier
ds_read_b32 v39,v2 offset:4
ds_read_b64 v[44:45],v0 offset:0
ds_read_b64 v[46:47],v0 offset:2112
ds_read_b64 v[48:49],v0 offset:4224
ds_read_b64 v[50:51],v0 offset:6336
s_waitcnt lgkmcnt(4)
v_mul_f32 v54,v61,v39
s_waitcnt lgkmcnt(0)
v_mul_f32_dpp v40,v61,v44 quad_perm:[0,0,0,0] row_mask:15 bank_mask:15
v_mul_f32_dpp v41,v61,v45 quad_perm:[0,0,0,0] row_mask:15 bank_mask:15
v_add_f32_dpp v54,v54,v54 quad_perm:[1,0,3,2] row_mask:15 bank_mask:15
v_fmac_f32_dpp v40,v61,v46 quad_perm:[1,1,1,1] row_mask:15 bank_mask:15
v_fmac_f32_dpp v41,v61,v47 quad_perm:[1,1,1,1] row_mask:15 bank_mask:15
v_add_f32_dpp v54,v54,v54 quad_perm:[2,3,0,1] row_mask:15 bank_mask:15
v_rcp_f32 v38,v54
v_log_f32 v54,v54
v_fmac_f32_dpp v40,v61,v48 quad_perm:[2,2,2,2] row_mask:15 bank_mask:15
v_fmac_f32_dpp v41,v61,v49 quad_perm:[2,2,2,2] row_mask:15 bank_mask:15
v_fmac_f32_dpp v40,v61,v50 quad_perm:[3,3,3,3] row_mask:15 bank_mask:15
v_fmac_f32_dpp v41,v61,v51 quad_perm:[3,3,3,3] row_mask:15 bank_mask:15
v_add_f32 v60,v60,v54
v_mul_f32 v40,v40,v38
v_mul_f32 v41,v41,v38
v_cvt_pk_bf16_f32 v40,v40,v41
Lw_219:
s_cmp_ge_i32 s85,2
s_cselect_b32 s94,s51,s96
s_add_u32 s95,s94,s76
s_cmp_lg_u32 s69,0
s_cbranch_scc0 Ls_220
buffer_store_dword v40,v36,s[12:15],s94 offen
s_mov_b32 exec_lo,1
s_mov_b32 exec_hi,0
buffer_store_dword v60,v3,s[12:15],s95 offen
Ls_221:
s_mov_b64 exec,-1
s_add_u32 m0,s82,0x41a0
s_nop 0
buffer_load_dwordx4 v5,s[4:7],s71 offen offset:1024 nt lds
s_add_u32 m0,s82,0x41c0
s_nop 0
buffer_load_dwordx4 v5,s[4:7],s71 offen offset:2048 nt lds
s_add_u32 m0,s82,0x41e0
s_nop 0
buffer_load_dwordx4 v5,s[4:7],s71 offen offset:3072 nt lds
s_sub_u32 s48,s85,0
s_lshl_b32 s48,s48,13
s_add_u32 s48,s48,0
s_add_u32 s48,s48,s80
s_cmp_ge_i32 s85,1
s_cselect_b32 s48,s48,s96
buffer_load_dwordx4 v[40:43],v3,s[12:15],s48 offen offset:0 sc1
s_waitcnt vmcnt(10)
s_cmp_ge_i32 s85,3
s_cbranch_scc0 Lw_222
Lc_223:
v_cmp_u_f32 vcc,v56,v57
s_cbranch_vccnz Lr_225
v_cmp_u_f32 vcc,v58,v59
s_cbranch_vccnz Lr_225
Lo_224:
ds_write_b128 v4,v[56:59]
ds_read_b128 v[20:23],v6 offset:0
ds_read_b128 v[24:27],v6 offset:64
ds_read_b128 v[28:31],v6 offset:128
ds_read_b128 v[32:35],v6 offset:192
s_waitcnt lgkmcnt(0)
v_mfma_f32_16x16x32_bf16 v[44:47],a[128:131],v[20:23],0
v_mfma_f32_16x16x32_bf16 v[44:47],a[132:135],v[24:27],v[44:47]
v_mfma_f32_16x16x32_bf16 v[44:47],a[136:139],v[28:31],v[44:47]
v_mfma_f32_16x16x32_bf16 v[44:47],a[140:143],v[32:35],v[44:47]
ds_read_b128 a[128:131],v8 offset:33536
ds_read_b128 a[132:135],v9 offset:33536
ds_read_b128 a[136:139],v10 offset:33536
ds_read_b128 a[140:143],v11 offset:33536
v_mfma_f32_16x16x32_bf16 v[52:55],a[144:147],v[20:23],0
v_mfma_f32_16x16x32_bf16 v[52:55],a[148:151],v[24:27],v[52:55]
v_mfma_f32_16x16x32_bf16 v[52:55],a[152:155],v[28:31],v[52:55]
v_mfma_f32_16x16x32_bf16 v[52:55],a[156:159],v[32:35],v[52:55]
v_mfma_f32_16x16x32_bf16 v[56:59],a[160:163],v[20:23],0
v_mfma_f32_16x16x32_bf16 v[56:59],a[164:167],v[24:27],v[56:59]
v_mfma_f32_16x16x32_bf16 v[56:59],a[168:171],v[28:31],v[56:59]
v_mfma_f32_16x16x32_bf16 v[56:59],a[172:175],v[32:35],v[56:59]
v_mfma_f32_16x16x32_bf16 v[60:63],a[176:179],v[20:23],0
v_mfma_f32_16x16x32_bf16 v[60:63],a[180:183],v[24:27],v[60:63]
v_mfma_f32_16x16x32_bf16 v[60:63],a[184:187],v[28:31],v[60:63]
v_mfma_f32_16x16x32_bf16 v[60:63],a[188:191],v[32:35],v[60:63]
v_mov_b32_dpp v44,v52 quad_perm:[0,1,2,3] row_mask:0xf bank_mask:0x2
v_mov_b32_dpp v45,v53 quad_perm:[0,1,2,3] row_mask:0xf bank_mask:0x2
s_waitcnt lgkmcnt(0)
v_mfma_f32_16x16x32_bf16 v[48:51],a[128:131],v[20:23],0
v_mov_b32_dpp v46,v54 quad_perm:[0,1,2,3] row_mask:0xf bank_mask:0x2
v_mov_b32_dpp v47,v55 quad_perm:[0,1,2,3] row_mask:0xf bank_mask:0x2
v_mfma_f32_16x16x32_bf16 v[48:51],a[132:135],v[24:27],v[48:51]
v_mov_b32_dpp v44,v56 quad_perm:[0,1,2,3] row_mask:0xf bank_mask:0x4
v_mov_b32_dpp v45,v57 quad_perm:[0,1,2,3] row_mask:0xf bank_mask:0x4
v_mfma_f32_16x16x32_bf16 v[48:51],a[136:139],v[28:31],v[48:51]
v_mov_b32_dpp v46,v58 quad_perm:[0,1,2,3] row_mask:0xf bank_mask:0x4
v_mov_b32_dpp v47,v59 quad_perm:[0,1,2,3] row_mask:0xf bank_mask:0x4
v_mfma_f32_16x16x32_bf16 v[48:51],a[140:143],v[32:35],v[48:51]
v_mov_b32_dpp v44,v60 quad_perm:[0,1,2,3] row_mask:0xf bank_mask:0x8
v_mov_b32_dpp v45,v61 quad_perm:[0,1,2,3] row_mask:0xf bank_mask:0x8
v_mov_b32_dpp v46,v62 quad_perm:[0,1,2,3] row_mask:0xf bank_mask:0x8
v_mov_b32_dpp v47,v63 quad_perm:[0,1,2,3] row_mask:0xf bank_mask:0x8
v_mov_b64 v[20:21],0
v_mov_b64 v[22:23],0
v_mov_b64 v[24:25],0
v_mov_b64 v[26:27],0
v_mov_b64 v[28:29],0
v_mov_b64 v[30:31],0
v_mov_b64 v[32:33],0
v_mov_b64 v[34:35],0
Lw_222:
ds_read_b128 a[128:131],v8 offset:4192
ds_read_b128 a[132:135],v9 offset:4192
ds_read_b128 a[136:139],v10 offset:4192
ds_read_b128 a[140:143],v11 offset:4192
s_add_u32 s71,s98,0x4000
s_add_u32 m0,s82,0x8300
s_nop 0
buffer_load_dwordx4 v5,s[4:7],s71 offen offset:0 nt lds
s_add_u32 m0,s82,0x8320
s_nop 0
buffer_load_dwordx4 v5,s[4:7],s71 offen offset:1024 nt lds
ds_read_b128 a[144:147],v8 offset:8384
ds_read_b128 a[148:151],v9 offset:8384
ds_read_b128 a[152:155],v10 offset:8384
ds_read_b128 a[156:159],v11 offset:8384
s_add_u32 m0,s82,0x8340
s_nop 0
buffer_load_dwordx4 v5,s[4:7],s71 offen offset:2048 nt lds
s_add_u32 m0,s82,0x8360
s_nop 0
buffer_load_dwordx4 v5,s[4:7],s71 offen offset:3072 nt lds
s_waitcnt lgkmcnt(8)
s_add_u32 s71,s98,0
s_add_u32 m0,s82,0
s_nop 0
buffer_load_dwordx4 v5,s[8:11],s71 offen offset:0 nt lds
s_cmp_ge_i32 s85,3
s_cbranch_scc0 Lw_226
v_max3_f32 v38,v44,v45,v46
v_max3_f32 v38,v38,v47,v48
v_max3_f32 v38,v38,v49,v50
v_max_f32 v38,v38,v51
s_nop 1
v_max_f32_dpp v38,v38,v38 row_ror:4 row_mask:15 bank_mask:15
s_nop 1
v_max_f32_dpp v38,v38,v38 row_ror:8 row_mask:15 bank_mask:15
v_mov_b32 v37,v38
s_nop 1
v_permlane16_swap_b32 v38,v37
v_max_f32 v38,v38,v37
v_mov_b32 v37,v38
s_nop 1
v_permlane32_swap_b32 v38,v37
v_max_f32 v38,v38,v37
v_mul_f32 v38,s74,v38
v_fma_f32 v44,v44,s74,-v38
v_fma_f32 v45,v45,s74,-v38
v_fma_f32 v46,v46,s74,-v38
v_fma_f32 v47,v47,s74,-v38
v_fma_f32 v48,v48,s74,-v38
v_fma_f32 v49,v49,s74,-v38
v_fma_f32 v50,v50,s74,-v38
v_fma_f32 v51,v51,s74,-v38
v_exp_f32 v44,v44
v_exp_f32 v45,v45
v_exp_f32 v46,v46
v_exp_f32 v47,v47
v_exp_f32 v48,v48
v_exp_f32 v49,v49
v_exp_f32 v50,v50
v_exp_f32 v51,v51
v_cvt_pk_bf16_f32 v52,v44,v45
v_cvt_pk_bf16_f32 v53,v46,v47
v_cvt_pk_bf16_f32 v54,v48,v49
v_cvt_pk_bf16_f32 v55,v50,v51
Lw_226:
s_add_u32 m0,s82,32
s_nop 0
buffer_load_dwordx4 v5,s[8:11],s71 offen offset:1024 nt lds
s_waitcnt vmcnt(13)
ds_read_b128 a[160:163],v8 offset:12576
ds_read_b128 a[164:167],v9 offset:12576
ds_read_b128 a[168:171],v10 offset:12576
ds_read_b128 a[172:175],v11 offset:12576
s_add_u32 m0,s82,64
s_nop 0
buffer_load_dwordx4 v5,s[8:11],s71 offen offset:2048 nt lds
s_cmp_eq_u32 s85,1
s_cbranch_scc1 Lf_227
L_back1:
s_cmp_ge_i32 s85,3
s_cbranch_scc0 Lw_229
v_mov_b32_dpp v20,v52 quad_perm:[0,1,2,3] row_mask:0xf bank_mask:0x1
v_mov_b32_dpp v21,v53 quad_perm:[0,1,2,3] row_mask:0xf bank_mask:0x1
v_mov_b32_dpp v22,v52 row_shl:4 row_mask:0xf bank_mask:0x1
v_mov_b32_dpp v23,v53 row_shl:4 row_mask:0xf bank_mask:0x1
s_nop 1
v_mfma_f32_16x16x32_bf16 v[56:59],v[16:19],v[20:23],0
v_mov_b32_dpp v24,v52 row_shr:4 row_mask:0xf bank_mask:0x2
v_mov_b32_dpp v25,v53 row_shr:4 row_mask:0xf bank_mask:0x2
v_mfma_f32_16x16x32_bf16 v[44:47],v[176:179],v[20:23],0
v_mov_b32_dpp v26,v52 quad_perm:[0,1,2,3] row_mask:0xf bank_mask:0x2
v_mov_b32_dpp v27,v53 quad_perm:[0,1,2,3] row_mask:0xf bank_mask:0x2
v_mfma_f32_16x16x32_bf16 v[48:51],v[192:195],v[20:23],0
v_mov_b32_dpp v28,v52 row_shr:8 row_mask:0xf bank_mask:0x4
v_mov_b32_dpp v29,v53 row_shr:8 row_mask:0xf bank_mask:0x4
v_mfma_f32_16x16x32_bf16 v[44:47],v[180:183],v[24:27],v[44:47]
v_mov_b32_dpp v30,v52 row_shr:4 row_mask:0xf bank_mask:0x4
v_mov_b32_dpp v31,v53 row_shr:4 row_mask:0xf bank_mask:0x4
v_mfma_f32_16x16x32_bf16 v[48:51],v[196:199],v[24:27],v[48:51]
v_mov_b32_dpp v32,v52 row_shr:12 row_mask:0xf bank_mask:0x8
v_mov_b32_dpp v33,v53 row_shr:12 row_mask:0xf bank_mask:0x8
v_mfma_f32_16x16x32_bf16 v[44:47],v[184:187],v[28:31],v[44:47]
v_mov_b32_dpp v34,v52 row_shr:8 row_mask:0xf bank_mask:0x8
v_mov_b32_dpp v35,v53 row_shr:8 row_mask:0xf bank_mask:0x8
v_mfma_f32_16x16x32_bf16 v[48:51],v[200:203],v[28:31],v[48:51]
v_mov_b32_dpp v20,v52 row_shl:8 row_mask:0xf bank_mask:0x1
v_mov_b32_dpp v21,v53 row_shl:8 row_mask:0xf bank_mask:0x1
v_mfma_f32_16x16x32_bf16 v[44:47],v[188:191],v[32:35],v[44:47]
v_mov_b32_dpp v22,v52 row_shl:12 row_mask:0xf bank_mask:0x1
v_mov_b32_dpp v23,v53 row_shl:12 row_mask:0xf bank_mask:0x1
v_mfma_f32_16x16x32_bf16 v[48:51],v[204:207],v[32:35],v[48:51]
Lw_229:
s_add_u32 m0,s82,0x60
s_nop 0
buffer_load_dwordx4 v5,s[8:11],s71 offen offset:3072 nt lds
s_cmp_ge_i32 s85,3
s_cbranch_scc0 Lw_230
v_mfma_f32_16x16x32_bf16 v[56:59],v[16:19],v[20:23],v[56:59]
v_mov_b32_dpp v24,v52 row_shl:4 row_mask:0xf bank_mask:0x2
v_mov_b32_dpp v25,v53 row_shl:4 row_mask:0xf bank_mask:0x2
v_mfma_f32_16x16x32_bf16 v[44:47],v[208:211],v[20:23],v[44:47]
v_mov_b32_dpp v26,v52 row_shl:8 row_mask:0xf bank_mask:0x2
v_mov_b32_dpp v27,v53 row_shl:8 row_mask:0xf bank_mask:0x2
v_mfma_f32_16x16x32_bf16 v[48:51],v[224:227],v[20:23],v[48:51]
v_mov_b32_dpp v28,v52 quad_perm:[0,1,2,3] row_mask:0xf bank_mask:0x4
v_mov_b32_dpp v29,v53 quad_perm:[0,1,2,3] row_mask:0xf bank_mask:0x4
v_mfma_f32_16x16x32_bf16 v[44:47],v[212:215],v[24:27],v[44:47]
v_mov_b32_dpp v30,v52 row_shl:4 row_mask:0xf bank_mask:0x4
v_mov_b32_dpp v31,v53 row_shl:4 row_mask:0xf bank_mask:0x4
v_mfma_f32_16x16x32_bf16 v[48:51],v[228:231],v[24:27],v[48:51]
v_mov_b32_dpp v32,v52 row_shr:4 row_mask:0xf bank_mask:0x8
v_mov_b32_dpp v33,v53 row_shr:4 row_mask:0xf bank_mask:0x8
v_mfma_f32_16x16x32_bf16 v[44:47],v[216:219],v[28:31],v[44:47]
v_mov_b32_dpp v34,v52 quad_perm:[0,1,2,3] row_mask:0xf bank_mask:0x8
v_mov_b32_dpp v35,v53 quad_perm:[0,1,2,3] row_mask:0xf bank_mask:0x8
v_mfma_f32_16x16x32_bf16 v[48:51],v[232:235],v[28:31],v[48:51]
v_mov_b32_dpp v20,v54 quad_perm:[0,1,2,3] row_mask:0xf bank_mask:0x1
v_mov_b32_dpp v21,v55 quad_perm:[0,1,2,3] row_mask:0xf bank_mask:0x1
v_mfma_f32_16x16x32_bf16 v[44:47],v[220:223],v[32:35],v[44:47]
v_mfma_f32_16x16x32_bf16 v[48:51],v[236:239],v[32:35],v[48:51]
Lw_230:
s_waitcnt lgkmcnt(8)
s_add_u32 s71,s98,0x1000
s_add_u32 m0,s82,0x1060
s_nop 0
buffer_load_dwordx4 v5,s[8:11],s71 offen offset:0 nt lds
s_add_u32 m0,s82,0x1080
s_nop 0
buffer_load_dwordx4 v5,s[8:11],s71 offen offset:1024 nt lds
s_cmp_ge_i32 s85,3
s_cbranch_scc0 Lw_231
ds_write_b32 v1,v38
s_waitcnt lgkmcnt(0)
s_barrier
ds_read_b32 v38,v2
v_mfma_f32_16x16x16_bf16 v[56:59],v[16:17],v[20:21],v[56:59]
v_mov_b32_dpp v24,v54 row_shr:4 row_mask:0xf bank_mask:0x2
v_mov_b32_dpp v25,v55 row_shr:4 row_mask:0xf bank_mask:0x2
v_mfma_f32_16x16x16_bf16 v[44:47],v[240:241],v[20:21],v[44:47]
v_mov_b32_dpp v28,v54 row_shr:8 row_mask:0xf bank_mask:0x4
v_mov_b32_dpp v29,v55 row_shr:8 row_mask:0xf bank_mask:0x4
v_mfma_f32_16x16x16_bf16 v[48:51],v[248:249],v[20:21],v[48:51]
v_mov_b32_dpp v32,v54 row_shr:12 row_mask:0xf bank_mask:0x8
v_mov_b32_dpp v33,v55 row_shr:12 row_mask:0xf bank_mask:0x8
v_mfma_f32_16x16x16_bf16 v[44:47],v[242:243],v[24:25],v[44:47]
v_mfma_f32_16x16x16_bf16 v[48:51],v[250:251],v[24:25],v[48:51]
v_mfma_f32_16x16x16_bf16 v[44:47],v[244:245],v[28:29],v[44:47]
s_waitcnt lgkmcnt(0)
v_max_f32_dpp v60,v38,v38 quad_perm:[1,0,3,2] row_mask:15 bank_mask:15
v_mfma_f32_16x16x16_bf16 v[48:51],v[252:253],v[28:29],v[48:51]
v_mfma_f32_16x16x16_bf16 v[44:47],v[246:247],v[32:33],v[44:47]
v_max_f32_dpp v60,v60,v60 quad_perm:[2,3,0,1] row_mask:15 bank_mask:15
v_sub_f32 v61,v38,v60
v_mfma_f32_16x16x16_bf16 v[48:51],v[254:255],v[32:33],v[48:51]
v_exp_f32 v61,v61
Lw_231:
s_waitcnt vmcnt(11)
ds_read_b128 a[176:179],v8 offset:16768
ds_read_b128 a[180:183],v9 offset:16768
ds_read_b128 a[184:187],v10 offset:16768
ds_read_b128 a[188:191],v11 offset:16768
s_add_u32 m0,s82,0x10a0
s_nop 0
buffer_load_dwordx4 v5,s[8:11],s71 offen offset:2048 nt lds
s_add_u32 m0,s82,0x10c0
s_nop 0
buffer_load_dwordx4 v5,s[8:11],s71 offen offset:3072 nt lds
s_cmp_ge_i32 s85,3
s_cbranch_scc0 Lw_232
s_mov_b32 exec_lo,0xf000f
s_mov_b32 exec_hi,0xf000f
ds_write_b32 v1,v56 offset:4
s_mov_b64 exec,-1
ds_write_b128 v7,v[44:47] offset:0
ds_write_b128 v7,v[48:51] offset:16
s_waitcnt lgkmcnt(0)
s_barrier
ds_read_b32 v39,v2 offset:4
ds_read_b64 v[44:45],v0 offset:0
ds_read_b64 v[46:47],v0 offset:2112
ds_read_b64 v[48:49],v0 offset:4224
ds_read_b64 v[50:51],v0 offset:6336
s_waitcnt lgkmcnt(4)
v_mul_f32 v58,v61,v39
s_waitcnt lgkmcnt(0)
v_mul_f32_dpp v52,v61,v44 quad_perm:[0,0,0,0] row_mask:15 bank_mask:15
v_mul_f32_dpp v53,v61,v45 quad_perm:[0,0,0,0] row_mask:15 bank_mask:15
v_add_f32_dpp v58,v58,v58 quad_perm:[1,0,3,2] row_mask:15 bank_mask:15
v_fmac_f32_dpp v52,v61,v46 quad_perm:[1,1,1,1] row_mask:15 bank_mask:15
v_fmac_f32_dpp v53,v61,v47 quad_perm:[1,1,1,1] row_mask:15 bank_mask:15
v_add_f32_dpp v58,v58,v58 quad_perm:[2,3,0,1] row_mask:15 bank_mask:15
v_rcp_f32 v38,v58
v_log_f32 v58,v58
v_fmac_f32_dpp v52,v61,v48 quad_perm:[2,2,2,2] row_mask:15 bank_mask:15
v_fmac_f32_dpp v53,v61,v49 quad_perm:[2,2,2,2] row_mask:15 bank_mask:15
v_fmac_f32_dpp v52,v61,v50 quad_perm:[3,3,3,3] row_mask:15 bank_mask:15
v_fmac_f32_dpp v53,v61,v51 quad_perm:[3,3,3,3] row_mask:15 bank_mask:15
v_add_f32 v60,v60,v58
v_mul_f32 v52,v52,v38
v_mul_f32 v53,v53,v38
v_cvt_pk_bf16_f32 v52,v52,v53
Lw_232:
s_cmp_ge_i32 s85,3
s_cselect_b32 s94,s55,s96
s_add_u32 s95,s94,s76
s_cmp_lg_u32 s69,0
s_cbranch_scc0 Ls_233
buffer_store_dword v52,v36,s[12:15],s94 offen
s_mov_b32 exec_lo,1
s_mov_b32 exec_hi,0
buffer_store_dword v60,v3,s[12:15],s95 offen
Ls_234:
s_mov_b64 exec,-1
s_waitcnt lgkmcnt(8)
s_add_u32 s71,s98,0x2000
s_add_u32 m0,s82,0x20c0
s_nop 0
buffer_load_dwordx4 v5,s[8:11],s71 offen offset:0 nt lds
s_add_u32 m0,s82,0x20e0
s_nop 0
buffer_load_dwordx4 v5,s[8:11],s71 offen offset:1024 nt lds
s_waitcnt vmcnt(12)
s_add_u32 m0,s82,0x2100
s_nop 0
buffer_load_dwordx4 v5,s[8:11],s71 offen offset:2048 nt lds
s_cmp_eq_u32 s85,8
s_cbranch_scc1 L_exit0
s_cmp_eq_u32 s85,1
s_cbranch_scc1 Lg_235
Lg_236:
s_cmp_ge_i32 s85,1
s_cbranch_scc0 Lw_239
Lc_240:
v_cmp_u_f32 vcc,v40,v41
s_cbranch_vccnz Lr_242
v_cmp_u_f32 vcc,v42,v43
s_cbranch_vccnz Lr_242
Lo_241:
ds_write_b128 v4,v[40:43]
ds_read_b128 v[20:23],v6 offset:0
ds_read_b128 v[24:27],v6 offset:64
ds_read_b128 v[28:31],v6 offset:128
ds_read_b128 v[32:35],v6 offset:192
ds_read_b128 v[240:243],v8 offset:33536
ds_read_b128 v[244:247],v9 offset:33536
ds_read_b128 v[248:251],v10 offset:33536
ds_read_b128 v[252:255],v11 offset:33536
s_waitcnt lgkmcnt(4)
v_mfma_f32_16x16x32_bf16 v[44:47],a[128:131],v[20:23],0
v_mfma_f32_16x16x32_bf16 v[44:47],a[132:135],v[24:27],v[44:47]
v_mfma_f32_16x16x32_bf16 v[44:47],a[136:139],v[28:31],v[44:47]
v_mfma_f32_16x16x32_bf16 v[44:47],a[140:143],v[32:35],v[44:47]
v_mfma_f32_16x16x32_bf16 v[52:55],a[144:147],v[20:23],0
v_mfma_f32_16x16x32_bf16 v[52:55],a[148:151],v[24:27],v[52:55]
v_mfma_f32_16x16x32_bf16 v[52:55],a[152:155],v[28:31],v[52:55]
v_mfma_f32_16x16x32_bf16 v[52:55],a[156:159],v[32:35],v[52:55]
s_waitcnt lgkmcnt(8)
v_mfma_f32_16x16x32_bf16 v[40:43],a[160:163],v[20:23],0
v_mfma_f32_16x16x32_bf16 v[40:43],a[164:167],v[24:27],v[40:43]
v_mfma_f32_16x16x32_bf16 v[40:43],a[168:171],v[28:31],v[40:43]
v_mfma_f32_16x16x32_bf16 v[40:43],a[172:175],v[32:35],v[40:43]
s_waitcnt lgkmcnt(4)
v_mfma_f32_16x16x32_bf16 v[56:59],a[176:179],v[20:23],0
v_mfma_f32_16x16x32_bf16 v[56:59],a[180:183],v[24:27],v[56:59]
v_mfma_f32_16x16x32_bf16 v[56:59],a[184:187],v[28:31],v[56:59]
v_mfma_f32_16x16x32_bf16 v[56:59],a[188:191],v[32:35],v[56:59]
v_mov_b32_dpp v44,v52 quad_perm:[0,1,2,3] row_mask:0xf bank_mask:0x2
v_mov_b32_dpp v45,v53 quad_perm:[0,1,2,3] row_mask:0xf bank_mask:0x2
s_waitcnt lgkmcnt(0)
v_mfma_f32_16x16x32_bf16 v[48:51],v[240:243],v[20:23],0
v_mov_b32_dpp v46,v54 quad_perm:[0,1,2,3] row_mask:0xf bank_mask:0x2
v_mov_b32_dpp v47,v55 quad_perm:[0,1,2,3] row_mask:0xf bank_mask:0x2
v_mfma_f32_16x16x32_bf16 v[48:51],v[244:247],v[24:27],v[48:51]
v_mov_b32_dpp v44,v40 quad_perm:[0,1,2,3] row_mask:0xf bank_mask:0x4
v_mov_b32_dpp v45,v41 quad_perm:[0,1,2,3] row_mask:0xf bank_mask:0x4
v_mfma_f32_16x16x32_bf16 v[48:51],v[248:251],v[28:31],v[48:51]
v_mov_b32_dpp v46,v42 quad_perm:[0,1,2,3] row_mask:0xf bank_mask:0x4
v_mov_b32_dpp v47,v43 quad_perm:[0,1,2,3] row_mask:0xf bank_mask:0x4
v_mfma_f32_16x16x32_bf16 v[48:51],v[252:255],v[32:35],v[48:51]
v_mov_b32_dpp v44,v56 quad_perm:[0,1,2,3] row_mask:0xf bank_mask:0x8
v_mov_b32_dpp v45,v57 quad_perm:[0,1,2,3] row_mask:0xf bank_mask:0x8
v_mov_b32_dpp v46,v58 quad_perm:[0,1,2,3] row_mask:0xf bank_mask:0x8
v_mov_b32_dpp v47,v59 quad_perm:[0,1,2,3] row_mask:0xf bank_mask:0x8
v_mov_b64 v[20:21],0
v_mov_b64 v[22:23],0
v_mov_b64 v[24:25],0
v_mov_b64 v[26:27],0
v_mov_b64 v[28:29],0
v_mov_b64 v[30:31],0
v_mov_b64 v[32:33],0
v_mov_b64 v[34:35],0
Lw_239:
s_add_u32 m0,s82,0x2120
s_nop 0
buffer_load_dwordx4 v5,s[8:11],s71 offen offset:3072 nt lds
s_waitcnt lgkmcnt(4)
s_add_u32 s71,s98,0x3000
s_add_u32 m0,s82,0x3120
s_nop 0
buffer_load_dwordx4 v5,s[8:11],s71 offen offset:0 nt lds
s_add_u32 m0,s82,0x3140
s_nop 0
buffer_load_dwordx4 v5,s[8:11],s71 offen offset:1024 nt lds
s_waitcnt vmcnt(12)
ds_read_b64_tr_b16 v[176:177],v12 offset:0
ds_read_b64_tr_b16 v[180:181],v12 offset:32
ds_read_b64_tr_b16 v[184:185],v13 offset:0
ds_read_b64_tr_b16 v[188:189],v13 offset:32
ds_read_b64_tr_b16 v[192:193],v14 offset:0
ds_read_b64_tr_b16 v[196:197],v14 offset:32
ds_read_b64_tr_b16 v[200:201],v15 offset:0
ds_read_b64_tr_b16 v[204:205],v15 offset:32
s_add_u32 m0,s82,0x3160
s_nop 0
buffer_load_dwordx4 v5,s[8:11],s71 offen offset:2048 nt lds
s_add_u32 m0,s82,0x3180
s_nop 0
buffer_load_dwordx4 v5,s[8:11],s71 offen offset:3072 nt lds
s_waitcnt lgkmcnt(8)
s_add_u32 s71,s98,0x4000
s_add_u32 m0,s82,0x4180
s_nop 0
buffer_load_dwordx4 v5,s[8:11],s71 offen offset:0 nt lds
s_cmp_ge_i32 s85,1
s_cbranch_scc0 Lw_243
v_max3_f32 v38,v44,v45,v46
v_max3_f32 v38,v38,v47,v48
v_max3_f32 v38,v38,v49,v50
v_max_f32 v38,v38,v51
s_nop 1
v_max_f32_dpp v38,v38,v38 row_ror:4 row_mask:15 bank_mask:15
s_nop 1
v_max_f32_dpp v38,v38,v38 row_ror:8 row_mask:15 bank_mask:15
v_mov_b32 v37,v38
s_nop 1
v_permlane16_swap_b32 v38,v37
v_max_f32 v38,v38,v37
v_mov_b32 v37,v38
s_nop 1
v_permlane32_swap_b32 v38,v37
v_max_f32 v38,v38,v37
v_mul_f32 v38,s74,v38
v_fma_f32 v44,v44,s74,-v38
v_fma_f32 v45,v45,s74,-v38
v_fma_f32 v46,v46,s74,-v38
v_fma_f32 v47,v47,s74,-v38
v_fma_f32 v48,v48,s74,-v38
v_fma_f32 v49,v49,s74,-v38
v_fma_f32 v50,v50,s74,-v38
v_fma_f32 v51,v51,s74,-v38
v_exp_f32 v44,v44
v_exp_f32 v45,v45
v_exp_f32 v46,v46
v_exp_f32 v47,v47
v_exp_f32 v48,v48
v_exp_f32 v49,v49
v_exp_f32 v50,v50
v_exp_f32 v51,v51
v_cvt_pk_bf16_f32 v40,v44,v45
v_cvt_pk_bf16_f32 v41,v46,v47
v_cvt_pk_bf16_f32 v42,v48,v49
v_cvt_pk_bf16_f32 v43,v50,v51
Lw_243:
s_add_u32 m0,s82,0x41a0
s_nop 0
buffer_load_dwordx4 v5,s[8:11],s71 offen offset:1024 nt lds
s_waitcnt vmcnt(12)
ds_read_b64_tr_b16 v[178:179],v12 offset:4192
ds_read_b64_tr_b16 v[182:183],v12 offset:4224
ds_read_b64_tr_b16 v[186:187],v13 offset:4192
ds_read_b64_tr_b16 v[190:191],v13 offset:4224
ds_read_b64_tr_b16 v[194:195],v14 offset:4192
ds_read_b64_tr_b16 v[198:199],v14 offset:4224
ds_read_b64_tr_b16 v[202:203],v15 offset:4192
ds_read_b64_tr_b16 v[206:207],v15 offset:4224
s_add_u32 m0,s82,0x41c0
s_nop 0
buffer_load_dwordx4 v5,s[8:11],s71 offen offset:2048 nt lds
s_add_u32 m0,s82,0x41e0
s_nop 0
buffer_load_dwordx4 v5,s[8:11],s71 offen offset:3072 nt lds
s_cmp_ge_i32 s85,1
s_cbranch_scc0 Lw_244
v_mov_b32_dpp v20,v40 quad_perm:[0,1,2,3] row_mask:0xf bank_mask:0x1
v_mov_b32_dpp v21,v41 quad_perm:[0,1,2,3] row_mask:0xf bank_mask:0x1
v_mov_b32_dpp v22,v40 row_shl:4 row_mask:0xf bank_mask:0x1
v_mov_b32_dpp v23,v41 row_shl:4 row_mask:0xf bank_mask:0x1
s_waitcnt lgkmcnt(8)
s_waitcnt lgkmcnt(0)
v_mfma_f32_16x16x32_bf16 v[52:55],v[16:19],v[20:23],0
v_mov_b32_dpp v24,v40 row_shr:4 row_mask:0xf bank_mask:0x2
v_mov_b32_dpp v25,v41 row_shr:4 row_mask:0xf bank_mask:0x2
v_mfma_f32_16x16x32_bf16 v[44:47],v[176:179],v[20:23],0
v_mov_b32_dpp v26,v40 quad_perm:[0,1,2,3] row_mask:0xf bank_mask:0x2
v_mov_b32_dpp v27,v41 quad_perm:[0,1,2,3] row_mask:0xf bank_mask:0x2
v_mfma_f32_16x16x32_bf16 v[48:51],v[192:195],v[20:23],0
v_mov_b32_dpp v28,v40 row_shr:8 row_mask:0xf bank_mask:0x4
v_mov_b32_dpp v29,v41 row_shr:8 row_mask:0xf bank_mask:0x4
v_mfma_f32_16x16x32_bf16 v[44:47],v[180:183],v[24:27],v[44:47]
v_mov_b32_dpp v30,v40 row_shr:4 row_mask:0xf bank_mask:0x4
v_mov_b32_dpp v31,v41 row_shr:4 row_mask:0xf bank_mask:0x4
v_mfma_f32_16x16x32_bf16 v[48:51],v[196:199],v[24:27],v[48:51]
v_mov_b32_dpp v32,v40 row_shr:12 row_mask:0xf bank_mask:0x8
v_mov_b32_dpp v33,v41 row_shr:12 row_mask:0xf bank_mask:0x8
v_mfma_f32_16x16x32_bf16 v[44:47],v[184:187],v[28:31],v[44:47]
v_mov_b32_dpp v34,v40 row_shr:8 row_mask:0xf bank_mask:0x8
v_mov_b32_dpp v35,v41 row_shr:8 row_mask:0xf bank_mask:0x8
v_mfma_f32_16x16x32_bf16 v[48:51],v[200:203],v[28:31],v[48:51]
s_nop 0
v_mfma_f32_16x16x32_bf16 v[44:47],v[188:191],v[32:35],v[44:47]
v_mfma_f32_16x16x32_bf16 v[48:51],v[204:207],v[32:35],v[48:51]
Lw_244:
s_branch L_cut0
L_exit0:
s_mov_b32 s47,0
s_add_u32 s49,s80,0x1c000
s_mov_b32 s57,s53
s_mov_b32 s58,6
s_branch L_ep0
L_fast0:
v_accvgpr_read_b32 v44,a164
v_accvgpr_read_b32 v45,a165
v_accvgpr_read_b32 v46,a166
v_accvgpr_read_b32 v47,a167
s_add_u32 s49,s80,0
s_mov_b32 s57,s50
s_mov_b32 s58,-8
s_branch L_epq0
L_exit1:
s_mov_b32 s47,0
s_add_u32 s49,s80,0x1c000
s_mov_b32 s57,s54
s_mov_b32 s58,6
s_branch L_ep1
L_fast1:
v_accvgpr_read_b32 v44,a36
v_accvgpr_read_b32 v45,a37
v_accvgpr_read_b32 v46,a38
v_accvgpr_read_b32 v47,a39
s_add_u32 s49,s80,0
s_mov_b32 s57,s51
s_mov_b32 s58,-8
s_branch L_epq1
L_exit2:
s_mov_b32 s47,0
s_add_u32 s49,s80,0x1c000
s_mov_b32 s57,s55
s_mov_b32 s58,6
s_branch L_ep2
L_fast2:
v_accvgpr_read_b32 v44,a100
v_accvgpr_read_b32 v45,a101
v_accvgpr_read_b32 v46,a102
v_accvgpr_read_b32 v47,a103
s_add_u32 s49,s80,0
s_mov_b32 s57,s52
s_mov_b32 s58,-8
s_branch L_epq2
L_ep0:
s_waitcnt vmcnt(0)
s_waitcnt lgkmcnt(0)
s_nop 7
buffer_load_dwordx4 v[44:47],v3,s[12:15],s49 offen offset:0 sc1
s_waitcnt vmcnt(0)
L_epq0:
ds_read_b128 a[128:131],v8 offset:20960
ds_read_b128 a[132:135],v9 offset:20960
ds_read_b128 a[136:139],v10 offset:20960
ds_read_b128 a[140:143],v11 offset:20960
ds_read_b128 a[144:147],v8 offset:25152
ds_read_b128 a[148:151],v9 offset:25152
ds_read_b128 a[152:155],v10 offset:25152
ds_read_b128 a[156:159],v11 offset:25152
Lc_341:
v_cmp_u_f32 vcc,v44,v45
s_cbranch_vccnz Lr_343
v_cmp_u_f32 vcc,v46,v47
s_cbranch_vccnz Lr_343
Lo_342:
ds_write_b128 v4,v[44:47]
ds_read_b128 a[160:163],v6 offset:0
ds_read_b128 a[164:167],v6 offset:64
ds_read_b128 a[168:171],v6 offset:128
ds_read_b128 a[172:175],v6 offset:192
s_waitcnt lgkmcnt(0)
v_mfma_f32_16x16x32_bf16 v[48:51],a[0:3],a[160:163],0
v_mfma_f32_16x16x32_bf16 v[48:51],a[4:7],a[164:167],v[48:51]
v_mfma_f32_16x16x32_bf16 v[48:51],a[8:11],a[168:171],v[48:51]
v_mfma_f32_16x16x32_bf16 v[48:51],a[12:15],a[172:175],v[48:51]
v_mfma_f32_16x16x32_bf16 v[56:59],a[16:19],a[160:163],0
v_mfma_f32_16x16x32_bf16 v[56:59],a[20:23],a[164:167],v[56:59]
v_mfma_f32_16x16x32_bf16 v[56:59],a[24:27],a[168:171],v[56:59]
v_mfma_f32_16x16x32_bf16 v[56:59],a[28:31],a[172:175],v[56:59]
v_mfma_f32_16x16x32_bf16 v[44:47],a[32:35],a[160:163],0
v_mfma_f32_16x16x32_bf16 v[44:47],a[36:39],a[164:167],v[44:47]
v_mfma_f32_16x16x32_bf16 v[44:47],a[40:43],a[168:171],v[44:47]
v_mfma_f32_16x16x32_bf16 v[44:47],a[44:47],a[172:175],v[44:47]
v_mfma_f32_16x16x32_bf16 v[60:63],a[48:51],a[160:163],0
v_mfma_f32_16x16x32_bf16 v[60:63],a[52:55],a[164:167],v[60:63]
v_mfma_f32_16x16x32_bf16 v[60:63],a[56:59],a[168:171],v[60:63]
v_mfma_f32_16x16x32_bf16 v[60:63],a[60:63],a[172:175],v[60:63]
v_mov_b32_dpp v48,v56 quad_perm:[0,1,2,3] row_mask:0xf bank_mask:0x2
v_mov_b32_dpp v49,v57 quad_perm:[0,1,2,3] row_mask:0xf bank_mask:0x2
v_mfma_f32_16x16x32_bf16 v[52:55],a[128:131],a[160:163],0
v_mov_b32_dpp v50,v58 quad_perm:[0,1,2,3] row_mask:0xf bank_mask:0x2
v_mov_b32_dpp v51,v59 quad_perm:[0,1,2,3] row_mask:0xf bank_mask:0x2
v_mfma_f32_16x16x32_bf16 v[52:55],a[132:135],a[164:167],v[52:55]
v_mov_b32_dpp v48,v44 quad_perm:[0,1,2,3] row_mask:0xf bank_mask:0x4
v_mov_b32_dpp v49,v45 quad_perm:[0,1,2,3] row_mask:0xf bank_mask:0x4
v_mfma_f32_16x16x32_bf16 v[52:55],a[136:139],a[168:171],v[52:55]
v_mov_b32_dpp v50,v46 quad_perm:[0,1,2,3] row_mask:0xf bank_mask:0x4
v_mov_b32_dpp v51,v47 quad_perm:[0,1,2,3] row_mask:0xf bank_mask:0x4
v_mfma_f32_16x16x32_bf16 v[52:55],a[140:143],a[172:175],v[52:55]
v_mfma_f32_16x16x32_bf16 v[56:59],a[144:147],a[160:163],0
v_mfma_f32_16x16x32_bf16 v[56:59],a[148:151],a[164:167],v[56:59]
v_mov_b32_dpp v48,v60 quad_perm:[0,1,2,3] row_mask:0xf bank_mask:0x8
v_mov_b32_dpp v49,v61 quad_perm:[0,1,2,3] row_mask:0xf bank_mask:0x8
v_mfma_f32_16x16x32_bf16 v[56:59],a[152:155],a[168:171],v[56:59]
v_mov_b32_dpp v50,v62 quad_perm:[0,1,2,3] row_mask:0xf bank_mask:0x8
v_mov_b32_dpp v51,v63 quad_perm:[0,1,2,3] row_mask:0xf bank_mask:0x8
v_mfma_f32_16x16x32_bf16 v[56:59],a[156:159],a[172:175],v[56:59]
s_nop 7
v_mov_b32_dpp v52,v56 quad_perm:[0,1,2,3] row_mask:0xf bank_mask:0x2
v_mov_b32_dpp v53,v57 quad_perm:[0,1,2,3] row_mask:0xf bank_mask:0x2
v_mov_b32_dpp v54,v58 quad_perm:[0,1,2,3] row_mask:0xf bank_mask:0x2
v_mov_b32_dpp v55,v59 quad_perm:[0,1,2,3] row_mask:0xf bank_mask:0x2
v_max3_f32 v38,v48,v49,v50
v_max3_f32 v38,v38,v51,v52
v_max3_f32 v38,v38,v53,v54
v_max_f32 v38,v38,v55
s_nop 1
v_max_f32_dpp v38,v38,v38 row_ror:4 row_mask:15 bank_mask:15
s_nop 1
v_max_f32_dpp v38,v38,v38 row_ror:8 row_mask:15 bank_mask:15
v_mov_b32 v37,v38
s_nop 1
v_permlane16_swap_b32 v38,v37
v_max_f32 v38,v38,v37
v_mov_b32 v37,v38
s_nop 1
v_permlane32_swap_b32 v38,v37
v_max_f32 v38,v38,v37
v_mul_f32 v38,s74,v38
v_fma_f32 v48,v48,s74,-v38
v_fma_f32 v49,v49,s74,-v38
v_fma_f32 v50,v50,s74,-v38
v_fma_f32 v51,v51,s74,-v38
v_fma_f32 v52,v52,s74,-v38
v_fma_f32 v53,v53,s74,-v38
v_fma_f32 v54,v54,s74,-v38
v_fma_f32 v55,v55,s74,-v38
v_exp_f32 v48,v48
v_exp_f32 v49,v49
v_exp_f32 v50,v50
v_exp_f32 v51,v51
v_exp_f32 v52,v52
v_exp_f32 v53,v53
v_exp_f32 v54,v54
v_exp_f32 v55,v55
v_cvt_pk_bf16_f32 v44,v48,v49
v_cvt_pk_bf16_f32 v45,v50,v51
v_cvt_pk_bf16_f32 v46,v52,v53
v_cvt_pk_bf16_f32 v47,v54,v55
v_mov_b32_dpp v20,v44 quad_perm:[0,1,2,3] row_mask:0xf bank_mask:0x1
v_mov_b32_dpp v21,v45 quad_perm:[0,1,2,3] row_mask:0xf bank_mask:0x1
v_mov_b32_dpp v22,v44 row_shl:4 row_mask:0xf bank_mask:0x1
v_mov_b32_dpp v23,v45 row_shl:4 row_mask:0xf bank_mask:0x1
s_nop 1
v_mfma_f32_16x16x32_bf16 v[56:59],v[16:19],v[20:23],0
v_mov_b32_dpp v24,v44 row_shr:4 row_mask:0xf bank_mask:0x2
v_mov_b32_dpp v25,v45 row_shr:4 row_mask:0xf bank_mask:0x2
v_mfma_f32_16x16x32_bf16 v[48:51],a[192:195],v[20:23],0
v_mov_b32_dpp v26,v44 quad_perm:[0,1,2,3] row_mask:0xf bank_mask:0x2
v_mov_b32_dpp v27,v45 quad_perm:[0,1,2,3] row_mask:0xf bank_mask:0x2
v_mfma_f32_16x16x32_bf16 v[52:55],a[208:211],v[20:23],0
v_mov_b32_dpp v28,v44 row_shr:8 row_mask:0xf bank_mask:0x4
v_mov_b32_dpp v29,v45 row_shr:8 row_mask:0xf bank_mask:0x4
v_mfma_f32_16x16x32_bf16 v[48:51],a[196:199],v[24:27],v[48:51]
v_mov_b32_dpp v30,v44 row_shr:4 row_mask:0xf bank_mask:0x4
v_mov_b32_dpp v31,v45 row_shr:4 row_mask:0xf bank_mask:0x4
v_mfma_f32_16x16x32_bf16 v[52:55],a[212:215],v[24:27],v[52:55]
v_mov_b32_dpp v32,v44 row_shr:12 row_mask:0xf bank_mask:0x8
v_mov_b32_dpp v33,v45 row_shr:12 row_mask:0xf bank_mask:0x8
v_mfma_f32_16x16x32_bf16 v[48:51],a[200:203],v[28:31],v[48:51]
v_mov_b32_dpp v34,v44 row_shr:8 row_mask:0xf bank_mask:0x8
v_mov_b32_dpp v35,v45 row_shr:8 row_mask:0xf bank_mask:0x8
v_mfma_f32_16x16x32_bf16 v[52:55],a[216:219],v[28:31],v[52:55]
v_mov_b32_dpp v20,v44 row_shl:8 row_mask:0xf bank_mask:0x1
v_mov_b32_dpp v21,v45 row_shl:8 row_mask:0xf bank_mask:0x1
v_mfma_f32_16x16x32_bf16 v[48:51],a[204:207],v[32:35],v[48:51]
v_mov_b32_dpp v22,v44 row_shl:12 row_mask:0xf bank_mask:0x1
v_mov_b32_dpp v23,v45 row_shl:12 row_mask:0xf bank_mask:0x1
v_mfma_f32_16x16x32_bf16 v[52:55],a[220:223],v[32:35],v[52:55]
s_nop 0
v_mfma_f32_16x16x32_bf16 v[56:59],v[16:19],v[20:23],v[56:59]
v_mov_b32_dpp v24,v44 row_shl:4 row_mask:0xf bank_mask:0x2
v_mov_b32_dpp v25,v45 row_shl:4 row_mask:0xf bank_mask:0x2
v_mfma_f32_16x16x32_bf16 v[48:51],a[224:227],v[20:23],v[48:51]
v_mov_b32_dpp v26,v44 row_shl:8 row_mask:0xf bank_mask:0x2
v_mov_b32_dpp v27,v45 row_shl:8 row_mask:0xf bank_mask:0x2
v_mfma_f32_16x16x32_bf16 v[52:55],a[240:243],v[20:23],v[52:55]
v_mov_b32_dpp v28,v44 quad_perm:[0,1,2,3] row_mask:0xf bank_mask:0x4
v_mov_b32_dpp v29,v45 quad_perm:[0,1,2,3] row_mask:0xf bank_mask:0x4
v_mfma_f32_16x16x32_bf16 v[48:51],a[228:231],v[24:27],v[48:51]
v_mov_b32_dpp v30,v44 row_shl:4 row_mask:0xf bank_mask:0x4
v_mov_b32_dpp v31,v45 row_shl:4 row_mask:0xf bank_mask:0x4
v_mfma_f32_16x16x32_bf16 v[52:55],a[244:247],v[24:27],v[52:55]
v_mov_b32_dpp v32,v44 row_shr:4 row_mask:0xf bank_mask:0x8
v_mov_b32_dpp v33,v45 row_shr:4 row_mask:0xf bank_mask:0x8
v_mfma_f32_16x16x32_bf16 v[48:51],a[232:235],v[28:31],v[48:51]
v_mov_b32_dpp v34,v44 quad_perm:[0,1,2,3] row_mask:0xf bank_mask:0x8
v_mov_b32_dpp v35,v45 quad_perm:[0,1,2,3] row_mask:0xf bank_mask:0x8
v_mfma_f32_16x16x32_bf16 v[52:55],a[248:251],v[28:31],v[52:55]
v_mov_b32_dpp v20,v46 quad_perm:[0,1,2,3] row_mask:0xf bank_mask:0x1
v_mov_b32_dpp v21,v47 quad_perm:[0,1,2,3] row_mask:0xf bank_mask:0x1
v_mfma_f32_16x16x32_bf16 v[48:51],a[236:239],v[32:35],v[48:51]
v_mov_b32_dpp v22,v46 row_shl:4 row_mask:0xf bank_mask:0x1
v_mov_b32_dpp v23,v47 row_shl:4 row_mask:0xf bank_mask:0x1
v_mfma_f32_16x16x32_bf16 v[52:55],a[252:255],v[32:35],v[52:55]
ds_write_b32 v1,v38
s_waitcnt lgkmcnt(0)
s_barrier
ds_read_b32 v38,v2
v_mfma_f32_16x16x32_bf16 v[56:59],v[16:19],v[20:23],v[56:59]
v_mov_b32_dpp v24,v46 row_shr:4 row_mask:0xf bank_mask:0x2
v_mov_b32_dpp v25,v47 row_shr:4 row_mask:0xf bank_mask:0x2
v_mfma_f32_16x16x32_bf16 v[48:51],v[64:67],v[20:23],v[48:51]
v_mov_b32_dpp v26,v46 quad_perm:[0,1,2,3] row_mask:0xf bank_mask:0x2
v_mov_b32_dpp v27,v47 quad_perm:[0,1,2,3] row_mask:0xf bank_mask:0x2
v_mfma_f32_16x16x32_bf16 v[52:55],v[80:83],v[20:23],v[52:55]
v_mov_b32_dpp v28,v46 row_shr:8 row_mask:0xf bank_mask:0x4
v_mov_b32_dpp v29,v47 row_shr:8 row_mask:0xf bank_mask:0x4
v_mfma_f32_16x16x32_bf16 v[48:51],v[68:71],v[24:27],v[48:51]
v_mov_b32_dpp v30,v46 row_shr:4 row_mask:0xf bank_mask:0x4
v_mov_b32_dpp v31,v47 row_shr:4 row_mask:0xf bank_mask:0x4
v_mfma_f32_16x16x32_bf16 v[52:55],v[84:87],v[24:27],v[52:55]
v_mov_b32_dpp v32,v46 row_shr:12 row_mask:0xf bank_mask:0x8
v_mov_b32_dpp v33,v47 row_shr:12 row_mask:0xf bank_mask:0x8
v_mfma_f32_16x16x32_bf16 v[48:51],v[72:75],v[28:31],v[48:51]
v_mov_b32_dpp v34,v46 row_shr:8 row_mask:0xf bank_mask:0x8
v_mov_b32_dpp v35,v47 row_shr:8 row_mask:0xf bank_mask:0x8
v_mfma_f32_16x16x32_bf16 v[52:55],v[88:91],v[28:31],v[52:55]
s_waitcnt lgkmcnt(0)
v_max_f32_dpp v60,v38,v38 quad_perm:[1,0,3,2] row_mask:15 bank_mask:15
v_mfma_f32_16x16x32_bf16 v[48:51],v[76:79],v[32:35],v[48:51]
s_nop 0
v_max_f32_dpp v60,v60,v60 quad_perm:[2,3,0,1] row_mask:15 bank_mask:15
v_sub_f32 v61,v38,v60
v_mfma_f32_16x16x32_bf16 v[52:55],v[92:95],v[32:35],v[52:55]
v_exp_f32 v61,v61
s_mov_b32 exec_lo,0xf000f
s_mov_b32 exec_hi,0xf000f
ds_write_b32 v1,v56 offset:4
s_mov_b64 exec,-1
ds_write_b128 v7,v[48:51] offset:0
s_nop 1
ds_write_b128 v7,v[52:55] offset:16
s_waitcnt lgkmcnt(0)
s_barrier
ds_read_b32 v39,v2 offset:4
ds_read_b64 v[48:49],v0 offset:0
ds_read_b64 v[50:51],v0 offset:2112
ds_read_b64 v[52:53],v0 offset:4224
ds_read_b64 v[54:55],v0 offset:6336
s_waitcnt lgkmcnt(4)
v_mul_f32 v58,v61,v39
s_waitcnt lgkmcnt(0)
v_mul_f32_dpp v44,v61,v48 quad_perm:[0,0,0,0] row_mask:15 bank_mask:15
v_mul_f32_dpp v45,v61,v49 quad_perm:[0,0,0,0] row_mask:15 bank_mask:15
v_add_f32_dpp v58,v58,v58 quad_perm:[1,0,3,2] row_mask:15 bank_mask:15
v_fmac_f32_dpp v44,v61,v50 quad_perm:[1,1,1,1] row_mask:15 bank_mask:15
v_fmac_f32_dpp v45,v61,v51 quad_perm:[1,1,1,1] row_mask:15 bank_mask:15
v_add_f32_dpp v58,v58,v58 quad_perm:[2,3,0,1] row_mask:15 bank_mask:15
v_rcp_f32 v38,v58
v_log_f32 v58,v58
v_fmac_f32_dpp v44,v61,v52 quad_perm:[2,2,2,2] row_mask:15 bank_mask:15
v_fmac_f32_dpp v45,v61,v53 quad_perm:[2,2,2,2] row_mask:15 bank_mask:15
v_fmac_f32_dpp v44,v61,v54 quad_perm:[3,3,3,3] row_mask:15 bank_mask:15
v_fmac_f32_dpp v45,v61,v55 quad_perm:[3,3,3,3] row_mask:15 bank_mask:15
v_add_f32 v60,v60,v58
v_mul_f32 v44,v44,v38
v_mul_f32 v45,v45,v38
v_cvt_pk_bf16_f32 v44,v44,v45
s_mov_b32 s94,s57
s_add_u32 s95,s94,s76
s_cmp_lg_u32 s69,0
s_cbranch_scc0 Ls_344
buffer_store_dword v44,v36,s[12:15],s94 offen
s_mov_b32 exec_lo,1
s_mov_b32 exec_hi,0
buffer_store_dword v60,v3,s[12:15],s95 offen
Ls_345:
s_mov_b64 exec,-1
s_cmp_lt_u32 s47,16
s_cbranch_scc1 Le_346
s_and_b32 s47,s47,1
s_mov_b32 s49,0x40000000
s_nop 7
s_branch L_back0
Le_346:
s_add_u32 s47,s47,1
s_mov_b32 s58,7
s_add_u32 s49,s80,0x1e000
s_mov_b32 s57,s53
s_cmp_eq_u32 s47,2
s_cbranch_scc1 L_ep0
s_cmp_eq_u32 s47,3
s_cbranch_scc1 L_attend
s_mov_b32 s47,2
s_mov_b32 s57,s54
L_ep1:
s_waitcnt vmcnt(0)
s_waitcnt lgkmcnt(0)
s_nop 7
buffer_load_dwordx4 v[44:47],v3,s[12:15],s49 offen offset:0 sc1
s_waitcnt vmcnt(0)
L_epq1:
ds_read_b128 a[0:3],v8 offset:29344
ds_read_b128 a[4:7],v9 offset:29344
ds_read_b128 a[8:11],v10 offset:29344
ds_read_b128 a[12:15],v11 offset:29344
Lc_347:
v_cmp_u_f32 vcc,v44,v45
s_cbranch_vccnz Lr_349
v_cmp_u_f32 vcc,v46,v47
s_cbranch_vccnz Lr_349
Lo_348:
ds_write_b128 v4,v[44:47]
ds_read_b128 a[32:35],v6 offset:0
ds_read_b128 a[36:39],v6 offset:64
ds_read_b128 a[40:43],v6 offset:128
ds_read_b128 a[44:47],v6 offset:192
s_waitcnt lgkmcnt(0)
v_mfma_f32_16x16x32_bf16 v[48:51],a[64:67],a[32:35],0
v_mfma_f32_16x16x32_bf16 v[48:51],a[68:71],a[36:39],v[48:51]
v_mfma_f32_16x16x32_bf16 v[48:51],a[72:75],a[40:43],v[48:51]
v_mfma_f32_16x16x32_bf16 v[48:51],a[76:79],a[44:47],v[48:51]
v_mfma_f32_16x16x32_bf16 v[56:59],a[80:83],a[32:35],0
v_mfma_f32_16x16x32_bf16 v[56:59],a[84:87],a[36:39],v[56:59]
v_mfma_f32_16x16x32_bf16 v[56:59],a[88:91],a[40:43],v[56:59]
v_mfma_f32_16x16x32_bf16 v[56:59],a[92:95],a[44:47],v[56:59]
v_mfma_f32_16x16x32_bf16 v[44:47],a[96:99],a[32:35],0
v_mfma_f32_16x16x32_bf16 v[44:47],a[100:103],a[36:39],v[44:47]
v_mfma_f32_16x16x32_bf16 v[44:47],a[104:107],a[40:43],v[44:47]
v_mfma_f32_16x16x32_bf16 v[44:47],a[108:111],a[44:47],v[44:47]
v_mfma_f32_16x16x32_bf16 v[60:63],a[112:115],a[32:35],0
v_mfma_f32_16x16x32_bf16 v[60:63],a[116:119],a[36:39],v[60:63]
v_mfma_f32_16x16x32_bf16 v[60:63],a[120:123],a[40:43],v[60:63]
v_mfma_f32_16x16x32_bf16 v[60:63],a[124:127],a[44:47],v[60:63]
v_mov_b32_dpp v48,v56 quad_perm:[0,1,2,3] row_mask:0xf bank_mask:0x2
v_mov_b32_dpp v49,v57 quad_perm:[0,1,2,3] row_mask:0xf bank_mask:0x2
v_mfma_f32_16x16x32_bf16 v[52:55],a[0:3],a[32:35],0
v_mov_b32_dpp v50,v58 quad_perm:[0,1,2,3] row_mask:0xf bank_mask:0x2
v_mov_b32_dpp v51,v59 quad_perm:[0,1,2,3] row_mask:0xf bank_mask:0x2
v_mfma_f32_16x16x32_bf16 v[52:55],a[4:7],a[36:39],v[52:55]
v_mov_b32_dpp v48,v44 quad_perm:[0,1,2,3] row_mask:0xf bank_mask:0x4
v_mov_b32_dpp v49,v45 quad_perm:[0,1,2,3] row_mask:0xf bank_mask:0x4
v_mfma_f32_16x16x32_bf16 v[52:55],a[8:11],a[40:43],v[52:55]
v_mov_b32_dpp v50,v46 quad_perm:[0,1,2,3] row_mask:0xf bank_mask:0x4
v_mov_b32_dpp v51,v47 quad_perm:[0,1,2,3] row_mask:0xf bank_mask:0x4
v_mfma_f32_16x16x32_bf16 v[52:55],a[12:15],a[44:47],v[52:55]
v_mov_b32_dpp v48,v60 quad_perm:[0,1,2,3] row_mask:0xf bank_mask:0x8
v_mov_b32_dpp v49,v61 quad_perm:[0,1,2,3] row_mask:0xf bank_mask:0x8
v_mov_b32_dpp v50,v62 quad_perm:[0,1,2,3] row_mask:0xf bank_mask:0x8
v_mov_b32_dpp v51,v63 quad_perm:[0,1,2,3] row_mask:0xf bank_mask:0x8
v_max3_f32 v38,v48,v49,v50
s_nop 2
v_max3_f32 v38,v38,v51,v52
v_max3_f32 v38,v38,v53,v54
v_max_f32 v38,v38,v55
s_nop 1
v_max_f32_dpp v38,v38,v38 row_ror:4 row_mask:15 bank_mask:15
s_nop 1
v_max_f32_dpp v38,v38,v38 row_ror:8 row_mask:15 bank_mask:15
v_mov_b32 v37,v38
s_nop 1
v_permlane16_swap_b32 v38,v37
v_max_f32 v38,v38,v37
v_mov_b32 v37,v38
s_nop 1
v_permlane32_swap_b32 v38,v37
v_max_f32 v38,v38,v37
v_mul_f32 v38,s74,v38
v_fma_f32 v48,v48,s74,-v38
v_fma_f32 v49,v49,s74,-v38
v_fma_f32 v50,v50,s74,-v38
v_fma_f32 v51,v51,s74,-v38
v_fma_f32 v52,v52,s74,-v38
v_fma_f32 v53,v53,s74,-v38
v_fma_f32 v54,v54,s74,-v38
v_fma_f32 v55,v55,s74,-v38
v_exp_f32 v48,v48
v_exp_f32 v49,v49
v_exp_f32 v50,v50
v_exp_f32 v51,v51
v_exp_f32 v52,v52
v_exp_f32 v53,v53
v_exp_f32 v54,v54
v_exp_f32 v55,v55
v_cvt_pk_bf16_f32 v44,v48,v49
v_cvt_pk_bf16_f32 v45,v50,v51
v_cvt_pk_bf16_f32 v46,v52,v53
v_cvt_pk_bf16_f32 v47,v54,v55
v_mov_b32_dpp v20,v44 quad_perm:[0,1,2,3] row_mask:0xf bank_mask:0x1
v_mov_b32_dpp v21,v45 quad_perm:[0,1,2,3] row_mask:0xf bank_mask:0x1
v_mov_b32_dpp v22,v44 row_shl:4 row_mask:0xf bank_mask:0x1
v_mov_b32_dpp v23,v45 row_shl:4 row_mask:0xf bank_mask:0x1
s_nop 1
v_mfma_f32_16x16x32_bf16 v[56:59],v[16:19],v[20:23],0
v_mov_b32_dpp v24,v44 row_shr:4 row_mask:0xf bank_mask:0x2
v_mov_b32_dpp v25,v45 row_shr:4 row_mask:0xf bank_mask:0x2
v_mfma_f32_16x16x32_bf16 v[48:51],v[96:99],v[20:23],0
v_mov_b32_dpp v26,v44 quad_perm:[0,1,2,3] row_mask:0xf bank_mask:0x2
v_mov_b32_dpp v27,v45 quad_perm:[0,1,2,3] row_mask:0xf bank_mask:0x2
v_mfma_f32_16x16x32_bf16 v[52:55],v[112:115],v[20:23],0
v_mov_b32_dpp v28,v44 row_shr:8 row_mask:0xf bank_mask:0x4
v_mov_b32_dpp v29,v45 row_shr:8 row_mask:0xf bank_mask:0x4
v_mfma_f32_16x16x32_bf16 v[48:51],v[100:103],v[24:27],v[48:51]
v_mov_b32_dpp v30,v44 row_shr:4 row_mask:0xf bank_mask:0x4
v_mov_b32_dpp v31,v45 row_shr:4 row_mask:0xf bank_mask:0x4
v_mfma_f32_16x16x32_bf16 v[52:55],v[116:119],v[24:27],v[52:55]
v_mov_b32_dpp v32,v44 row_shr:12 row_mask:0xf bank_mask:0x8
v_mov_b32_dpp v33,v45 row_shr:12 row_mask:0xf bank_mask:0x8
v_mfma_f32_16x16x32_bf16 v[48:51],v[104:107],v[28:31],v[48:51]
v_mov_b32_dpp v34,v44 row_shr:8 row_mask:0xf bank_mask:0x8
v_mov_b32_dpp v35,v45 row_shr:8 row_mask:0xf bank_mask:0x8
v_mfma_f32_16x16x32_bf16 v[52:55],v[120:123],v[28:31],v[52:55]
v_mov_b32_dpp v20,v44 row_shl:8 row_mask:0xf bank_mask:0x1
v_mov_b32_dpp v21,v45 row_shl:8 row_mask:0xf bank_mask:0x1
v_mfma_f32_16x16x32_bf16 v[48:51],v[108:111],v[32:35],v[48:51]
v_mov_b32_dpp v22,v44 row_shl:12 row_mask:0xf bank_mask:0x1
v_mov_b32_dpp v23,v45 row_shl:12 row_mask:0xf bank_mask:0x1
v_mfma_f32_16x16x32_bf16 v[52:55],v[124:127],v[32:35],v[52:55]
s_nop 0
v_mfma_f32_16x16x32_bf16 v[56:59],v[16:19],v[20:23],v[56:59]
v_mov_b32_dpp v24,v44 row_shl:4 row_mask:0xf bank_mask:0x2
v_mov_b32_dpp v25,v45 row_shl:4 row_mask:0xf bank_mask:0x2
v_mfma_f32_16x16x32_bf16 v[48:51],v[128:131],v[20:23],v[48:51]
v_mov_b32_dpp v26,v44 row_shl:8 row_mask:0xf bank_mask:0x2
v_mov_b32_dpp v27,v45 row_shl:8 row_mask:0xf bank_mask:0x2
v_mfma_f32_16x16x32_bf16 v[52:55],v[144:147],v[20:23],v[52:55]
v_mov_b32_dpp v28,v44 quad_perm:[0,1,2,3] row_mask:0xf bank_mask:0x4
v_mov_b32_dpp v29,v45 quad_perm:[0,1,2,3] row_mask:0xf bank_mask:0x4
v_mfma_f32_16x16x32_bf16 v[48:51],v[132:135],v[24:27],v[48:51]
v_mov_b32_dpp v30,v44 row_shl:4 row_mask:0xf bank_mask:0x4
v_mov_b32_dpp v31,v45 row_shl:4 row_mask:0xf bank_mask:0x4
v_mfma_f32_16x16x32_bf16 v[52:55],v[148:151],v[24:27],v[52:55]
v_mov_b32_dpp v32,v44 row_shr:4 row_mask:0xf bank_mask:0x8
v_mov_b32_dpp v33,v45 row_shr:4 row_mask:0xf bank_mask:0x8
v_mfma_f32_16x16x32_bf16 v[48:51],v[136:139],v[28:31],v[48:51]
v_mov_b32_dpp v34,v44 quad_perm:[0,1,2,3] row_mask:0xf bank_mask:0x8
v_mov_b32_dpp v35,v45 quad_perm:[0,1,2,3] row_mask:0xf bank_mask:0x8
v_mfma_f32_16x16x32_bf16 v[52:55],v[152:155],v[28:31],v[52:55]
v_mov_b32_dpp v20,v46 quad_perm:[0,1,2,3] row_mask:0xf bank_mask:0x1
v_mov_b32_dpp v21,v47 quad_perm:[0,1,2,3] row_mask:0xf bank_mask:0x1
v_mfma_f32_16x16x32_bf16 v[48:51],v[140:143],v[32:35],v[48:51]
v_mfma_f32_16x16x32_bf16 v[52:55],v[156:159],v[32:35],v[52:55]
ds_write_b32 v1,v38
s_waitcnt lgkmcnt(0)
s_barrier
ds_read_b32 v38,v2
v_mfma_f32_16x16x16_bf16 v[56:59],v[16:17],v[20:21],v[56:59]
v_mov_b32_dpp v24,v46 row_shr:4 row_mask:0xf bank_mask:0x2
v_mov_b32_dpp v25,v47 row_shr:4 row_mask:0xf bank_mask:0x2
v_mfma_f32_16x16x16_bf16 v[48:51],v[160:161],v[20:21],v[48:51]
v_mov_b32_dpp v28,v46 row_shr:8 row_mask:0xf bank_mask:0x4
v_mov_b32_dpp v29,v47 row_shr:8 row_mask:0xf bank_mask:0x4
v_mfma_f32_16x16x16_bf16 v[52:55],v[168:169],v[20:21],v[52:55]
v_mov_b32_dpp v32,v46 row_shr:12 row_mask:0xf bank_mask:0x8
v_mov_b32_dpp v33,v47 row_shr:12 row_mask:0xf bank_mask:0x8
v_mfma_f32_16x16x16_bf16 v[48:51],v[162:163],v[24:25],v[48:51]
v_mfma_f32_16x16x16_bf16 v[52:55],v[170:171],v[24:25],v[52:55]
v_mfma_f32_16x16x16_bf16 v[48:51],v[164:165],v[28:29],v[48:51]
s_waitcnt lgkmcnt(0)
v_max_f32_dpp v60,v38,v38 quad_perm:[1,0,3,2] row_mask:15 bank_mask:15
v_mfma_f32_16x16x16_bf16 v[52:55],v[172:173],v[28:29],v[52:55]
v_mfma_f32_16x16x16_bf16 v[48:51],v[166:167],v[32:33],v[48:51]
v_max_f32_dpp v60,v60,v60 quad_perm:[2,3,0,1] row_mask:15 bank_mask:15
v_sub_f32 v61,v38,v60
v_mfma_f32_16x16x16_bf16 v[52:55],v[174:175],v[32:33],v[52:55]
v_exp_f32 v61,v61
s_mov_b32 exec_lo,0xf000f
s_mov_b32 exec_hi,0xf000f
ds_write_b32 v1,v56 offset:4
s_mov_b64 exec,-1
ds_write_b128 v7,v[48:51] offset:0
s_nop 1
ds_write_b128 v7,v[52:55] offset:16
s_waitcnt lgkmcnt(0)
s_barrier
ds_read_b32 v39,v2 offset:4
ds_read_b64 v[48:49],v0 offset:0
ds_read_b64 v[50:51],v0 offset:2112
ds_read_b64 v[52:53],v0 offset:4224
ds_read_b64 v[54:55],v0 offset:6336
s_waitcnt lgkmcnt(4)
v_mul_f32 v58,v61,v39
s_waitcnt lgkmcnt(0)
v_mul_f32_dpp v44,v61,v48 quad_perm:[0,0,0,0] row_mask:15 bank_mask:15
v_mul_f32_dpp v45,v61,v49 quad_perm:[0,0,0,0] row_mask:15 bank_mask:15
v_add_f32_dpp v58,v58,v58 quad_perm:[1,0,3,2] row_mask:15 bank_mask:15
v_fmac_f32_dpp v44,v61,v50 quad_perm:[1,1,1,1] row_mask:15 bank_mask:15
v_fmac_f32_dpp v45,v61,v51 quad_perm:[1,1,1,1] row_mask:15 bank_mask:15
v_add_f32_dpp v58,v58,v58 quad_perm:[2,3,0,1] row_mask:15 bank_mask:15
v_rcp_f32 v38,v58
v_log_f32 v58,v58
v_fmac_f32_dpp v44,v61,v52 quad_perm:[2,2,2,2] row_mask:15 bank_mask:15
v_fmac_f32_dpp v45,v61,v53 quad_perm:[2,2,2,2] row_mask:15 bank_mask:15
v_fmac_f32_dpp v44,v61,v54 quad_perm:[3,3,3,3] row_mask:15 bank_mask:15
v_fmac_f32_dpp v45,v61,v55 quad_perm:[3,3,3,3] row_mask:15 bank_mask:15
v_add_f32 v60,v60,v58
v_mul_f32 v44,v44,v38
v_mul_f32 v45,v45,v38
v_cvt_pk_bf16_f32 v44,v44,v45
s_mov_b32 s94,s57
s_add_u32 s95,s94,s76
s_cmp_lg_u32 s69,0
s_cbranch_scc0 Ls_350
buffer_store_dword v44,v36,s[12:15],s94 offen
s_mov_b32 exec_lo,1
s_mov_b32 exec_hi,0
buffer_store_dword v60,v3,s[12:15],s95 offen
Ls_351:
s_mov_b64 exec,-1
s_cmp_lt_u32 s47,16
s_cbranch_scc1 Le_352
s_and_b32 s47,s47,1
s_mov_b32 s49,0x40000000
s_nop 7
s_branch L_back1
Le_352:
s_add_u32 s47,s47,1
s_mov_b32 s58,7
s_add_u32 s49,s80,0x1e000
s_mov_b32 s57,s54
s_cmp_eq_u32 s47,2
s_cbranch_scc1 L_ep1
s_cmp_eq_u32 s47,3
s_cbranch_scc1 L_attend
s_mov_b32 s47,2
s_mov_b32 s57,s55
L_ep2:
s_waitcnt vmcnt(0)
s_waitcnt lgkmcnt(0)
s_nop 7
buffer_load_dwordx4 v[44:47],v3,s[12:15],s49 offen offset:0 sc1
s_waitcnt vmcnt(0)
L_epq2:
ds_read_b128 a[64:67],v8 offset:33536
ds_read_b128 a[68:71],v9 offset:33536
ds_read_b128 a[72:75],v10 offset:33536
ds_read_b128 a[76:79],v11 offset:33536
Lc_353:
v_cmp_u_f32 vcc,v44,v45
s_cbranch_vccnz Lr_355
v_cmp_u_f32 vcc,v46,v47
s_cbranch_vccnz Lr_355
Lo_354:
ds_write_b128 v4,v[44:47]
ds_read_b128 a[96:99],v6 offset:0
ds_read_b128 a[100:103],v6 offset:64
ds_read_b128 a[104:107],v6 offset:128
ds_read_b128 a[108:111],v6 offset:192
s_waitcnt lgkmcnt(0)
v_mfma_f32_16x16x32_bf16 v[48:51],a[128:131],a[96:99],0
v_mfma_f32_16x16x32_bf16 v[48:51],a[132:135],a[100:103],v[48:51]
v_mfma_f32_16x16x32_bf16 v[48:51],a[136:139],a[104:107],v[48:51]
v_mfma_f32_16x16x32_bf16 v[48:51],a[140:143],a[108:111],v[48:51]
v_mfma_f32_16x16x32_bf16 v[56:59],a[144:147],a[96:99],0
v_mfma_f32_16x16x32_bf16 v[56:59],a[148:151],a[100:103],v[56:59]
v_mfma_f32_16x16x32_bf16 v[56:59],a[152:155],a[104:107],v[56:59]
v_mfma_f32_16x16x32_bf16 v[56:59],a[156:159],a[108:111],v[56:59]
v_mfma_f32_16x16x32_bf16 v[44:47],a[160:163],a[96:99],0
v_mfma_f32_16x16x32_bf16 v[44:47],a[164:167],a[100:103],v[44:47]
v_mfma_f32_16x16x32_bf16 v[44:47],a[168:171],a[104:107],v[44:47]
v_mfma_f32_16x16x32_bf16 v[44:47],a[172:175],a[108:111],v[44:47]
v_mfma_f32_16x16x32_bf16 v[60:63],a[176:179],a[96:99],0
v_mfma_f32_16x16x32_bf16 v[60:63],a[180:183],a[100:103],v[60:63]
v_mfma_f32_16x16x32_bf16 v[60:63],a[184:187],a[104:107],v[60:63]
v_mfma_f32_16x16x32_bf16 v[60:63],a[188:191],a[108:111],v[60:63]
v_mov_b32_dpp v48,v56 quad_perm:[0,1,2,3] row_mask:0xf bank_mask:0x2
v_mov_b32_dpp v49,v57 quad_perm:[0,1,2,3] row_mask:0xf bank_mask:0x2
v_mfma_f32_16x16x32_bf16 v[52:55],a[64:67],a[96:99],0
v_mov_b32_dpp v50,v58 quad_perm:[0,1,2,3] row_mask:0xf bank_mask:0x2
v_mov_b32_dpp v51,v59 quad_perm:[0,1,2,3] row_mask:0xf bank_mask:0x2
v_mfma_f32_16x16x32_bf16 v[52:55],a[68:71],a[100:103],v[52:55]
v_mov_b32_dpp v48,v44 quad_perm:[0,1,2,3] row_mask:0xf bank_mask:0x4
v_mov_b32_dpp v49,v45 quad_perm:[0,1,2,3] row_mask:0xf bank_mask:0x4
v_mfma_f32_16x16x32_bf16 v[52:55],a[72:75],a[104:107],v[52:55]
v_mov_b32_dpp v50,v46 quad_perm:[0,1,2,3] row_mask:0xf bank_mask:0x4
v_mov_b32_dpp v51,v47 quad_perm:[0,1,2,3] row_mask:0xf bank_mask:0x4
v_mfma_f32_16x16x32_bf16 v[52:55],a[76:79],a[108:111],v[52:55]
v_mov_b32_dpp v48,v60 quad_perm:[0,1,2,3] row_mask:0xf bank_mask:0x8
v_mov_b32_dpp v49,v61 quad_perm:[0,1,2,3] row_mask:0xf bank_mask:0x8
v_mov_b32_dpp v50,v62 quad_perm:[0,1,2,3] row_mask:0xf bank_mask:0x8
v_mov_b32_dpp v51,v63 quad_perm:[0,1,2,3] row_mask:0xf bank_mask:0x8
v_max3_f32 v38,v48,v49,v50
s_nop 2
v_max3_f32 v38,v38,v51,v52
v_max3_f32 v38,v38,v53,v54
v_max_f32 v38,v38,v55
s_nop 1
v_max_f32_dpp v38,v38,v38 row_ror:4 row_mask:15 bank_mask:15
s_nop 1
v_max_f32_dpp v38,v38,v38 row_ror:8 row_mask:15 bank_mask:15
v_mov_b32 v37,v38
s_nop 1
v_permlane16_swap_b32 v38,v37
v_max_f32 v38,v38,v37
v_mov_b32 v37,v38
s_nop 1
v_permlane32_swap_b32 v38,v37
v_max_f32 v38,v38,v37
v_mul_f32 v38,s74,v38
v_fma_f32 v48,v48,s74,-v38
v_fma_f32 v49,v49,s74,-v38
v_fma_f32 v50,v50,s74,-v38
v_fma_f32 v51,v51,s74,-v38
v_fma_f32 v52,v52,s74,-v38
v_fma_f32 v53,v53,s74,-v38
v_fma_f32 v54,v54,s74,-v38
v_fma_f32 v55,v55,s74,-v38
v_exp_f32 v48,v48
v_exp_f32 v49,v49
v_exp_f32 v50,v50
v_exp_f32 v51,v51
v_exp_f32 v52,v52
v_exp_f32 v53,v53
v_exp_f32 v54,v54
v_exp_f32 v55,v55
v_cvt_pk_bf16_f32 v44,v48,v49
v_cvt_pk_bf16_f32 v45,v50,v51
v_cvt_pk_bf16_f32 v46,v52,v53
v_cvt_pk_bf16_f32 v47,v54,v55
v_mov_b32_dpp v20,v44 quad_perm:[0,1,2,3] row_mask:0xf bank_mask:0x1
v_mov_b32_dpp v21,v45 quad_perm:[0,1,2,3] row_mask:0xf bank_mask:0x1
v_mov_b32_dpp v22,v44 row_shl:4 row_mask:0xf bank_mask:0x1
v_mov_b32_dpp v23,v45 row_shl:4 row_mask:0xf bank_mask:0x1
s_nop 1
v_mfma_f32_16x16x32_bf16 v[56:59],v[16:19],v[20:23],0
v_mov_b32_dpp v24,v44 row_shr:4 row_mask:0xf bank_mask:0x2
v_mov_b32_dpp v25,v45 row_shr:4 row_mask:0xf bank_mask:0x2
v_mfma_f32_16x16x32_bf16 v[48:51],v[176:179],v[20:23],0
v_mov_b32_dpp v26,v44 quad_perm:[0,1,2,3] row_mask:0xf bank_mask:0x2
v_mov_b32_dpp v27,v45 quad_perm:[0,1,2,3] row_mask:0xf bank_mask:0x2
v_mfma_f32_16x16x32_bf16 v[52:55],v[192:195],v[20:23],0
v_mov_b32_dpp v28,v44 row_shr:8 row_mask:0xf bank_mask:0x4
v_mov_b32_dpp v29,v45 row_shr:8 row_mask:0xf bank_mask:0x4
v_mfma_f32_16x16x32_bf16 v[48:51],v[180:183],v[24:27],v[48:51]
v_mov_b32_dpp v30,v44 row_shr:4 row_mask:0xf bank_mask:0x4
v_mov_b32_dpp v31,v45 row_shr:4 row_mask:0xf bank_mask:0x4
v_mfma_f32_16x16x32_bf16 v[52:55],v[196:199],v[24:27],v[52:55]
v_mov_b32_dpp v32,v44 row_shr:12 row_mask:0xf bank_mask:0x8
v_mov_b32_dpp v33,v45 row_shr:12 row_mask:0xf bank_mask:0x8
v_mfma_f32_16x16x32_bf16 v[48:51],v[184:187],v[28:31],v[48:51]
v_mov_b32_dpp v34,v44 row_shr:8 row_mask:0xf bank_mask:0x8
v_mov_b32_dpp v35,v45 row_shr:8 row_mask:0xf bank_mask:0x8
v_mfma_f32_16x16x32_bf16 v[52:55],v[200:203],v[28:31],v[52:55]
v_mov_b32_dpp v20,v44 row_shl:8 row_mask:0xf bank_mask:0x1
v_mov_b32_dpp v21,v45 row_shl:8 row_mask:0xf bank_mask:0x1
v_mfma_f32_16x16x32_bf16 v[48:51],v[188:191],v[32:35],v[48:51]
v_mov_b32_dpp v22,v44 row_shl:12 row_mask:0xf bank_mask:0x1
v_mov_b32_dpp v23,v45 row_shl:12 row_mask:0xf bank_mask:0x1
v_mfma_f32_16x16x32_bf16 v[52:55],v[204:207],v[32:35],v[52:55]
s_nop 0
v_mfma_f32_16x16x32_bf16 v[56:59],v[16:19],v[20:23],v[56:59]
v_mov_b32_dpp v24,v44 row_shl:4 row_mask:0xf bank_mask:0x2
v_mov_b32_dpp v25,v45 row_shl:4 row_mask:0xf bank_mask:0x2
v_mfma_f32_16x16x32_bf16 v[48:51],v[208:211],v[20:23],v[48:51]
v_mov_b32_dpp v26,v44 row_shl:8 row_mask:0xf bank_mask:0x2
v_mov_b32_dpp v27,v45 row_shl:8 row_mask:0xf bank_mask:0x2
v_mfma_f32_16x16x32_bf16 v[52:55],v[224:227],v[20:23],v[52:55]
v_mov_b32_dpp v28,v44 quad_perm:[0,1,2,3] row_mask:0xf bank_mask:0x4
v_mov_b32_dpp v29,v45 quad_perm:[0,1,2,3] row_mask:0xf bank_mask:0x4
v_mfma_f32_16x16x32_bf16 v[48:51],v[212:215],v[24:27],v[48:51]
v_mov_b32_dpp v30,v44 row_shl:4 row_mask:0xf bank_mask:0x4
v_mov_b32_dpp v31,v45 row_shl:4 row_mask:0xf bank_mask:0x4
v_mfma_f32_16x16x32_bf16 v[52:55],v[228:231],v[24:27],v[52:55]
v_mov_b32_dpp v32,v44 row_shr:4 row_mask:0xf bank_mask:0x8
v_mov_b32_dpp v33,v45 row_shr:4 row_mask:0xf bank_mask:0x8
v_mfma_f32_16x16x32_bf16 v[48:51],v[216:219],v[28:31],v[48:51]
v_mov_b32_dpp v34,v44 quad_perm:[0,1,2,3] row_mask:0xf bank_mask:0x8
v_mov_b32_dpp v35,v45 quad_perm:[0,1,2,3] row_mask:0xf bank_mask:0x8
v_mfma_f32_16x16x32_bf16 v[52:55],v[232:235],v[28:31],v[52:55]
v_mov_b32_dpp v20,v46 quad_perm:[0,1,2,3] row_mask:0xf bank_mask:0x1
v_mov_b32_dpp v21,v47 quad_perm:[0,1,2,3] row_mask:0xf bank_mask:0x1
v_mfma_f32_16x16x32_bf16 v[48:51],v[220:223],v[32:35],v[48:51]
v_mfma_f32_16x16x32_bf16 v[52:55],v[236:239],v[32:35],v[52:55]
ds_write_b32 v1,v38
s_waitcnt lgkmcnt(0)
s_barrier
ds_read_b32 v38,v2
v_mfma_f32_16x16x16_bf16 v[56:59],v[16:17],v[20:21],v[56:59]
v_mov_b32_dpp v24,v46 row_shr:4 row_mask:0xf bank_mask:0x2
v_mov_b32_dpp v25,v47 row_shr:4 row_mask:0xf bank_mask:0x2
v_mfma_f32_16x16x16_bf16 v[48:51],v[240:241],v[20:21],v[48:51]
v_mov_b32_dpp v28,v46 row_shr:8 row_mask:0xf bank_mask:0x4
v_mov_b32_dpp v29,v47 row_shr:8 row_mask:0xf bank_mask:0x4
v_mfma_f32_16x16x16_bf16 v[52:55],v[248:249],v[20:21],v[52:55]
v_mov_b32_dpp v32,v46 row_shr:12 row_mask:0xf bank_mask:0x8
v_mov_b32_dpp v33,v47 row_shr:12 row_mask:0xf bank_mask:0x8
v_mfma_f32_16x16x16_bf16 v[48:51],v[242:243],v[24:25],v[48:51]
v_mfma_f32_16x16x16_bf16 v[52:55],v[250:251],v[24:25],v[52:55]
v_mfma_f32_16x16x16_bf16 v[48:51],v[244:245],v[28:29],v[48:51]
s_waitcnt lgkmcnt(0)
v_max_f32_dpp v60,v38,v38 quad_perm:[1,0,3,2] row_mask:15 bank_mask:15
v_mfma_f32_16x16x16_bf16 v[52:55],v[252:253],v[28:29],v[52:55]
v_mfma_f32_16x16x16_bf16 v[48:51],v[246:247],v[32:33],v[48:51]
v_max_f32_dpp v60,v60,v60 quad_perm:[2,3,0,1] row_mask:15 bank_mask:15
v_sub_f32 v61,v38,v60
v_mfma_f32_16x16x16_bf16 v[52:55],v[254:255],v[32:33],v[52:55]
v_exp_f32 v61,v61
s_mov_b32 exec_lo,0xf000f
s_mov_b32 exec_hi,0xf000f
ds_write_b32 v1,v56 offset:4
s_mov_b64 exec,-1
ds_write_b128 v7,v[48:51] offset:0
s_nop 1
ds_write_b128 v7,v[52:55] offset:16
s_waitcnt lgkmcnt(0)
s_barrier
ds_read_b32 v39,v2 offset:4
ds_read_b64 v[48:49],v0 offset:0
ds_read_b64 v[50:51],v0 offset:2112
ds_read_b64 v[52:53],v0 offset:4224
ds_read_b64 v[54:55],v0 offset:6336
s_waitcnt lgkmcnt(4)
v_mul_f32 v58,v61,v39
s_waitcnt lgkmcnt(0)
v_mul_f32_dpp v44,v61,v48 quad_perm:[0,0,0,0] row_mask:15 bank_mask:15
v_mul_f32_dpp v45,v61,v49 quad_perm:[0,0,0,0] row_mask:15 bank_mask:15
v_add_f32_dpp v58,v58,v58 quad_perm:[1,0,3,2] row_mask:15 bank_mask:15
v_fmac_f32_dpp v44,v61,v50 quad_perm:[1,1,1,1] row_mask:15 bank_mask:15
v_fmac_f32_dpp v45,v61,v51 quad_perm:[1,1,1,1] row_mask:15 bank_mask:15
v_add_f32_dpp v58,v58,v58 quad_perm:[2,3,0,1] row_mask:15 bank_mask:15
v_rcp_f32 v38,v58
v_log_f32 v58,v58
v_fmac_f32_dpp v44,v61,v52 quad_perm:[2,2,2,2] row_mask:15 bank_mask:15
v_fmac_f32_dpp v45,v61,v53 quad_perm:[2,2,2,2] row_mask:15 bank_mask:15
v_fmac_f32_dpp v44,v61,v54 quad_perm:[3,3,3,3] row_mask:15 bank_mask:15
v_fmac_f32_dpp v45,v61,v55 quad_perm:[3,3,3,3] row_mask:15 bank_mask:15
v_add_f32 v60,v60,v58
v_mul_f32 v44,v44,v38
v_mul_f32 v45,v45,v38
v_cvt_pk_bf16_f32 v44,v44,v45
s_mov_b32 s94,s57
s_add_u32 s95,s94,s76
s_cmp_lg_u32 s69,0
s_cbranch_scc0 Ls_356
buffer_store_dword v44,v36,s[12:15],s94 offen
s_mov_b32 exec_lo,1
s_mov_b32 exec_hi,0
buffer_store_dword v60,v3,s[12:15],s95 offen
Ls_357:
s_mov_b64 exec,-1
s_cmp_lt_u32 s47,16
s_cbranch_scc1 Le_358
s_and_b32 s47,s47,1
s_mov_b32 s49,0x40000000
s_nop 7
s_branch L_back2
Le_358:
s_add_u32 s47,s47,1
s_mov_b32 s58,7
s_add_u32 s49,s80,0x1e000
s_mov_b32 s57,s55
s_cmp_eq_u32 s47,2
s_cbranch_scc1 L_ep2
s_cmp_eq_u32 s47,3
s_cbranch_scc1 L_attend
s_mov_b32 s47,2
s_mov_b32 s57,s53
s_branch L_ep0
L_attend:
s_endpgm
Lf_150:
s_nop 7
v_lshrrev_b32 v21,2,v3
v_and_b32 v21,12,v21
v_and_b32 v20,64,v3
v_lshl_add_u32 v21,v20,1,v21
Lc_152:
buffer_load_dword v20,v21,s[40:43],0 offen offset:32 sc1
s_waitcnt vmcnt(0)
v_readlane_b32 s72,v20,s66
s_nop 1
s_cmp_lg_u32 s72,0
s_cbranch_scc1 Lo_153
s_cmp_eq_u32 s70,0
s_cbranch_scc1 Lo_153
s_sub_u32 s70,s70,1
s_sleep 6
s_nop 11
s_branch Lc_152
Lo_153:
s_cmp_eq_u32 s72,2
s_cselect_b32 s69,1,0
v_cmp_eq_u32 vcc,0,v20
s_nop 0
s_cmp_eq_u64 vcc,0
s_cselect_b32 s47,17,16
v_mov_b64 v[20:21],0
buffer_load_dwordx4 a[100:103],v3,s[12:15],s80 offen sc1
s_nop 3
s_branch Lf_151
Ls_156:
buffer_store_dword v40,v36,s[12:15],s94 offen sc1
s_mov_b32 exec_lo,1
s_mov_b32 exec_hi,0
buffer_store_dword v60,v3,s[12:15],s95 offen sc1
s_nop 1
s_branch Ls_157
Lr_161:
s_cmp_eq_u32 s70,0
s_cbranch_scc1 Lo_160
s_sub_u32 s70,s70,1
s_sleep 8
buffer_load_dwordx4 v[56:59],v3,s[12:15],s49 offen offset:0 sc1
s_waitcnt vmcnt(0)
s_branch Lc_159
Lf_163:
s_nop 7
s_branch L_fast2
Ls_169:
buffer_store_dword v52,v36,s[12:15],s94 offen sc1
s_mov_b32 exec_lo,1
s_mov_b32 exec_hi,0
buffer_store_dword v60,v3,s[12:15],s95 offen sc1
s_nop 1
s_branch Ls_170
Lg_171:
s_cmp_lg_u32 s47,0
s_cbranch_scc1 Lg_172
v_lshrrev_b32 v45,2,v3
v_and_b32 v45,12,v45
v_and_b32 v44,64,v3
v_lshl_add_u32 v45,v44,1,v45
Lc_173:
buffer_load_dword v44,v45,s[40:43],0 offen offset:32 sc1
s_waitcnt vmcnt(0)
v_readlane_b32 s72,v44,s66
s_nop 1
v_cmp_eq_u32 vcc,0,v44
s_cbranch_vccz Lo_174
s_cmp_eq_u32 s70,0
s_cbranch_scc1 Lo_174
s_sub_u32 s70,s70,1
s_sleep 6
s_nop 11
s_branch Lc_173
Lo_174:
s_nop 3
s_branch Lg_172
Lr_178:
s_cmp_eq_u32 s70,0
s_cbranch_scc1 Lo_177
s_sub_u32 s70,s70,1
s_sleep 8
buffer_load_dwordx4 v[40:43],v3,s[12:15],s48 offen offset:0 sc1
s_waitcnt vmcnt(0)
s_branch Lc_176
Lf_182:
s_nop 7
v_lshrrev_b32 v21,2,v3
v_and_b32 v21,12,v21
v_and_b32 v20,64,v3
v_lshl_add_u32 v21,v20,1,v21
Lc_184:
buffer_load_dword v20,v21,s[40:43],0 offen offset:32 sc1
s_waitcnt vmcnt(0)
v_readlane_b32 s72,v20,s66
s_nop 1
s_cmp_lg_u32 s72,0
s_cbranch_scc1 Lo_185
s_cmp_eq_u32 s70,0
s_cbranch_scc1 Lo_185
s_sub_u32 s70,s70,1
s_sleep 6
s_nop 11
s_branch Lc_184
Lo_185:
s_cmp_eq_u32 s72,2
s_cselect_b32 s69,1,0
v_cmp_eq_u32 vcc,0,v20
s_nop 0
s_cmp_eq_u64 vcc,0
s_cselect_b32 s47,17,16
v_mov_b64 v[20:21],0
buffer_load_dwordx4 a[164:167],v3,s[12:15],s80 offen sc1
s_nop 3
s_branch Lf_183
Ls_188:
buffer_store_dword v40,v36,s[12:15],s94 offen sc1
s_mov_b32 exec_lo,1
s_mov_b32 exec_hi,0
buffer_store_dword v60,v3,s[12:15],s95 offen sc1
s_nop 1
s_branch Ls_189
Lr_193:
s_cmp_eq_u32 s70,0
s_cbranch_scc1 Lo_192
s_sub_u32 s70,s70,1
s_sleep 8
buffer_load_dwordx4 v[56:59],v3,s[12:15],s49 offen offset:0 sc1
s_waitcnt vmcnt(0)
s_branch Lc_191
Lf_195:
s_nop 7
s_branch L_fast0
Ls_201:
buffer_store_dword v52,v36,s[12:15],s94 offen sc1
s_mov_b32 exec_lo,1
s_mov_b32 exec_hi,0
buffer_store_dword v60,v3,s[12:15],s95 offen sc1
s_nop 1
s_branch Ls_202
Lg_203:
s_cmp_lg_u32 s47,0
s_cbranch_scc1 Lg_204
v_lshrrev_b32 v45,2,v3
v_and_b32 v45,12,v45
v_and_b32 v44,64,v3
v_lshl_add_u32 v45,v44,1,v45
Lc_205:
buffer_load_dword v44,v45,s[40:43],0 offen offset:32 sc1
s_waitcnt vmcnt(0)
v_readlane_b32 s72,v44,s66
s_nop 1
v_cmp_eq_u32 vcc,0,v44
s_cbranch_vccz Lo_206
s_cmp_eq_u32 s70,0
s_cbranch_scc1 Lo_206
s_sub_u32 s70,s70,1
s_sleep 6
s_nop 11
s_branch Lc_205
Lo_206:
s_nop 3
s_branch Lg_204
Lr_210:
s_cmp_eq_u32 s70,0
s_cbranch_scc1 Lo_209
s_sub_u32 s70,s70,1
s_sleep 8
buffer_load_dwordx4 v[40:43],v3,s[12:15],s48 offen offset:0 sc1
s_waitcnt vmcnt(0)
s_branch Lc_208
Lf_214:
s_nop 7
v_lshrrev_b32 v21,2,v3
v_and_b32 v21,12,v21
v_and_b32 v20,64,v3
v_lshl_add_u32 v21,v20,1,v21
Lc_216:
buffer_load_dword v20,v21,s[40:43],0 offen offset:32 sc1
s_waitcnt vmcnt(0)
v_readlane_b32 s72,v20,s66
s_nop 1
s_cmp_lg_u32 s72,0
s_cbranch_scc1 Lo_217
s_cmp_eq_u32 s70,0
s_cbranch_scc1 Lo_217
s_sub_u32 s70,s70,1
s_sleep 6
s_nop 11
s_branch Lc_216
Lo_217:
s_cmp_eq_u32 s72,2
s_cselect_b32 s69,1,0
v_cmp_eq_u32 vcc,0,v20
s_nop 0
s_cmp_eq_u64 vcc,0
s_cselect_b32 s47,17,16
v_mov_b64 v[20:21],0
buffer_load_dwordx4 a[36:39],v3,s[12:15],s80 offen sc1
s_nop 3
s_branch Lf_215
Ls_220:
buffer_store_dword v40,v36,s[12:15],s94 offen sc1
s_mov_b32 exec_lo,1
s_mov_b32 exec_hi,0
buffer_store_dword v60,v3,s[12:15],s95 offen sc1
s_nop 1
s_branch Ls_221
Lr_225:
s_cmp_eq_u32 s70,0
s_cbranch_scc1 Lo_224
s_sub_u32 s70,s70,1
s_sleep 8
buffer_load_dwordx4 v[56:59],v3,s[12:15],s49 offen offset:0 sc1
s_waitcnt vmcnt(0)
s_branch Lc_223
Lf_227:
s_nop 7
s_branch L_fast1
Ls_233:
buffer_store_dword v52,v36,s[12:15],s94 offen sc1
s_mov_b32 exec_lo,1
s_mov_b32 exec_hi,0
buffer_store_dword v60,v3,s[12:15],s95 offen sc1
s_nop 1
s_branch Ls_234
Lg_235:
s_cmp_lg_u32 s47,0
s_cbranch_scc1 Lg_236
v_lshrrev_b32 v45,2,v3
v_and_b32 v45,12,v45
v_and_b32 v44,64,v3
v_lshl_add_u32 v45,v44,1,v45
Lc_237:
buffer_load_dword v44,v45,s[40:43],0 offen offset:32 sc1
s_waitcnt vmcnt(0)
v_readlane_b32 s72,v44,s66
s_nop 1
v_cmp_eq_u32 vcc,0,v44
s_cbranch_vccz Lo_238
s_cmp_eq_u32 s70,0
s_cbranch_scc1 Lo_238
s_sub_u32 s70,s70,1
s_sleep 6
s_nop 11
s_branch Lc_237
Lo_238:
s_nop 3
s_branch Lg_236
Lr_242:
s_cmp_eq_u32 s70,0
s_cbranch_scc1 Lo_241
s_sub_u32 s70,s70,1
s_sleep 8
buffer_load_dwordx4 v[40:43],v3,s[12:15],s48 offen offset:0 sc1
s_waitcnt vmcnt(0)
s_branch Lc_240
Lr_343:
s_cmp_eq_u32 s70,0
s_cbranch_scc1 Lo_342
s_sub_u32 s70,s70,1
buffer_load_dwordx4 v[44:47],v3,s[12:15],s49 offen offset:0 sc1
s_waitcnt vmcnt(0)
s_branch Lc_341
Ls_344:
buffer_store_dword v44,v36,s[12:15],s94 offen sc1
s_mov_b32 exec_lo,1
s_mov_b32 exec_hi,0
buffer_store_dword v60,v3,s[12:15],s95 offen sc1
s_nop 1
s_branch Ls_345
Lr_349:
s_cmp_eq_u32 s70,0
s_cbranch_scc1 Lo_348
s_sub_u32 s70,s70,1
buffer_load_dwordx4 v[44:47],v3,s[12:15],s49 offen offset:0 sc1
s_waitcnt vmcnt(0)
s_branch Lc_347
Ls_350:
buffer_store_dword v44,v36,s[12:15],s94 offen sc1
s_mov_b32 exec_lo,1
s_mov_b32 exec_hi,0
buffer_store_dword v60,v3,s[12:15],s95 offen sc1
s_nop 1
s_branch Ls_351
Lr_355:
s_cmp_eq_u32 s70,0
s_cbranch_scc1 Lo_354
s_sub_u32 s70,s70,1
buffer_load_dwordx4 v[44:47],v3,s[12:15],s49 offen offset:0 sc1
s_waitcnt vmcnt(0)
s_branch Lc_353
Ls_356:
buffer_store_dword v44,v36,s[12:15],s94 offen sc1
s_mov_b32 exec_lo,1
s_mov_b32 exec_hi,0
buffer_store_dword v60,v3,s[12:15],s95 offen sc1
s_nop 1
s_branch Ls_357
L_chain:
s_sub_u32 s99,s67,24
s_lshl_b32 s98,s99,2
s_add_u32 s98,s98,s68
s_mov_b32 s32,s44
s_mov_b32 s33,s45
s_mov_b32 s34,0x2000
s_mov_b32 s35,0x20000
s_mov_b32 s16,s50
s_mov_b32 s17,s51
s_mov_b32 s18,0x400000
s_mov_b32 s19,0x20000
v_lshl_add_u32 v24,v1,10,v4
s_lshl_b32 s73,s68,8
v_add_u32 v24,s73,v24
v_mov_b32 v8,0x3f803f80
v_mov_b32 v9,0x3f803f80
v_mov_b32 v10,0x3f803f80
v_mov_b32 v11,0x3f803f80
v_mov_b32 v12,0x3f803f80
v_mov_b32 v13,0x3f803f80
v_mov_b32 v14,0x3f803f80
v_mov_b32 v15,0x3f803f80
v_mov_b32 v16,0x3f803f80
v_mov_b32 v17,0x3f803f80
v_mov_b32 v18,0x3f803f80
v_mov_b32 v19,0x3f803f80
v_mov_b32 v20,0x3f803f80
v_mov_b32 v21,0x3f803f80
v_mov_b32 v22,0x3f803f80
v_mov_b32 v23,0x3f803f80
s_mov_b32 exec_lo,0xff00ff
s_mov_b32 exec_hi,0xff00ff
buffer_load_dwordx4 v[8:11],v24,s[32:35],0 offen offset:0
buffer_load_dwordx4 v[12:15],v24,s[32:35],0 offen offset:64
buffer_load_dwordx4 v[16:19],v24,s[32:35],0 offen offset:128
buffer_load_dwordx4 v[20:23],v24,s[32:35],0 offen offset:192
s_mov_b64 exec,-1
s_lshl_b32 s94,s68,7
s_lshl_b32 s95,s66,10
s_lshl_b32 s73,s99,7
s_add_u32 s95,s95,s73
s_lshl_b32 s96,s68,14
s_add_u32 s96,s96,0x4000
s_mul_i32 s72,s94,0x2000
s_add_u32 s72,s72,s95
v_lshrrev_b32 v6,3,v0
v_mul_u32_u24 v6,0x2000,v6
v_and_b32 v7,7,v0
v_lshl_add_u32 v6,v7,4,v6
s_add_u32 m0,s96,0
s_nop 0
buffer_load_dwordx4 v6,s[16:19],s72 offen lds
s_add_u32 s72,s72,0x10000
s_add_u32 m0,s96,0x400
s_nop 0
buffer_load_dwordx4 v6,s[16:19],s72 offen lds
s_add_u32 s72,s72,0x10000
s_add_u32 m0,s96,0x800
s_nop 0
buffer_load_dwordx4 v6,s[16:19],s72 offen lds
s_add_u32 s72,s72,0x10000
s_add_u32 m0,s96,0xc00
s_nop 0
buffer_load_dwordx4 v6,s[16:19],s72 offen lds
s_add_u32 s72,s72,0x10000
s_add_u32 m0,s96,0x1000
s_nop 0
buffer_load_dwordx4 v6,s[16:19],s72 offen lds
s_add_u32 s72,s72,0x10000
s_add_u32 m0,s96,0x1400
s_nop 0
buffer_load_dwordx4 v6,s[16:19],s72 offen lds
s_add_u32 s72,s72,0x10000
s_add_u32 m0,s96,0x1800
s_nop 0
buffer_load_dwordx4 v6,s[16:19],s72 offen lds
s_add_u32 s72,s72,0x10000
s_add_u32 m0,s96,0x1c00
s_nop 0
buffer_load_dwordx4 v6,s[16:19],s72 offen lds
s_add_u32 s72,s72,0x10000
s_add_u32 m0,s96,0x2000
s_nop 0
buffer_load_dwordx4 v6,s[16:19],s72 offen lds
s_add_u32 s72,s72,0x10000
s_add_u32 m0,s96,0x2400
s_nop 0
buffer_load_dwordx4 v6,s[16:19],s72 offen lds
s_add_u32 s72,s72,0x10000
s_add_u32 m0,s96,0x2800
s_nop 0
buffer_load_dwordx4 v6,s[16:19],s72 offen lds
s_add_u32 s72,s72,0x10000
s_add_u32 m0,s96,0x2c00
s_nop 0
buffer_load_dwordx4 v6,s[16:19],s72 offen lds
s_add_u32 s72,s72,0x10000
s_add_u32 m0,s96,0x3000
s_nop 0
buffer_load_dwordx4 v6,s[16:19],s72 offen lds
s_add_u32 s72,s72,0x10000
s_add_u32 m0,s96,0x3400
s_nop 0
buffer_load_dwordx4 v6,s[16:19],s72 offen lds
s_add_u32 s72,s72,0x10000
s_add_u32 m0,s96,0x3800
s_nop 0
buffer_load_dwordx4 v6,s[16:19],s72 offen lds
s_add_u32 s72,s72,0x10000
s_add_u32 m0,s96,0x3c00
s_nop 0
buffer_load_dwordx4 v6,s[16:19],s72 offen lds
v_mov_b32 v28,-1
v_mov_b32 v29,-1
v_mov_b32 v30,-1
v_mov_b32 v31,-1
s_mul_i32 s82,s66,0x6200
s_mul_i32 s73,s98,0x310
s_add_u32 s82,s82,s73
s_add_u32 s72,s82,0x1b7000
s_mov_b32 exec_lo,-1
s_mov_b32 exec_hi,0x1ffff
buffer_store_dwordx4 v[28:31],v3,s[12:15],s72 offen sc1
s_mov_b64 exec,-1
s_lshl_b32 s72,s66,5
s_add_u32 s72,s72,s98
s_mul_i32 s72,s72,0x1b10
s_add_u32 s72,s72,0x6000
buffer_store_dwordx4 v[28:31],v3,s[12:15],s72 offen offset:0 sc1
buffer_store_dwordx4 v[28:31],v3,s[12:15],s72 offen offset:1024 sc1
buffer_store_dwordx4 v[28:31],v3,s[12:15],s72 offen offset:2048 sc1
buffer_store_dwordx4 v[28:31],v3,s[12:15],s72 offen offset:3072 sc1
s_add_u32 s72,s72,0x1000
buffer_store_dwordx4 v[28:31],v3,s[12:15],s72 offen offset:0 sc1
buffer_store_dwordx4 v[28:31],v3,s[12:15],s72 offen offset:1024 sc1
s_mov_b32 exec_lo,-1
s_mov_b32 exec_hi,0x1ffff
buffer_store_dwordx4 v[28:31],v3,s[12:15],s72 offen offset:2048 sc1
s_mov_b64 exec,-1
s_mov_b32 s20,s52
s_mov_b32 s21,s53
s_mov_b32 s22,0x400000
s_mov_b32 s23,0x20000
s_mov_b32 s24,s56
s_mov_b32 s25,s57
s_mov_b32 s26,0x1c0000
s_mov_b32 s27,0x20000
s_mov_b32 s28,s58
s_mov_b32 s29,s59
s_mov_b32 s30,0x1c0000
s_mov_b32 s31,0x20000
s_mov_b32 s36,s60
s_mov_b32 s37,s61
s_mov_b32 s38,0x2000
s_mov_b32 s39,0x20000
v_mov_b32 v25,1.0
v_mov_b32 v36,0x3f803f80
v_mov_b32 v37,0x3f803f80
v_mov_b32 v38,0x3f803f80
v_mov_b32 v39,0x3f803f80
v_lshrrev_b32 v40,2,v1
v_and_b32 v41,3,v1
s_lshl_b32 s73,s68,2
v_add_u32 v26,s73,v3
s_lshl_b32 s73,s68,10
v_add_u32 v42,s73,v3
s_lshl_b32 s72,s98,9
s_lshl_b32 s73,s66,6
s_add_u32 s72,s72,s73
v_add_u32 v27,s72,v4
v_lshrrev_b32 v7,3,v1
v_lshlrev_b32 v7,5,v7
v_and_b32 v5,1,v1
v_lshl_add_u32 v7,v5,4,v7
v_and_b32 v5,6,v1
v_lshl_add_u32 v7,v5,1,v7
v_add_u32 v43,s72,v7
v_lshrrev_b32 v7,1,v2
v_lshlrev_b32 v7,9,v7
v_and_b32 v5,1,v2
v_lshl_add_u32 v7,v5,5,v7
v_lshrrev_b32 v5,1,v1
v_lshl_add_u32 v7,v5,6,v7
v_and_b32 v5,1,v1
v_lshl_add_u32 v44,v5,4,v7
v_lshlrev_b32 v32,1,v1
v_lshlrev_b32 v33,6,v40
v_lshl_add_u32 v33,v41,2,v33
v_add_u32 v33,v33,v4
s_mul_i32 s75,s66,0x6200
s_lshl_b32 s73,s68,7
s_add_u32 s76,s75,s73
s_add_u32 s76,s76,0x6000
s_mul_i32 s73,s68,0x1800
s_add_u32 s75,s75,s73
v_lshlrev_b32 v46,3,v4
v_lshl_add_u32 v46,v1,4,v46
s_lshl_b32 s72,s66,9
s_lshl_b32 s77,s68,12
s_add_u32 s77,s77,0x22000
s_add_u32 s78,s72,0xa2000
s_lshl_b32 s73,s99,6
s_add_u32 s79,s78,s73
s_lshl_b32 s73,s68,5
s_add_u32 s79,s79,s73
s_lshl_b32 s73,s98,5
s_add_u32 s81,s80,s73
s_lshr_b32 s83,s98,1
s_lshl_b32 s83,s83,10
s_add_u32 s83,s83,0x82000
s_mov_b32 s86,0xaaaaaaaa
s_mov_b32 s87,0xaaaaaaaa
v_lshl_add_u32 v7,v2,3,v40
v_lshlrev_b32 v7,7,v7
v_lshl_add_u32 v7,v41,3,v7
s_lshl_b32 s72,s68,14
s_add_u32 s72,s72,0x4000
v_add_u32 v47,s72,v7
s_waitcnt vmcnt(8)
ds_read_b64_tr_b16 a[0:1],v47 offset:0
ds_read_b64_tr_b16 a[2:3],v47 offset:512
ds_read_b64_tr_b16 a[4:5],v47 offset:4096
ds_read_b64_tr_b16 a[6:7],v47 offset:4608
ds_read_b64_tr_b16 a[8:9],v47 offset:8192
ds_read_b64_tr_b16 a[10:11],v47 offset:8704
ds_read_b64_tr_b16 a[12:13],v47 offset:12288
ds_read_b64_tr_b16 a[14:15],v47 offset:12800
ds_read_b64_tr_b16 a[16:17],v47 offset:32
ds_read_b64_tr_b16 a[18:19],v47 offset:544
ds_read_b64_tr_b16 a[20:21],v47 offset:4128
ds_read_b64_tr_b16 a[22:23],v47 offset:4640
ds_read_b64_tr_b16 a[24:25],v47 offset:8224
ds_read_b64_tr_b16 a[26:27],v47 offset:8736
ds_read_b64_tr_b16 a[28:29],v47 offset:12320
ds_read_b64_tr_b16 a[30:31],v47 offset:12832
ds_read_b64_tr_b16 a[32:33],v47 offset:64
ds_read_b64_tr_b16 a[34:35],v47 offset:576
ds_read_b64_tr_b16 a[36:37],v47 offset:4160
ds_read_b64_tr_b16 a[38:39],v47 offset:4672
ds_read_b64_tr_b16 a[40:41],v47 offset:8256
ds_read_b64_tr_b16 a[42:43],v47 offset:8768
ds_read_b64_tr_b16 a[44:45],v47 offset:12352
ds_read_b64_tr_b16 a[46:47],v47 offset:12864
ds_read_b64_tr_b16 a[48:49],v47 offset:96
ds_read_b64_tr_b16 a[50:51],v47 offset:608
ds_read_b64_tr_b16 a[52:53],v47 offset:4192
ds_read_b64_tr_b16 a[54:55],v47 offset:4704
ds_read_b64_tr_b16 a[56:57],v47 offset:8288
ds_read_b64_tr_b16 a[58:59],v47 offset:8800
ds_read_b64_tr_b16 a[60:61],v47 offset:12384
ds_read_b64_tr_b16 a[62:63],v47 offset:12896
v_lshlrev_b32 v48,2,v2
v_sub_u32 v48,v1,v48
v_lshrrev_b32 v49,1,v3
v_mfma_f32_16x16x32_bf16 v[72:75],v[8:11],v[8:11],0
v_mfma_f32_16x16x32_bf16 v[72:75],v[12:15],v[12:15],v[72:75]
v_mfma_f32_16x16x32_bf16 v[72:75],v[16:19],v[16:19],v[72:75]
v_mfma_f32_16x16x32_bf16 v[72:75],v[20:23],v[20:23],v[72:75]
v_mfma_f32_16x16x32_bf16 v[68:71],v[36:39],v[8:11],0
v_mfma_f32_16x16x32_bf16 v[68:71],v[36:39],v[12:15],v[68:71]
v_mfma_f32_16x16x32_bf16 v[68:71],v[36:39],v[16:19],v[68:71]
v_mfma_f32_16x16x32_bf16 v[68:71],v[36:39],v[20:23],v[68:71]
s_waitcnt lgkmcnt(0)
v_mfma_f32_16x16x32_bf16 v[52:55],a[0:3],v[8:11],0
v_mfma_f32_16x16x32_bf16 v[52:55],a[4:7],v[12:15],v[52:55]
v_mfma_f32_16x16x32_bf16 v[52:55],a[8:11],v[16:19],v[52:55]
v_mfma_f32_16x16x32_bf16 v[52:55],a[12:15],v[20:23],v[52:55]
v_mov_b32 v51,0
v_cmp_eq_u32 vcc,0,v48
s_nop 1
v_cndmask_b32 v51,v51,v72,vcc
v_cmp_eq_u32 vcc,1,v48
s_nop 1
v_cndmask_b32 v51,v51,v73,vcc
v_cmp_eq_u32 vcc,2,v48
s_nop 1
v_cndmask_b32 v51,v51,v74,vcc
v_cmp_eq_u32 vcc,3,v48
s_nop 1
v_cndmask_b32 v51,v51,v75,vcc
v_mov_b32 v50,v68
v_mov_b32 v78,v51
s_nop 1
v_permlane16_swap_b32 v51,v78
v_add_f32 v51,v51,v78
v_mov_b32 v78,v51
s_nop 1
v_permlane32_swap_b32 v51,v78
v_add_f32 v51,v51,v78
v_mfma_f32_16x16x32_bf16 v[56:59],a[16:19],v[8:11],0
v_mfma_f32_16x16x32_bf16 v[56:59],a[20:23],v[12:15],v[56:59]
v_mfma_f32_16x16x32_bf16 v[56:59],a[24:27],v[16:19],v[56:59]
v_mfma_f32_16x16x32_bf16 v[56:59],a[28:31],v[20:23],v[56:59]
v_mfma_f32_16x16x32_bf16 v[60:63],a[32:35],v[8:11],0
v_mfma_f32_16x16x32_bf16 v[60:63],a[36:39],v[12:15],v[60:63]
v_mfma_f32_16x16x32_bf16 v[60:63],a[40:43],v[16:19],v[60:63]
v_mfma_f32_16x16x32_bf16 v[60:63],a[44:47],v[20:23],v[60:63]
v_mfma_f32_16x16x32_bf16 v[64:67],a[48:51],v[8:11],0
v_mfma_f32_16x16x32_bf16 v[64:67],a[52:55],v[12:15],v[64:67]
v_mfma_f32_16x16x32_bf16 v[64:67],a[56:59],v[16:19],v[64:67]
v_mfma_f32_16x16x32_bf16 v[64:67],a[60:63],v[20:23],v[64:67]
s_lshl_b32 s72,s68,9
s_add_u32 s72,s72,0x23000
v_add_u32 v77,s72,v49
ds_write_b64 v77,v[50:51]
ds_write_b128 v42,v[52:55] offset:0
ds_write_b128 v42,v[56:59] offset:4096
ds_write_b128 v42,v[60:63] offset:8192
s_nop 0
ds_write_b128 v42,v[64:67] offset:12288
s_waitcnt lgkmcnt(0)
s_barrier
v_add_u32 v77,0x23000,v49
s_lshl_b32 s72,s68,12
v_add_u32 v76,s72,v3
ds_read_b64 v[78:79],v77 offset:0
ds_read_b64 v[96:97],v77 offset:512
ds_read_b64 v[98:99],v77 offset:1024
ds_read_b64 v[100:101],v77 offset:1536
ds_read_b128 v[80:83],v76 offset:0
ds_read_b128 v[84:87],v76 offset:1024
ds_read_b128 v[88:91],v76 offset:2048
ds_read_b128 v[92:95],v76 offset:3072
s_waitcnt lgkmcnt(4)
v_add_f32 v78,v78,v96
v_add_f32 v98,v98,v100
v_add_f32 v78,v78,v98
v_add_f32 v79,v79,v97
v_add_f32 v99,v99,v101
v_add_f32 v79,v79,v99
v_mul_f32 v78,0x3b000000,v78
v_mul_f32 v79,0x3b000000,v79
v_fma_f32 v79,-v78,v78,v79
v_max_f32 v79,0,v79
v_add_f32 v79,0x3727c5ac,v79
v_rsq_f32 v79,v79
v_sub_f32 v78,0,v78
s_waitcnt lgkmcnt(0)
v_add_f32 v80,v80,v84
v_add_f32 v88,v88,v92
v_add_f32 v81,v81,v85
v_add_f32 v89,v89,v93
v_add_f32 v82,v82,v86
v_add_f32 v90,v90,v94
v_add_f32 v83,v83,v87
v_add_f32 v91,v91,v95
v_add_f32 v84,v80,v88
v_add_f32 v80,v80,v88
v_add_f32 v85,v81,v89
v_add_f32 v81,v81,v89
v_add_f32 v86,v82,v90
v_add_f32 v82,v82,v90
v_add_f32 v87,v83,v91
v_add_f32 v83,v83,v91
v_fmac_f32_dpp v80,v84,v78 row_newbcast:8 row_mask:15 bank_mask:15
v_fmac_f32_dpp v81,v85,v78 row_newbcast:8 row_mask:15 bank_mask:15
v_fmac_f32_dpp v82,v86,v78 row_newbcast:8 row_mask:15 bank_mask:15
v_fmac_f32_dpp v83,v87,v78 row_newbcast:8 row_mask:15 bank_mask:15
v_mul_f32 v80,v80,v79
v_mul_f32 v81,v81,v79
v_mul_f32 v82,v82,v79
v_mul_f32 v83,v83,v79
v_cvt_pk_bf16_f32 v102,v80,v81
v_cvt_pk_bf16_f32 v103,v82,v83
v_lshrrev_b32 v50,1,v4
v_lshl_add_u32 v50,v1,13,v50
s_add_u32 s72,s81,0
s_mov_b32 exec_lo,0x70007
s_mov_b32 exec_hi,0x70007
buffer_store_dwordx2 v[102:103],v50,s[12:15],s72 offen sc1
s_mov_b64 exec,-1
s_lshl_b32 s72,s68,6
s_add_u32 s73,s72,0x25000
v_add_u32 v51,s73,v4
v_lshl_add_u32 v45,v1,2,s73
s_waitcnt vmcnt(0)
s_waitcnt lgkmcnt(0)
s_barrier
v_mov_b32 v55,0
s_cmp_eq_u32 s68,0
s_cbranch_scc0 Lw_100001
v_mov_b32 v54,s97
s_lshl_b32 s72,s66,2
s_and_b32 s73,s66,4
s_mul_i32 s73,s73,28
s_add_u32 s72,s72,s73
v_mov_b32 v55,s72
s_mov_b32 exec_lo,1
s_mov_b32 exec_hi,0
buffer_atomic_add v54,v55,s[40:43],0 offen sc0 sc1
s_mov_b64 exec,-1
s_waitcnt vmcnt(0)
v_readfirstlane_b32 s72,v54
s_nop 1
s_add_u32 s72,s72,s97
s_and_b32 s73,s72,31
s_cbranch_scc1 Lo_100003
Lo_100004:
s_lshl_b32 s73,s97,5
s_cmp_eq_u32 s72,s73
s_cselect_b32 s72,2,1
v_mov_b32 v54,s72
s_mov_b32 exec_lo,1
s_mov_b32 exec_hi,0
buffer_store_dword v54,v55,s[40:43],0 offen offset:32 sc1
s_mov_b64 exec,-1
Lo_100003:
Lw_100001:
s_lshl_b32 s94,s66,9
s_lshl_b32 s73,s68,7
s_add_u32 s94,s94,s73
s_lshl_b32 s95,s99,7
s_lshl_b32 s96,s68,14
s_add_u32 s96,s96,0x4000
s_mul_i32 s72,s94,0x400
s_add_u32 s72,s72,s95
v_lshrrev_b32 v6,3,v0
v_mul_u32_u24 v6,0x400,v6
v_and_b32 v7,7,v0
v_lshl_add_u32 v6,v7,4,v6
s_add_u32 m0,s96,0
s_nop 0
buffer_load_dwordx4 v6,s[20:23],s72 offen lds
s_add_u32 s72,s72,0x2000
s_add_u32 m0,s96,0x400
s_nop 0
buffer_load_dwordx4 v6,s[20:23],s72 offen lds
s_add_u32 s72,s72,0x2000
s_add_u32 m0,s96,0x800
s_nop 0
buffer_load_dwordx4 v6,s[20:23],s72 offen lds
s_add_u32 s72,s72,0x2000
s_add_u32 m0,s96,0xc00
s_nop 0
buffer_load_dwordx4 v6,s[20:23],s72 offen lds
s_add_u32 s72,s72,0x2000
s_add_u32 m0,s96,0x1000
s_nop 0
buffer_load_dwordx4 v6,s[20:23],s72 offen lds
s_add_u32 s72,s72,0x2000
s_add_u32 m0,s96,0x1400
s_nop 0
buffer_load_dwordx4 v6,s[20:23],s72 offen lds
s_add_u32 s72,s72,0x2000
s_add_u32 m0,s96,0x1800
s_nop 0
buffer_load_dwordx4 v6,s[20:23],s72 offen lds
s_add_u32 s72,s72,0x2000
s_add_u32 m0,s96,0x1c00
s_nop 0
buffer_load_dwordx4 v6,s[20:23],s72 offen lds
s_add_u32 s72,s72,0x2000
s_add_u32 m0,s96,0x2000
s_nop 0
buffer_load_dwordx4 v6,s[20:23],s72 offen lds
s_add_u32 s72,s72,0x2000
s_add_u32 m0,s96,0x2400
s_nop 0
buffer_load_dwordx4 v6,s[20:23],s72 offen lds
s_add_u32 s72,s72,0x2000
s_add_u32 m0,s96,0x2800
s_nop 0
buffer_load_dwordx4 v6,s[20:23],s72 offen lds
s_add_u32 s72,s72,0x2000
s_add_u32 m0,s96,0x2c00
s_nop 0
buffer_load_dwordx4 v6,s[20:23],s72 offen lds
s_add_u32 s72,s72,0x2000
s_add_u32 m0,s96,0x3000
s_nop 0
buffer_load_dwordx4 v6,s[20:23],s72 offen lds
s_add_u32 s72,s72,0x2000
s_add_u32 m0,s96,0x3400
s_nop 0
buffer_load_dwordx4 v6,s[20:23],s72 offen lds
s_add_u32 s72,s72,0x2000
s_add_u32 m0,s96,0x3800
s_nop 0
buffer_load_dwordx4 v6,s[20:23],s72 offen lds
s_add_u32 s72,s72,0x2000
s_add_u32 m0,s96,0x3c00
s_nop 0
buffer_load_dwordx4 v6,s[20:23],s72 offen lds
s_lshl_b32 s94,s68,7
s_mul_i32 s95,s66,0x1c0
s_lshl_b32 s73,s99,6
s_add_u32 s95,s95,s73
s_lshl_b32 s96,s68,13
s_add_u32 s96,s96,0x14000
s_mul_i32 s72,s94,0xe00
s_add_u32 s72,s72,s95
v_lshrrev_b32 v6,2,v0
v_mul_u32_u24 v6,0xe00,v6
v_and_b32 v7,3,v0
v_lshl_add_u32 v6,v7,4,v6
s_add_u32 m0,s96,0
s_nop 0
buffer_load_dwordx4 v6,s[24:27],s72 offen lds
s_add_u32 s72,s72,0xe000
s_add_u32 m0,s96,0x400
s_nop 0
buffer_load_dwordx4 v6,s[24:27],s72 offen lds
s_add_u32 s72,s72,0xe000
s_add_u32 m0,s96,0x800
s_nop 0
buffer_load_dwordx4 v6,s[24:27],s72 offen lds
s_add_u32 s72,s72,0xe000
s_add_u32 m0,s96,0xc00
s_nop 0
buffer_load_dwordx4 v6,s[24:27],s72 offen lds
s_add_u32 s72,s72,0xe000
s_add_u32 m0,s96,0x1000
s_nop 0
buffer_load_dwordx4 v6,s[24:27],s72 offen lds
s_add_u32 s72,s72,0xe000
s_add_u32 m0,s96,0x1400
s_nop 0
buffer_load_dwordx4 v6,s[24:27],s72 offen lds
s_add_u32 s72,s72,0xe000
s_add_u32 m0,s96,0x1800
s_nop 0
buffer_load_dwordx4 v6,s[24:27],s72 offen lds
s_add_u32 s72,s72,0xe000
s_add_u32 m0,s96,0x1c00
s_nop 0
buffer_load_dwordx4 v6,s[24:27],s72 offen lds
s_mul_i32 s94,s66,0xe0
s_mul_i32 s73,s68,56
s_add_u32 s94,s94,s73
s_lshl_b32 s95,s99,7
s_mul_i32 s96,s68,0x1c00
s_add_u32 s96,s96,0x1c000
s_mul_i32 s72,s94,0x400
s_add_u32 s72,s72,s95
v_lshrrev_b32 v6,3,v0
v_mul_u32_u24 v6,0x400,v6
v_and_b32 v7,7,v0
v_lshl_add_u32 v6,v7,4,v6
s_add_u32 m0,s96,0
s_nop 0
buffer_load_dwordx4 v6,s[28:31],s72 offen lds
s_add_u32 s72,s72,0x2000
s_add_u32 m0,s96,0x400
s_nop 0
buffer_load_dwordx4 v6,s[28:31],s72 offen lds
s_add_u32 s72,s72,0x2000
s_add_u32 m0,s96,0x800
s_nop 0
buffer_load_dwordx4 v6,s[28:31],s72 offen lds
s_add_u32 s72,s72,0x2000
s_add_u32 m0,s96,0xc00
s_nop 0
buffer_load_dwordx4 v6,s[28:31],s72 offen lds
s_add_u32 s72,s72,0x2000
s_add_u32 m0,s96,0x1000
s_nop 0
buffer_load_dwordx4 v6,s[28:31],s72 offen lds
s_add_u32 s72,s72,0x2000
s_add_u32 m0,s96,0x1400
s_nop 0
buffer_load_dwordx4 v6,s[28:31],s72 offen lds
s_add_u32 s72,s72,0x2000
s_add_u32 m0,s96,0x1800
s_nop 0
buffer_load_dwordx4 v6,s[28:31],s72 offen lds
v_lshrrev_b32 v5,1,v4
v_lshl_add_u32 v5,v1,10,v5
s_lshl_b32 s72,s98,5
buffer_load_dwordx2 v[56:57],v5,s[32:35],s72 offen
s_waitcnt vmcnt(0)
s_waitcnt lgkmcnt(0)
s_barrier
v_lshl_add_u32 v7,v2,3,v40
v_lshlrev_b32 v7,6,v7
v_lshl_add_u32 v7,v41,3,v7
s_lshl_b32 s72,s68,13
s_add_u32 s72,s72,0x14000
v_add_u32 v52,s72,v7
ds_read_b64_tr_b16 a[64:65],v52 offset:0
ds_read_b64_tr_b16 a[66:67],v52 offset:256
ds_read_b64_tr_b16 a[68:69],v52 offset:2048
ds_read_b64_tr_b16 a[70:71],v52 offset:2304
ds_read_b64_tr_b16 a[72:73],v52 offset:4096
ds_read_b64_tr_b16 a[74:75],v52 offset:4352
ds_read_b64_tr_b16 a[76:77],v52 offset:6144
ds_read_b64_tr_b16 a[78:79],v52 offset:6400
ds_read_b64_tr_b16 a[80:81],v52 offset:32
ds_read_b64_tr_b16 a[82:83],v52 offset:288
ds_read_b64_tr_b16 a[84:85],v52 offset:2080
ds_read_b64_tr_b16 a[86:87],v52 offset:2336
ds_read_b64_tr_b16 a[88:89],v52 offset:4128
ds_read_b64_tr_b16 a[90:91],v52 offset:4384
ds_read_b64_tr_b16 a[92:93],v52 offset:6176
ds_read_b64_tr_b16 a[94:95],v52 offset:6432
v_lshl_add_u32 v7,v2,3,v40
v_lshlrev_b32 v7,7,v7
v_lshl_add_u32 v7,v41,3,v7
s_lshl_b32 s72,s68,5
s_add_u32 s72,s72,0x1c000
v_add_u32 v53,s72,v7
ds_read_b64_tr_b16 a[96:97],v53 offset:0
ds_read_b64_tr_b16 a[98:99],v53 offset:512
ds_read_b64_tr_b16 a[100:101],v53 offset:4096
ds_read_b64_tr_b16 a[102:103],v53 offset:4608
ds_read_b64_tr_b16 a[104:105],v53 offset:8192
ds_read_b64_tr_b16 a[106:107],v53 offset:8704
ds_read_b64_tr_b16 a[108:109],v53 offset:12288
ds_read_b64_tr_b16 a[110:111],v53 offset:12800
ds_read_b64_tr_b16 a[112:113],v53 offset:16384
ds_read_b64_tr_b16 a[114:115],v53 offset:16896
ds_read_b64_tr_b16 a[116:117],v53 offset:20480
ds_read_b64_tr_b16 a[118:119],v53 offset:20992
ds_read_b64_tr_b16 a[120:121],v53 offset:24576
ds_read_b64_tr_b16 a[122:123],v53 offset:25088
s_cmp_eq_u32 s66,0
s_cselect_b32 s72,0xffff0000,0
v_and_b32 v59,s72,v57
v_lshlrev_b32 v58,16,v57
v_and_b32 v58,s72,v58
v_and_b32 v57,s72,v56
v_lshlrev_b32 v56,16,v56
v_and_b32 v56,s72,v56
v_lshl_add_u32 v5,v1,8,v51
s_mov_b32 exec_lo,0xff00ff
s_mov_b32 exec_hi,0xff00ff
ds_write_b128 v5,v[56:59]
s_mov_b64 exec,-1
s_waitcnt lgkmcnt(0)
v_mfma_f32_16x16x32_bf16 v[56:59],v[36:39],a[64:67],0
v_mfma_f32_16x16x32_bf16 v[56:59],v[36:39],a[68:71],v[56:59]
v_mfma_f32_16x16x32_bf16 v[56:59],v[36:39],a[72:75],v[56:59]
v_mfma_f32_16x16x32_bf16 v[56:59],v[36:39],a[76:79],v[56:59]
v_mfma_f32_16x16x32_bf16 v[60:63],v[36:39],a[80:83],0
v_mfma_f32_16x16x32_bf16 v[60:63],v[36:39],a[84:87],v[60:63]
v_mfma_f32_16x16x32_bf16 v[60:63],v[36:39],a[88:91],v[60:63]
v_mfma_f32_16x16x32_bf16 v[60:63],v[36:39],a[92:95],v[60:63]
v_mfma_f32_16x16x32_bf16 v[64:67],v[36:39],a[0:3],0
v_mfma_f32_16x16x32_bf16 v[64:67],v[36:39],a[4:7],v[64:67]
v_mfma_f32_16x16x32_bf16 v[64:67],v[36:39],a[8:11],v[64:67]
v_mfma_f32_16x16x32_bf16 v[64:67],v[36:39],a[12:15],v[64:67]
v_mfma_f32_16x16x32_bf16 v[68:71],v[36:39],a[16:19],0
v_mfma_f32_16x16x32_bf16 v[68:71],v[36:39],a[20:23],v[68:71]
v_mfma_f32_16x16x32_bf16 v[68:71],v[36:39],a[24:27],v[68:71]
v_mfma_f32_16x16x32_bf16 v[68:71],v[36:39],a[28:31],v[68:71]
v_mfma_f32_16x16x32_bf16 v[72:75],v[36:39],a[32:35],0
v_mfma_f32_16x16x32_bf16 v[72:75],v[36:39],a[36:39],v[72:75]
v_mfma_f32_16x16x32_bf16 v[72:75],v[36:39],a[40:43],v[72:75]
v_mfma_f32_16x16x32_bf16 v[72:75],v[36:39],a[44:47],v[72:75]
v_mfma_f32_16x16x32_bf16 v[76:79],v[36:39],a[48:51],0
v_mfma_f32_16x16x32_bf16 v[76:79],v[36:39],a[52:55],v[76:79]
v_mfma_f32_16x16x32_bf16 v[76:79],v[36:39],a[56:59],v[76:79]
v_mfma_f32_16x16x32_bf16 v[76:79],v[36:39],a[60:63],v[76:79]
ds_write_b32 v26,v56 offset:0
ds_write_b32 v26,v60 offset:1024
ds_write_b32 v26,v64 offset:4096
ds_write_b32 v26,v68 offset:5120
ds_write_b32 v26,v72 offset:6144
s_nop 2
ds_write_b32 v26,v76 offset:7168
s_waitcnt lgkmcnt(0)
s_barrier
ds_read_b128 v[56:59],v42
ds_read_b128 v[60:63],v42 offset:4096
s_waitcnt lgkmcnt(0)
v_add_f32 v56,v56,v57
v_add_f32 v58,v58,v59
v_add_f32 v35,v56,v58
v_add_f32 v60,v60,v61
v_add_f32 v62,v62,v63
v_add_f32 v34,v60,v62
v_mov_b32 v8,0x3f803f80
v_mov_b32 v9,0x3f803f80
v_mov_b32 v10,0x3f803f80
v_mov_b32 v11,0x3f803f80
v_mov_b32 v12,0x3f803f80
v_mov_b32 v13,0x3f803f80
v_mov_b32 v14,0x3f803f80
v_mov_b32 v15,0x3f803f80
v_mov_b32 v16,0x3f803f80
v_mov_b32 v17,0x3f803f80
v_mov_b32 v18,0x3f803f80
v_mov_b32 v19,0x3f803f80
v_mov_b32 v20,0x3f803f80
v_mov_b32 v21,0x3f803f80
v_mov_b32 v22,0x3f803f80
v_mov_b32 v23,0x3f803f80
v_lshl_add_u32 v7,v2,2,v40
v_lshlrev_b32 v7,7,v7
v_lshl_add_u32 v7,v41,3,v7
s_lshl_b32 s72,s68,14
s_add_u32 s72,s72,0x4000
v_add_u32 v47,s72,v7
ds_read_b64_tr_b16 a[124:125],v47 offset:0
ds_read_b64_tr_b16 a[126:127],v47 offset:8192
ds_read_b64_tr_b16 a[128:129],v47 offset:2048
ds_read_b64_tr_b16 a[130:131],v47 offset:10240
ds_read_b64_tr_b16 a[132:133],v47 offset:4096
ds_read_b64_tr_b16 a[134:135],v47 offset:12288
ds_read_b64_tr_b16 a[136:137],v47 offset:6144
ds_read_b64_tr_b16 a[138:139],v47 offset:14336
ds_read_b64_tr_b16 a[140:141],v47 offset:32
ds_read_b64_tr_b16 a[142:143],v47 offset:8224
ds_read_b64_tr_b16 a[144:145],v47 offset:2080
ds_read_b64_tr_b16 a[146:147],v47 offset:10272
ds_read_b64_tr_b16 a[148:149],v47 offset:4128
ds_read_b64_tr_b16 a[150:151],v47 offset:12320
ds_read_b64_tr_b16 a[152:153],v47 offset:6176
ds_read_b64_tr_b16 a[154:155],v47 offset:14368
ds_read_b64_tr_b16 a[156:157],v47 offset:64
ds_read_b64_tr_b16 a[158:159],v47 offset:8256
ds_read_b64_tr_b16 a[160:161],v47 offset:2112
ds_read_b64_tr_b16 a[162:163],v47 offset:10304
ds_read_b64_tr_b16 a[164:165],v47 offset:4160
ds_read_b64_tr_b16 a[166:167],v47 offset:12352
ds_read_b64_tr_b16 a[168:169],v47 offset:6208
ds_read_b64_tr_b16 a[170:171],v47 offset:14400
ds_read_b64_tr_b16 a[172:173],v47 offset:96
ds_read_b64_tr_b16 a[174:175],v47 offset:8288
ds_read_b64_tr_b16 a[176:177],v47 offset:2144
ds_read_b64_tr_b16 a[178:179],v47 offset:10336
ds_read_b64_tr_b16 a[180:181],v47 offset:4192
ds_read_b64_tr_b16 a[182:183],v47 offset:12384
ds_read_b64_tr_b16 a[184:185],v47 offset:6240
ds_read_b64_tr_b16 a[186:187],v47 offset:14432
s_and_b32 s72,s98,1
s_lshl_b32 s72,s72,4
v_lshlrev_b32 v5,3,v2
v_sub_u32 v5,v1,v5
v_add_u32 v5,s72,v5
v_mov_b32 v6,0x3f80
v_cmp_eq_u32 vcc,0,v5
s_nop 1
v_cndmask_b32 v56,0,v6,vcc
v_mov_b32 v6,0x3f800000
v_cmp_eq_u32 vcc,1,v5
s_nop 1
v_cndmask_b32 v56,v56,v6,vcc
v_mov_b32 v6,0x3f80
v_cmp_eq_u32 vcc,2,v5
s_nop 1
v_cndmask_b32 v57,0,v6,vcc
v_mov_b32 v6,0x3f800000
v_cmp_eq_u32 vcc,3,v5
s_nop 1
v_cndmask_b32 v57,v57,v6,vcc
v_mov_b32 v6,0x3f80
v_cmp_eq_u32 vcc,4,v5
s_nop 1
v_cndmask_b32 v58,0,v6,vcc
v_mov_b32 v6,0x3f800000
v_cmp_eq_u32 vcc,5,v5
s_nop 1
v_cndmask_b32 v58,v58,v6,vcc
v_mov_b32 v6,0x3f80
v_cmp_eq_u32 vcc,6,v5
s_nop 1
v_cndmask_b32 v59,0,v6,vcc
v_mov_b32 v6,0x3f800000
v_cmp_eq_u32 vcc,7,v5
s_nop 1
v_cndmask_b32 v59,v59,v6,vcc
buffer_load_dword v54,v55,s[40:43],0 offen offset:32 sc1
s_waitcnt vmcnt(0)
v_readfirstlane_b32 s72,v54
s_nop 1
s_or_b32 s72,s72,s68
s_cbranch_scc1 Lo_100005
s_cmp_lg_u32 s67,24
s_cbranch_scc1 Lo_100007
Lc_100006:
buffer_load_dword v54,v55,s[40:43],0 offen sc1
s_waitcnt vmcnt(0)
v_readfirstlane_b32 s72,v54
s_nop 1
s_and_b32 s73,s72,31
s_cbranch_scc0 Lo_100008
s_cmp_eq_u32 s70,0
s_cbranch_scc1 Lo_100007
s_sub_u32 s70,s70,1
s_sleep 8
s_nop 11
s_branch Lc_100006
Lo_100008:
s_lshl_b32 s73,s97,5
s_cmp_eq_u32 s72,s73
s_cselect_b32 s72,2,1
v_mov_b32 v54,s72
s_mov_b32 exec_lo,1
s_mov_b32 exec_hi,0
buffer_store_dword v54,v55,s[40:43],0 offen offset:32 sc1
s_mov_b64 exec,-1
Lo_100007:
Lo_100005:
v_lshrrev_b32 v55,2,v3
v_and_b32 v55,12,v55
v_and_b32 v54,64,v3
v_lshl_add_u32 v55,v54,1,v55
Lc_100009:
buffer_load_dword v54,v55,s[40:43],0 offen offset:32 sc1
s_waitcnt vmcnt(0)
v_readlane_b32 s72,v54,s66
s_nop 1
v_cmp_eq_u32 vcc,0,v54
s_cbranch_vccz Lo_100010
s_cmp_eq_u32 s70,0
s_cbranch_scc1 Lo_100010
s_sub_u32 s70,s70,1
s_sleep 6
s_nop 11
s_branch Lc_100009
Lo_100010:
s_cmp_eq_u32 s72,2
s_cselect_b32 s69,1,0
s_add_u32 s72,s82,0x1b7000
s_mov_b32 exec_lo,-1
s_mov_b32 exec_hi,0x1ffff
buffer_load_dwordx4 v[60:63],v3,s[12:15],s72 offen sc1
s_mov_b64 exec,-1
s_add_u32 s72,s82,0xc2000
s_mov_b32 exec_lo,-1
s_mov_b32 exec_hi,0x1ffff
buffer_load_dwordx4 v[60:63],v3,s[12:15],s72 offen sc1
s_mov_b64 exec,-1
s_add_u32 s72,s82,0xf3000
s_mov_b32 exec_lo,-1
s_mov_b32 exec_hi,0x1ffff
buffer_load_dwordx4 v[60:63],v3,s[12:15],s72 offen sc1
s_mov_b64 exec,-1
s_lshl_b32 s72,s98,13
s_add_u32 s72,s72,s80
s_add_u32 s73,s72,0x92000
s_cmp_lt_u32 s98,16
s_cselect_b32 s72,s72,s73
s_sub_u32 s73,s98,24
s_lshl_b32 s73,s73,13
s_add_u32 s73,s73,s78
s_cmp_lt_u32 s98,24
s_cselect_b32 s72,s72,s73
s_cselect_b32 s73,0,0xe00
v_lshrrev_b32 v5,9,v3
v_mul_u32_u24 v5,s73,v5
v_add_u32 v5,v5,v3
buffer_load_dwordx4 v[60:63],v5,s[12:15],s72 offen sc1
s_waitcnt vmcnt(0)
s_waitcnt lgkmcnt(0)
v_mov_b32 v72,0
v_mov_b32 v73,0
v_mov_b32 v74,0
v_mov_b32 v75,0
v_mov_b32 v76,0
v_mov_b32 v77,0
v_mov_b32 v78,0
v_mov_b32 v79,0
v_mov_b32 v80,0
v_mov_b32 v81,0
v_mov_b32 v82,0
v_mov_b32 v83,0
v_mov_b32 v84,0
v_mov_b32 v85,0
v_mov_b32 v86,0
v_mov_b32 v87,0
v_mov_b32 v5,0xf149f2ca
v_mov_b32 v136,0
v_mov_b32 v137,0
v_mov_b32 v138,0
v_mov_b32 v139,0
v_mov_b32 v140,0
v_mov_b32 v141,0
v_mov_b32 v142,0
v_mov_b32 v143,0
v_mov_b32 v144,0
v_mov_b32 v145,0
v_mov_b32 v146,0
v_mov_b32 v147,0
v_mov_b32 v148,0
v_mov_b32 v149,0
v_mov_b32 v150,0
v_mov_b32 v151,0
v_mov_b32 v7,0xf149f2ca
v_min_u32 v41,6,v1
v_lshl_add_u32 v41,v41,6,v4
s_mov_b32 s61,0x40000000
s_waitcnt vmcnt(0)
s_waitcnt lgkmcnt(0)
s_barrier
s_mov_b32 s60,0x40000000
s_mov_b32 s62,0x40000000
s_mov_b32 s53,0x40000000
s_mov_b32 s54,0x40000000
s_mov_b32 s55,0x40000000
s_mov_b32 s56,0x40000000
s_mov_b32 s57,0x40000000
s_mov_b32 s58,0x40000000
v_mov_b32 v176,0
v_mov_b32 v177,0
v_mov_b32 v178,0
v_mov_b32 v179,0
s_mov_b32 s16,0x1b7000
s_mov_b32 s17,0xc2000
s_mov_b32 s18,0xf3000
s_mov_b32 s19,0x124000
s_mov_b32 s20,0x155000
s_mov_b32 s21,0x186000
s_mov_b32 s44,0
s_add_u32 s45,s75,s16
s_add_u32 s46,s76,s16
s_mov_b32 exec_lo,0xff00ff
s_mov_b32 exec_hi,0xf000f
buffer_load_dword v5,v33,s[12:15],s46 offen offset:0 sc1
s_mov_b64 exec,-1
buffer_load_dwordx4 v[52:55],v3,s[12:15],s45 offen offset:0 sc1
buffer_load_dwordx4 v[60:63],v3,s[12:15],s45 offen offset:1024 sc1
buffer_load_dwordx4 v[64:67],v3,s[12:15],s45 offen offset:2048 sc1
buffer_load_dwordx4 v[68:71],v3,s[12:15],s45 offen offset:3072 sc1
s_add_u32 s73,s45,0x1000
s_mov_b32 exec_lo,0xff00ff
s_mov_b32 exec_hi,0xff00ff
buffer_load_dwordx4 v[72:75],v46,s[12:15],s73 offen offset:0 sc1
buffer_load_dwordx4 v[76:79],v46,s[12:15],s73 offen offset:512 sc1
buffer_load_dwordx4 v[80:83],v46,s[12:15],s73 offen offset:1024 sc1
buffer_load_dwordx4 v[84:87],v46,s[12:15],s73 offen offset:1536 sc1
s_mov_b64 exec,-1
s_waitcnt vmcnt(0)
s_nop 3
s_mul_i32 s24,s66,0x6200
s_lshr_b32 s72,s98,3
s_lshl_b32 s73,s72,7
s_add_u32 s26,s24,s73
s_add_u32 s26,s26,0x6000
s_mul_i32 s73,s72,0x1800
s_add_u32 s24,s24,s73
s_bfe_u32 s72,s98,0x20001
s_lshl_b32 s73,s72,9
s_add_u32 s25,s24,s73
s_add_u32 s25,s25,0x1000
s_lshl_b32 s73,s72,10
s_add_u32 s24,s24,s73
s_add_u32 s27,s81,0xb2000
s_lshl_b32 s72,s68,2
s_add_u32 s72,s72,0x6800
v_mov_b32 v47,s72
.p2align 6
L_loop:
s_and_b32 s51,s44,7
s_lshl_b32 s73,s44,12
s_add_u32 s49,s78,s73
s_add_u32 s50,s79,s73
s_and_b32 s73,s44,8
s_add_u32 s73,s73,s44
s_lshl_b32 s73,s73,14
s_add_u32 s47,s77,s73
s_add_u32 s48,s73,0x22000
s_lshl_b32 s73,s51,8
v_add_u32 v6,s73,v45
ds_read_b32 v116,v6
Lc_100011:
v_cmp_u_f32 vcc,v5,v5
s_cbranch_vccnz Lr_100013
Lo_100012:
v_max_f32_dpp v100,v5,v5 row_half_mirror row_mask:15 bank_mask:15
s_nop 1
v_max_f32_dpp v100,v100,v100 quad_perm:[2,3,0,1] row_mask:15 bank_mask:15
s_nop 1
v_max_f32_dpp v100,v100,v100 quad_perm:[1,0,3,2] row_mask:15 bank_mask:15
s_waitcnt vmcnt(7)
v_mfma_f32_16x16x32_bf16 v[200:203],v[52:55],a[124:127],0
v_mov_b32 v237,v100
v_mfma_f32_16x16x32_bf16 v[208:211],v[52:55],a[140:143],0
s_nop 0
v_permlane16_swap_b32 v100,v237
v_max_f32 v100,v100,v237
v_mfma_f32_16x16x32_bf16 v[216:219],v[52:55],a[156:159],0
v_mov_b32 v237,v100
v_mfma_f32_16x16x32_bf16 v[224:227],v[52:55],a[172:175],0
s_nop 0
v_permlane32_swap_b32 v100,v237
v_max_f32 v100,v100,v237
s_waitcnt vmcnt(6)
v_mfma_f32_16x16x32_bf16 v[200:203],v[60:63],a[128:131],v[200:203]
v_sub_f32 v236,v5,v100
v_exp_f32 v236,v236
v_mfma_f32_16x16x32_bf16 v[208:211],v[60:63],a[144:147],v[208:211]
s_nop 0
v_add_f32_dpp v101,v236,v236 row_half_mirror row_mask:15 bank_mask:15
v_mfma_f32_16x16x32_bf16 v[216:219],v[60:63],a[160:163],v[216:219]
s_nop 0
v_add_f32_dpp v101,v101,v101 quad_perm:[2,3,0,1] row_mask:15 bank_mask:15
v_mfma_f32_16x16x32_bf16 v[224:227],v[60:63],a[176:179],v[224:227]
s_nop 0
v_add_f32_dpp v101,v101,v101 quad_perm:[1,0,3,2] row_mask:15 bank_mask:15
s_waitcnt vmcnt(5)
v_mfma_f32_16x16x32_bf16 v[200:203],v[64:67],a[132:135],v[200:203]
v_mov_b32 v237,v101
v_mfma_f32_16x16x32_bf16 v[208:211],v[64:67],a[148:151],v[208:211]
s_nop 0
v_permlane16_swap_b32 v101,v237
v_add_f32 v101,v101,v237
v_mfma_f32_16x16x32_bf16 v[216:219],v[64:67],a[164:167],v[216:219]
v_mov_b32 v237,v101
v_mfma_f32_16x16x32_bf16 v[224:227],v[64:67],a[180:183],v[224:227]
s_nop 0
v_permlane32_swap_b32 v101,v237
v_add_f32 v101,v101,v237
s_waitcnt vmcnt(4)
v_mfma_f32_16x16x32_bf16 v[200:203],v[68:71],a[136:139],v[200:203]
v_rcp_f32 v101,v101
v_mfma_f32_16x16x32_bf16 v[208:211],v[68:71],a[152:155],v[208:211]
v_mul_f32 v236,v236,v101
v_mfma_f32_16x16x32_bf16 v[216:219],v[68:71],a[168:171],v[216:219]
v_mfma_f32_16x16x32_bf16 v[224:227],v[68:71],a[184:187],v[224:227]
s_waitcnt vmcnt(3)
v_mfma_f32_16x16x32_bf16 v[204:207],v[72:75],a[124:127],0
s_nop 0
v_mul_f32_dpp v232,v236,v200 row_newbcast:0 row_mask:15 bank_mask:15
v_fmac_f32_dpp v232,v236,v201 row_newbcast:1 row_mask:15 bank_mask:15
v_mfma_f32_16x16x32_bf16 v[212:215],v[72:75],a[140:143],0
v_fmac_f32_dpp v232,v236,v202 row_newbcast:2 row_mask:15 bank_mask:15
v_fmac_f32_dpp v232,v236,v203 row_newbcast:3 row_mask:15 bank_mask:15
v_mfma_f32_16x16x32_bf16 v[220:223],v[72:75],a[156:159],0
v_mul_f32_dpp v233,v236,v208 row_newbcast:0 row_mask:15 bank_mask:15
v_fmac_f32_dpp v233,v236,v209 row_newbcast:1 row_mask:15 bank_mask:15
v_mfma_f32_16x16x32_bf16 v[228:231],v[72:75],a[172:175],0
v_fmac_f32_dpp v233,v236,v210 row_newbcast:2 row_mask:15 bank_mask:15
v_fmac_f32_dpp v233,v236,v211 row_newbcast:3 row_mask:15 bank_mask:15
s_waitcnt vmcnt(2)
v_mfma_f32_16x16x32_bf16 v[204:207],v[76:79],a[128:131],v[204:207]
v_mul_f32_dpp v234,v236,v216 row_newbcast:0 row_mask:15 bank_mask:15
v_fmac_f32_dpp v234,v236,v217 row_newbcast:1 row_mask:15 bank_mask:15
v_mfma_f32_16x16x32_bf16 v[212:215],v[76:79],a[144:147],v[212:215]
v_fmac_f32_dpp v234,v236,v218 row_newbcast:2 row_mask:15 bank_mask:15
v_fmac_f32_dpp v234,v236,v219 row_newbcast:3 row_mask:15 bank_mask:15
v_mfma_f32_16x16x32_bf16 v[220:223],v[76:79],a[160:163],v[220:223]
v_mul_f32_dpp v235,v236,v224 row_newbcast:0 row_mask:15 bank_mask:15
v_fmac_f32_dpp v235,v236,v225 row_newbcast:1 row_mask:15 bank_mask:15
v_mfma_f32_16x16x32_bf16 v[228:231],v[76:79],a[176:179],v[228:231]
v_fmac_f32_dpp v235,v236,v226 row_newbcast:2 row_mask:15 bank_mask:15
v_fmac_f32_dpp v235,v236,v227 row_newbcast:3 row_mask:15 bank_mask:15
s_waitcnt vmcnt(1)
v_mfma_f32_16x16x32_bf16 v[204:207],v[80:83],a[132:135],v[204:207]
s_waitcnt vmcnt(0)
v_mfma_f32_16x16x32_bf16 v[204:207],v[84:87],a[136:139],v[204:207]
v_mfma_f32_16x16x32_bf16 v[212:215],v[80:83],a[148:151],v[212:215]
v_mfma_f32_16x16x32_bf16 v[212:215],v[84:87],a[152:155],v[212:215]
v_mfma_f32_16x16x32_bf16 v[220:223],v[80:83],a[164:167],v[220:223]
s_nop 4
v_fmac_f32_dpp v232,v236,v204 row_newbcast:4 row_mask:15 bank_mask:15
v_fmac_f32_dpp v232,v236,v205 row_newbcast:5 row_mask:15 bank_mask:15
v_mfma_f32_16x16x32_bf16 v[220:223],v[84:87],a[168:171],v[220:223]
v_fmac_f32_dpp v232,v236,v206 row_newbcast:6 row_mask:15 bank_mask:15
v_fmac_f32_dpp v232,v236,v207 row_newbcast:7 row_mask:15 bank_mask:15
v_mfma_f32_16x16x32_bf16 v[228:231],v[80:83],a[180:183],v[228:231]
ds_write_b32 v26,v232 offset:0
v_fmac_f32_dpp v233,v236,v212 row_newbcast:4 row_mask:15 bank_mask:15
v_mfma_f32_16x16x32_bf16 v[228:231],v[84:87],a[184:187],v[228:231]
v_fmac_f32_dpp v233,v236,v213 row_newbcast:5 row_mask:15 bank_mask:15
v_fmac_f32_dpp v233,v236,v214 row_newbcast:6 row_mask:15 bank_mask:15
v_fmac_f32_dpp v233,v236,v215 row_newbcast:7 row_mask:15 bank_mask:15
ds_write_b32 v26,v233 offset:1024
v_fmac_f32_dpp v234,v236,v220 row_newbcast:4 row_mask:15 bank_mask:15
v_fmac_f32_dpp v234,v236,v221 row_newbcast:5 row_mask:15 bank_mask:15
v_fmac_f32_dpp v234,v236,v222 row_newbcast:6 row_mask:15 bank_mask:15
v_fmac_f32_dpp v234,v236,v223 row_newbcast:7 row_mask:15 bank_mask:15
ds_write_b32 v26,v234 offset:2048
v_fmac_f32_dpp v235,v236,v228 row_newbcast:4 row_mask:15 bank_mask:15
v_fmac_f32_dpp v235,v236,v229 row_newbcast:5 row_mask:15 bank_mask:15
v_fmac_f32_dpp v235,v236,v230 row_newbcast:6 row_mask:15 bank_mask:15
v_fmac_f32_dpp v235,v236,v231 row_newbcast:7 row_mask:15 bank_mask:15
ds_write_b32 v26,v235 offset:3072
v_cmp_u_f32 vcc,v235,v235
s_cbranch_vccnz Lr_100015
Lo_100014:
s_add_u32 s73,s60,0x20000
buffer_load_dwordx4 v[184:187],v44,s[12:15],s73 offen offset:0 sc1
buffer_load_dwordx4 v[188:191],v44,s[12:15],s73 offen offset:1024 sc1
buffer_load_dwordx4 v[192:195],v44,s[12:15],s73 offen offset:2048 sc1
buffer_load_dwordx4 v[196:199],v44,s[12:15],s73 offen offset:3072 sc1
s_waitcnt lgkmcnt(0)
s_barrier
ds_read_b128 v[232:235],v42 offset:0
s_waitcnt lgkmcnt(0)
v_add_f32 v232,v232,v233
v_add_f32 v234,v234,v235
v_add_f32 v232,v232,v234
s_nop 1
v_mfma_f32_16x16x4_f32 v[116:119],v25,v232,v[116:119]
s_nop 9
v_mov_b32_dpp v89,v116 quad_perm:[1,0,3,2] row_mask:15 bank_mask:15
v_cvt_pk_bf16_f32 v88,v116,v89
v_lshlrev_b32 v90,16,v88
v_and_b32 v91,0xffff0000,v88
v_sub_f32 v90,v116,v90
v_sub_f32 v91,v89,v91
v_cvt_pk_bf16_f32 v89,v91,v90
v_cndmask_b32 v88,v88,v89,s[86:87]
s_mov_b32 exec_lo,0xffff
s_mov_b32 exec_hi,0
buffer_store_dword v88,v43,s[12:15],s48 offen sc1
s_mov_b64 exec,-1
s_waitcnt vmcnt(4)
Lc_100016:
v_mfma_f32_16x16x32_bf16 v[200:203],v[184:187],v[184:187],0
v_mfma_f32_16x16x32_bf16 v[204:207],v[184:187],v[36:39],0
v_mfma_f32_16x16x32_bf16 v[208:211],v[184:187],a[0:3],0
v_mfma_f32_16x16x32_bf16 v[212:215],v[184:187],a[16:19],0
v_mfma_f32_16x16x32_bf16 v[216:219],v[184:187],a[32:35],0
v_mfma_f32_16x16x32_bf16 v[220:223],v[184:187],a[48:51],0
s_waitcnt vmcnt(3)
v_mfma_f32_16x16x32_bf16 v[200:203],v[188:191],v[188:191],v[200:203]
v_mfma_f32_16x16x32_bf16 v[204:207],v[188:191],v[36:39],v[204:207]
v_mfma_f32_16x16x32_bf16 v[208:211],v[188:191],a[4:7],v[208:211]
v_mfma_f32_16x16x32_bf16 v[212:215],v[188:191],a[20:23],v[212:215]
v_mfma_f32_16x16x32_bf16 v[216:219],v[188:191],a[36:39],v[216:219]
v_mfma_f32_16x16x32_bf16 v[220:223],v[188:191],a[52:55],v[220:223]
s_waitcnt vmcnt(2)
v_mfma_f32_16x16x32_bf16 v[200:203],v[192:195],v[192:195],v[200:203]
v_mfma_f32_16x16x32_bf16 v[204:207],v[192:195],v[36:39],v[204:207]
v_mfma_f32_16x16x32_bf16 v[208:211],v[192:195],a[8:11],v[208:211]
v_mfma_f32_16x16x32_bf16 v[212:215],v[192:195],a[24:27],v[212:215]
v_mfma_f32_16x16x32_bf16 v[216:219],v[192:195],a[40:43],v[216:219]
v_mfma_f32_16x16x32_bf16 v[220:223],v[192:195],a[56:59],v[220:223]
s_waitcnt vmcnt(1)
v_mfma_f32_16x16x32_bf16 v[200:203],v[196:199],v[196:199],v[200:203]
v_mfma_f32_16x16x32_bf16 v[204:207],v[196:199],v[36:39],v[204:207]
v_mfma_f32_16x16x32_bf16 v[208:211],v[196:199],a[12:15],v[208:211]
v_mfma_f32_16x16x32_bf16 v[212:215],v[196:199],a[28:31],v[212:215]
v_mfma_f32_16x16x32_bf16 v[216:219],v[196:199],a[44:47],v[216:219]
v_mfma_f32_16x16x32_bf16 v[220:223],v[196:199],a[60:63],v[220:223]
s_nop 2
v_add_f32 v200,v200,v201
v_add_f32 v202,v202,v203
v_add_f32 v200,v200,v202
v_add_f32 v204,v204,v205
v_add_f32 v206,v206,v207
v_add_f32_dpp v200,v200,v200 row_ror:8 row_mask:15 bank_mask:15
v_add_f32 v204,v204,v206
v_add_f32 v208,v208,v209
v_add_f32_dpp v200,v200,v200 row_ror:4 row_mask:15 bank_mask:15
v_add_f32 v210,v210,v211
v_add_f32 v208,v208,v210
v_add_f32_dpp v200,v200,v200 row_ror:2 row_mask:15 bank_mask:15
ds_write_b32 v26,v208 offset:20480
v_add_f32 v212,v212,v213
v_add_f32_dpp v200,v200,v200 row_ror:1 row_mask:15 bank_mask:15
v_cndmask_b32 v204,v204,v200,s[86:87]
ds_write_b32 v26,v204 offset:24576
v_add_f32 v214,v214,v215
v_add_f32 v212,v212,v214
ds_write_b32 v26,v212 offset:21504
v_add_f32 v216,v216,v217
v_add_f32 v218,v218,v219
v_add_f32 v216,v216,v218
ds_write_b32 v26,v216 offset:22528
v_add_f32 v220,v220,v221
v_add_f32 v222,v222,v223
v_add_f32 v220,v220,v222
ds_write_b32 v26,v220 offset:23552
v_cmp_u_f32 vcc,v200,v200
s_cbranch_vccnz Lr_100018
Lo_100017:
s_waitcnt lgkmcnt(0)
s_barrier
ds_read_b128 v[200:203],v3 offset:24576
ds_read_b128 v[208:211],v42 offset:20480
s_waitcnt lgkmcnt(1)
v_add_f32 v200,v200,v201
v_add_f32 v202,v202,v203
v_add_f32 v200,v200,v202
s_nop 1
v_mfma_f32_16x16x4_f32 v[204:207],v200,v25,0
s_waitcnt lgkmcnt(0)
v_add_f32 v208,v208,v209
v_add_f32 v210,v210,v211
v_add_f32 v208,v208,v210
v_mov_b32 v100,v208
s_nop 1
v_permlane16_swap_b32 v208,v100
v_add_f32 v208,v208,v100
v_mov_b32 v100,v208
s_nop 1
v_permlane32_swap_b32 v208,v100
v_add_f32 v208,v208,v100
v_mul_f32 v204,0x3b000000,v204
v_mul_f32 v205,0x3b000000,v205
v_fma_f32 v205,-v204,v204,v205
v_max_f32 v205,0,v205
v_add_f32 v205,0x3727c5ac,v205
v_rsq_f32 v205,v205
v_fma_f32 v208,-v204,v34,v208
v_mul_f32 v208,v208,v205
s_nop 1
v_mov_b32_dpp v100,v208 quad_perm:[1,1,3,3] row_mask:15 bank_mask:15
v_cvt_pk_bf16_f32 v208,v208,v100
s_cmp_lg_u32 s69,0
s_cbranch_scc0 Ls_100019
s_mov_b32 exec_lo,0x5555
s_mov_b32 exec_hi,0
buffer_store_dword v208,v32,s[12:15],s62 offen
Ls_100020:
s_mov_b64 exec,-1
buffer_load_dwordx4 v[92:95],v44,s[12:15],s47 offen offset:0 sc1
buffer_load_dwordx4 v[96:99],v44,s[12:15],s47 offen offset:1024 sc1
buffer_load_dwordx4 v[104:107],v44,s[12:15],s47 offen offset:2048 sc1
buffer_load_dwordx4 v[108:111],v44,s[12:15],s47 offen offset:3072 sc1
s_cmp_eq_u32 s44,7
s_cbranch_scc1 L_it7
s_waitcnt vmcnt(3)
Lc_100021:
v_mfma_f32_16x16x32_bf16 v[200:203],v[92:95],v[92:95],0
v_mfma_f32_16x16x32_bf16 v[204:207],v[92:95],v[36:39],0
v_mfma_f32_16x16x32_bf16 v[208:211],v[92:95],a[64:67],0
v_mfma_f32_16x16x32_bf16 v[212:215],v[92:95],a[80:83],0
s_waitcnt vmcnt(2)
v_mfma_f32_16x16x32_bf16 v[200:203],v[96:99],v[96:99],v[200:203]
v_mfma_f32_16x16x32_bf16 v[204:207],v[96:99],v[36:39],v[204:207]
v_mfma_f32_16x16x32_bf16 v[208:211],v[96:99],a[68:71],v[208:211]
v_mfma_f32_16x16x32_bf16 v[212:215],v[96:99],a[84:87],v[212:215]
s_waitcnt vmcnt(1)
v_mfma_f32_16x16x32_bf16 v[200:203],v[104:107],v[104:107],v[200:203]
v_mfma_f32_16x16x32_bf16 v[204:207],v[104:107],v[36:39],v[204:207]
v_mfma_f32_16x16x32_bf16 v[208:211],v[104:107],a[72:75],v[208:211]
v_mfma_f32_16x16x32_bf16 v[212:215],v[104:107],a[88:91],v[212:215]
s_waitcnt vmcnt(0)
v_mfma_f32_16x16x32_bf16 v[200:203],v[108:111],v[108:111],v[200:203]
v_mfma_f32_16x16x32_bf16 v[204:207],v[108:111],v[36:39],v[204:207]
v_mfma_f32_16x16x32_bf16 v[208:211],v[108:111],a[76:79],v[208:211]
v_mfma_f32_16x16x32_bf16 v[212:215],v[108:111],a[92:95],v[212:215]
s_and_b32 s73,s98,2
s_lshl_b32 s73,s73,4
s_add_u32 s73,s73,s98
s_cmp_lt_u32 s73,28
s_cselect_b32 s95,s50,s61
v_add_f32 v200,v200,v201
v_add_f32 v202,v202,v203
v_add_f32 v200,v200,v202
v_add_f32 v204,v204,v205
v_add_f32 v206,v206,v207
v_add_f32_dpp v200,v200,v200 row_ror:8 row_mask:15 bank_mask:15
v_add_f32 v204,v204,v206
v_add_f32 v208,v208,v209
v_add_f32_dpp v200,v200,v200 row_ror:4 row_mask:15 bank_mask:15
v_add_f32 v210,v210,v211
v_add_f32 v208,v208,v210
v_add_f32_dpp v200,v200,v200 row_ror:2 row_mask:15 bank_mask:15
ds_write_b32 v26,v208 offset:10240
v_add_f32 v212,v212,v213
v_add_f32_dpp v200,v200,v200 row_ror:1 row_mask:15 bank_mask:15
v_cndmask_b32 v204,v204,v200,s[86:87]
ds_write_b32 v26,v204 offset:14336
v_add_f32 v214,v214,v215
v_add_f32 v212,v212,v214
ds_write_b32 v26,v212 offset:11264
v_cmp_u_f32 vcc,v200,v200
s_cbranch_vccnz Lr_100023
Lo_100022:
s_waitcnt lgkmcnt(0)
s_barrier
ds_read_b128 v[200:203],v3 offset:14336
ds_read_b128 v[208:211],v42 offset:10240
s_waitcnt lgkmcnt(1)
v_add_f32 v200,v200,v201
v_add_f32 v202,v202,v203
v_add_f32 v200,v200,v202
s_nop 1
v_mfma_f32_16x16x4_f32 v[204:207],v200,v25,0
s_waitcnt lgkmcnt(0)
v_add_f32 v208,v208,v209
v_add_f32 v210,v210,v211
v_add_f32 v208,v208,v210
v_mov_b32 v100,v208
s_nop 1
v_permlane16_swap_b32 v208,v100
v_add_f32 v208,v208,v100
v_mov_b32 v100,v208
s_nop 1
v_permlane32_swap_b32 v208,v100
v_add_f32 v208,v208,v100
v_mul_f32 v204,0x3b000000,v204
v_mul_f32 v205,0x3b000000,v205
v_fma_f32 v205,-v204,v204,v205
v_max_f32 v205,0,v205
v_add_f32 v205,0x3727c5ac,v205
v_rsq_f32 v205,v205
v_fma_f32 v208,-v204,v35,v208
v_mul_f32 v208,v208,v205
v_mul_f32 v213,0xbfb8aa3b,v208
v_exp_f32 v213,v213
s_nop 0
v_add_f32 v213,1.0,v213
v_rcp_f32 v213,v213
s_nop 0
v_mul_f32 v208,v208,v213
s_nop 1
v_mov_b32_dpp v100,v208 quad_perm:[1,1,3,3] row_mask:15 bank_mask:15
v_cvt_pk_bf16_f32 v208,v208,v100
s_cmp_lg_u32 s69,0
s_cbranch_scc0 Ls_100024
s_mov_b32 exec_lo,0x5555
s_mov_b32 exec_hi,0
buffer_store_dword v208,v32,s[12:15],s95 offen
Ls_100025:
s_mov_b64 exec,-1
s_add_u32 s94,s82,s19
s_add_u32 s95,s82,s16
s_cmp_lt_u32 s44,5
s_cselect_b32 s95,s95,s61
s_cmp_lg_u32 s69,0
s_cbranch_scc0 Ls_100026
s_mov_b32 exec_lo,-1
s_mov_b32 exec_hi,0x1ffff
buffer_store_dwordx4 v[28:31],v3,s[12:15],s94 offen
buffer_store_dwordx4 v[28:31],v3,s[12:15],s95 offen
Ls_100027:
s_mov_b64 exec,-1
s_sub_u32 s96,s44,2
s_add_u32 s53,s24,s20
s_add_u32 s55,s25,s20
s_add_u32 s54,s26,s20
s_lshl_b32 s56,s96,13
s_add_u32 s56,s56,s27
s_cmp_lt_i32 s96,0
s_cselect_b32 s53,s61,s53
s_cselect_b32 s55,s61,s55
s_cselect_b32 s54,s61,s54
s_cselect_b32 s56,s61,s56
s_mov_b32 exec_lo,0xff00ff
s_mov_b32 exec_hi,0xf000f
buffer_load_dword v7,v33,s[12:15],s54 offen offset:0 sc1
s_mov_b32 exec_lo,0xff00ff
s_mov_b32 exec_hi,0xff00ff
buffer_load_dwordx4 v[136:139],v46,s[12:15],s55 offen offset:0 sc1
s_mov_b64 exec,-1
buffer_load_dwordx4 v[120:123],v3,s[12:15],s53 offen offset:0 sc1
buffer_load_dwordx4 v[112:115],v41,s[12:15],s49 offen offset:0 sc1
s_waitcnt vmcnt(0)
Lc_100028:
v_cmp_u_f32 vcc,v112,v113
s_cbranch_vccnz Lr_100030
v_cmp_u_f32 vcc,v114,v115
s_cbranch_vccnz Lr_100030
Lo_100029:
v_mfma_f32_16x16x32_bf16 v[200:203],v[112:115],a[96:99],v[116:119]
v_mov_b32_dpp v208,v112 row_shl:1 row_mask:15 bank_mask:15
v_mov_b32_dpp v209,v113 row_shl:1 row_mask:15 bank_mask:15
v_mov_b32_dpp v210,v114 row_shl:1 row_mask:15 bank_mask:15
v_mov_b32_dpp v211,v115 row_shl:1 row_mask:15 bank_mask:15
v_mov_b32_dpp v204,v112 row_shl:2 row_mask:15 bank_mask:15
v_mov_b32_dpp v205,v113 row_shl:2 row_mask:15 bank_mask:15
v_mov_b32_dpp v206,v114 row_shl:2 row_mask:15 bank_mask:15
v_mov_b32_dpp v207,v115 row_shl:2 row_mask:15 bank_mask:15
v_mfma_f32_16x16x32_bf16 v[200:203],v[208:211],a[100:103],v[200:203]
v_mov_b32_dpp v208,v112 row_shl:3 row_mask:15 bank_mask:15
v_mov_b32_dpp v209,v113 row_shl:3 row_mask:15 bank_mask:15
v_mov_b32_dpp v210,v114 row_shl:3 row_mask:15 bank_mask:15
v_mov_b32_dpp v211,v115 row_shl:3 row_mask:15 bank_mask:15
v_mfma_f32_16x16x32_bf16 v[200:203],v[204:207],a[104:107],v[200:203]
v_mov_b32_dpp v204,v112 row_shl:4 row_mask:15 bank_mask:15
v_mov_b32_dpp v205,v113 row_shl:4 row_mask:15 bank_mask:15
v_mov_b32_dpp v206,v114 row_shl:4 row_mask:15 bank_mask:15
v_mov_b32_dpp v207,v115 row_shl:4 row_mask:15 bank_mask:15
v_mfma_f32_16x16x32_bf16 v[200:203],v[208:211],a[108:111],v[200:203]
v_mov_b32_dpp v208,v112 row_shl:5 row_mask:15 bank_mask:15
v_mov_b32_dpp v209,v113 row_shl:5 row_mask:15 bank_mask:15
v_mov_b32_dpp v210,v114 row_shl:5 row_mask:15 bank_mask:15
v_mov_b32_dpp v211,v115 row_shl:5 row_mask:15 bank_mask:15
v_mfma_f32_16x16x32_bf16 v[200:203],v[204:207],a[112:115],v[200:203]
v_mov_b32_dpp v204,v112 row_shl:6 row_mask:15 bank_mask:15
v_mov_b32_dpp v205,v113 row_shl:6 row_mask:15 bank_mask:15
v_mov_b32_dpp v206,v114 row_shl:6 row_mask:15 bank_mask:15
v_mov_b32_dpp v207,v115 row_shl:6 row_mask:15 bank_mask:15
v_mfma_f32_16x16x32_bf16 v[200:203],v[208:211],a[116:119],v[200:203]
s_nop 0
v_mfma_f32_16x16x32_bf16 v[200:203],v[204:207],a[120:123],v[200:203]
s_nop 7
v_mov_b32_dpp v89,v200 quad_perm:[1,0,3,2] row_mask:15 bank_mask:15
v_cvt_pk_bf16_f32 v88,v200,v89
v_lshlrev_b32 v90,16,v88
v_and_b32 v91,0xffff0000,v88
v_sub_f32 v90,v200,v90
v_sub_f32 v91,v89,v91
v_cvt_pk_bf16_f32 v89,v91,v90
v_cndmask_b32 v88,v88,v89,s[86:87]
s_add_u32 s72,s48,0x20000
s_mov_b32 exec_lo,0xffff
s_mov_b32 exec_hi,0
buffer_store_dword v88,v43,s[12:15],s72 offen sc1
ds_write_b32 v6,v200
s_mov_b64 exec,-1
s_mov_b32 s60,s47
s_lshl_b32 s62,s51,13
s_add_u32 s62,s62,s81
s_add_u32 s62,s62,0x10000
s_cmp_lt_i32 s44,0
s_cselect_b32 s62,s61,s62
s_add_u32 s72,s81,0
s_cmp_lt_u32 s44,5
s_cselect_b32 s72,s72,s61
s_add_u32 s94,s44,1
s_lshl_b32 s94,0x40004,s94
s_cmp_lg_u32 s69,0
s_cbranch_scc0 Ls_100031
s_mov_b32 exec_lo,s94
s_mov_b32 exec_hi,s94
buffer_store_dwordx2 v[102:103],v50,s[12:15],s72 offen
Ls_100032:
s_mov_b64 exec,-1
s_add_u32 s45,s75,s17
s_add_u32 s46,s76,s17
Lc_100033:
v_mfma_f32_16x16x32_bf16 v[200:203],v[120:123],v[56:59],0
v_mfma_f32_16x16x32_bf16 v[204:207],v[136:139],v[56:59],0
v_max_f32_dpp v100,v7,v7 row_half_mirror row_mask:15 bank_mask:15
s_nop 1
v_max_f32_dpp v100,v100,v100 quad_perm:[2,3,0,1] row_mask:15 bank_mask:15
s_nop 1
v_max_f32_dpp v100,v100,v100 quad_perm:[1,0,3,2] row_mask:15 bank_mask:15
v_mov_b32 v211,v100
s_nop 1
v_permlane16_swap_b32 v100,v211
v_max_f32 v100,v100,v211
v_mov_b32 v211,v100
s_nop 1
v_permlane32_swap_b32 v100,v211
v_max_f32 v100,v100,v211
v_sub_f32 v209,v7,v100
v_exp_f32 v209,v209
s_nop 1
v_add_f32_dpp v101,v209,v209 row_half_mirror row_mask:15 bank_mask:15
v_mul_f32_dpp v208,v209,v200 row_newbcast:0 row_mask:15 bank_mask:15
v_fmac_f32_dpp v208,v209,v201 row_newbcast:1 row_mask:15 bank_mask:15
v_add_f32_dpp v101,v101,v101 quad_perm:[2,3,0,1] row_mask:15 bank_mask:15
v_fmac_f32_dpp v208,v209,v202 row_newbcast:2 row_mask:15 bank_mask:15
v_fmac_f32_dpp v208,v209,v203 row_newbcast:3 row_mask:15 bank_mask:15
v_add_f32_dpp v101,v101,v101 quad_perm:[1,0,3,2] row_mask:15 bank_mask:15
v_fmac_f32_dpp v208,v209,v204 row_newbcast:4 row_mask:15 bank_mask:15
v_fmac_f32_dpp v208,v209,v205 row_newbcast:5 row_mask:15 bank_mask:15
v_mov_b32_dpp v101,v101 row_newbcast:0 row_mask:15 bank_mask:15
v_fmac_f32_dpp v208,v209,v206 row_newbcast:6 row_mask:15 bank_mask:15
v_fmac_f32_dpp v208,v209,v207 row_newbcast:7 row_mask:15 bank_mask:15
v_mov_b32 v210,v101
v_mov_b32 v100,v208
s_nop 0
v_permlane16_swap_b32 v101,v210
v_permlane16_swap_b32 v208,v100
v_add_f32 v101,v101,v210
v_add_f32 v208,v208,v100
v_mov_b32 v210,v101
v_mov_b32 v100,v208
s_nop 0
v_permlane32_swap_b32 v101,v210
v_permlane32_swap_b32 v208,v100
v_add_f32 v101,v101,v210
v_add_f32 v208,v208,v100
v_rcp_f32 v101,v101
s_nop 0
v_mul_f32 v208,v208,v101
v_cmp_u_f32 vcc,v208,v208
s_cbranch_vccnz Lr_100035
Lo_100034:
v_mov_b32_dpp v211,v208 quad_perm:[1,1,3,3] row_mask:15 bank_mask:15
v_cvt_pk_bf16_f32 v208,v208,v211
s_cmp_lg_u32 s69,0
s_cbranch_scc0 Ls_100036
s_mov_b32 exec_lo,0x5555
s_mov_b32 exec_hi,0
buffer_store_dword v208,v32,s[12:15],s56 offen
Ls_100037:
s_mov_b64 exec,-1
s_mov_b32 exec_lo,0xff00ff
s_mov_b32 exec_hi,0xf000f
buffer_load_dword v5,v33,s[12:15],s46 offen offset:0 sc1
s_mov_b64 exec,-1
s_waitcnt vmcnt(0)
v_cmp_u_f32 vcc,v5,v5
s_nop 0
s_cmp_eq_u64 vcc,0
s_cselect_b32 s22,1,0
s_cbranch_scc0 Lw_100038
buffer_load_dwordx4 v[52:55],v3,s[12:15],s45 offen offset:0 sc1
buffer_load_dwordx4 v[60:63],v3,s[12:15],s45 offen offset:1024 sc1
buffer_load_dwordx4 v[64:67],v3,s[12:15],s45 offen offset:2048 sc1
buffer_load_dwordx4 v[68:71],v3,s[12:15],s45 offen offset:3072 sc1
s_add_u32 s73,s45,0x1000
s_mov_b32 exec_lo,0xff00ff
s_mov_b32 exec_hi,0xff00ff
buffer_load_dwordx4 v[72:75],v46,s[12:15],s73 offen offset:0 sc1
buffer_load_dwordx4 v[76:79],v46,s[12:15],s73 offen offset:512 sc1
buffer_load_dwordx4 v[80:83],v46,s[12:15],s73 offen offset:1024 sc1
buffer_load_dwordx4 v[84:87],v46,s[12:15],s73 offen offset:1536 sc1
s_mov_b64 exec,-1
Lw_100038:
s_add_u32 s44,s44,1
s_mov_b32 s72,s16
s_mov_b32 s16,s17
s_mov_b32 s17,s18
s_mov_b32 s18,s72
s_mov_b32 s72,s19
s_mov_b32 s19,s20
s_mov_b32 s20,s21
s_mov_b32 s21,s72
s_nop 3
s_branch L_loop
L_it7:
s_mov_b32 s96,5
s_add_u32 s53,s24,0x186000
s_add_u32 s55,s25,0x186000
s_add_u32 s54,s26,0x186000
s_lshl_b32 s56,s96,13
s_add_u32 s56,s56,s27
s_cmp_lt_i32 s96,0
s_cselect_b32 s53,s61,s53
s_cselect_b32 s55,s61,s55
s_cselect_b32 s54,s61,s54
s_cselect_b32 s56,s61,s56
s_mov_b32 exec_lo,0xff00ff
s_mov_b32 exec_hi,0xf000f
buffer_load_dword v7,v33,s[12:15],s54 offen offset:0 sc1
s_mov_b32 exec_lo,0xff00ff
s_mov_b32 exec_hi,0xff00ff
buffer_load_dwordx4 v[136:139],v46,s[12:15],s55 offen offset:0 sc1
s_mov_b64 exec,-1
buffer_load_dwordx4 v[120:123],v3,s[12:15],s53 offen offset:0 sc1
v_min_u32 v100,6,v1
v_lshl_add_u32 v101,v100,8,v51
ds_read_b128 v[176:179],v101
v_lshl_add_u32 v101,v100,14,v27
v_and_b32 v100,7,v1
v_min_u32 v100,6,v100
v_lshl_add_u32 v100,v100,12,v4
v_and_b32 v200,8,v1
v_lshl_add_u32 v100,v200,5,v100
v_lshrrev_b32 v204,1,v4
v_lshl_add_u32 v204,v1,12,v204
s_and_b32 s73,s98,2
s_lshl_b32 s73,s73,4
s_add_u32 s73,s73,s98
s_add_u32 s63,s79,0x8000
s_cmp_lt_u32 s73,28
s_cselect_b32 s63,s63,s61
s_mov_b32 s28,0x20000
v_min_u32 v205,6,v1
v_lshl_add_u32 v205,v205,13,v4
s_lshl_b32 s29,s68,8
s_add_u32 s29,s29,s80
s_add_u32 s29,s29,0xb2000
s_waitcnt vmcnt(6)
Lc_100039:
v_mfma_f32_16x16x32_bf16 v[208:211],v[92:95],v[92:95],0
v_mfma_f32_16x16x32_bf16 v[212:215],v[92:95],v[36:39],0
v_mfma_f32_16x16x32_bf16 v[216:219],v[92:95],a[64:67],0
v_mfma_f32_16x16x32_bf16 v[220:223],v[92:95],a[80:83],0
s_waitcnt vmcnt(5)
v_mfma_f32_16x16x32_bf16 v[208:211],v[96:99],v[96:99],v[208:211]
v_mfma_f32_16x16x32_bf16 v[212:215],v[96:99],v[36:39],v[212:215]
v_mfma_f32_16x16x32_bf16 v[216:219],v[96:99],a[68:71],v[216:219]
v_mfma_f32_16x16x32_bf16 v[220:223],v[96:99],a[84:87],v[220:223]
s_waitcnt vmcnt(4)
v_mfma_f32_16x16x32_bf16 v[208:211],v[104:107],v[104:107],v[208:211]
v_mfma_f32_16x16x32_bf16 v[212:215],v[104:107],v[36:39],v[212:215]
v_mfma_f32_16x16x32_bf16 v[216:219],v[104:107],a[72:75],v[216:219]
v_mfma_f32_16x16x32_bf16 v[220:223],v[104:107],a[88:91],v[220:223]
s_waitcnt vmcnt(3)
v_mfma_f32_16x16x32_bf16 v[208:211],v[108:111],v[108:111],v[208:211]
v_mfma_f32_16x16x32_bf16 v[212:215],v[108:111],v[36:39],v[212:215]
v_mfma_f32_16x16x32_bf16 v[216:219],v[108:111],a[76:79],v[216:219]
v_mfma_f32_16x16x32_bf16 v[220:223],v[108:111],a[92:95],v[220:223]
s_and_b32 s73,s98,2
s_lshl_b32 s73,s73,4
s_add_u32 s73,s73,s98
s_cmp_lt_u32 s73,28
s_cselect_b32 s95,s50,s61
v_add_f32 v208,v208,v209
v_add_f32 v210,v210,v211
v_add_f32 v208,v208,v210
v_add_f32 v212,v212,v213
v_add_f32 v214,v214,v215
v_add_f32_dpp v208,v208,v208 row_ror:8 row_mask:15 bank_mask:15
v_add_f32 v212,v212,v214
v_add_f32 v216,v216,v217
v_add_f32_dpp v208,v208,v208 row_ror:4 row_mask:15 bank_mask:15
v_add_f32 v218,v218,v219
v_add_f32 v216,v216,v218
v_add_f32_dpp v208,v208,v208 row_ror:2 row_mask:15 bank_mask:15
ds_write_b32 v26,v216 offset:10240
v_add_f32 v220,v220,v221
v_add_f32_dpp v208,v208,v208 row_ror:1 row_mask:15 bank_mask:15
v_cndmask_b32 v212,v212,v208,s[86:87]
ds_write_b32 v26,v212 offset:14336
v_add_f32 v222,v222,v223
v_add_f32 v220,v220,v222
ds_write_b32 v26,v220 offset:11264
v_cmp_u_f32 vcc,v208,v208
s_cbranch_vccnz Lr_100041
Lo_100040:
s_waitcnt lgkmcnt(0)
s_barrier
ds_read_b128 v[208:211],v3 offset:14336
ds_read_b128 v[216:219],v42 offset:10240
s_waitcnt lgkmcnt(1)
v_add_f32 v208,v208,v209
v_add_f32 v210,v210,v211
v_add_f32 v208,v208,v210
s_nop 1
v_mfma_f32_16x16x4_f32 v[212:215],v208,v25,0
s_waitcnt lgkmcnt(0)
v_add_f32 v216,v216,v217
v_add_f32 v218,v218,v219
v_add_f32 v216,v216,v218
v_mov_b32 v206,v216
s_nop 1
v_permlane16_swap_b32 v216,v206
v_add_f32 v216,v216,v206
v_mov_b32 v206,v216
s_nop 1
v_permlane32_swap_b32 v216,v206
v_add_f32 v216,v216,v206
v_mul_f32 v212,0x3b000000,v212
v_mul_f32 v213,0x3b000000,v213
v_fma_f32 v213,-v212,v212,v213
v_max_f32 v213,0,v213
v_add_f32 v213,0x3727c5ac,v213
v_rsq_f32 v213,v213
v_fma_f32 v216,-v212,v35,v216
v_mul_f32 v216,v216,v213
v_mul_f32 v221,0xbfb8aa3b,v216
v_exp_f32 v221,v221
s_nop 0
v_add_f32 v221,1.0,v221
v_rcp_f32 v221,v221
s_nop 0
v_mul_f32 v216,v216,v221
s_nop 1
v_mov_b32_dpp v206,v216 quad_perm:[1,1,3,3] row_mask:15 bank_mask:15
v_cvt_pk_bf16_f32 v216,v216,v206
s_cmp_lg_u32 s69,0
s_cbranch_scc0 Ls_100042
s_mov_b32 exec_lo,0x5555
s_mov_b32 exec_hi,0
buffer_store_dword v216,v32,s[12:15],s95 offen
Ls_100043:
s_mov_b64 exec,-1
s_add_u32 s94,s82,s19
s_add_u32 s95,s82,s16
s_cmp_lt_u32 s44,5
s_cselect_b32 s95,s95,s61
s_cmp_lg_u32 s69,0
s_cbranch_scc0 Ls_100044
s_mov_b32 exec_lo,-1
s_mov_b32 exec_hi,0x1ffff
buffer_store_dwordx4 v[28:31],v3,s[12:15],s94 offen
buffer_store_dwordx4 v[28:31],v3,s[12:15],s95 offen
Ls_100045:
s_mov_b64 exec,-1
buffer_load_dwordx4 v[112:115],v41,s[12:15],s49 offen offset:0 sc1
s_waitcnt vmcnt(4)
Lc_100046:
v_mfma_f32_16x16x32_bf16 v[208:211],v[120:123],v[56:59],0
v_mfma_f32_16x16x32_bf16 v[212:215],v[136:139],v[56:59],0
v_max_f32_dpp v206,v7,v7 row_half_mirror row_mask:15 bank_mask:15
s_nop 1
v_max_f32_dpp v206,v206,v206 quad_perm:[2,3,0,1] row_mask:15 bank_mask:15
s_nop 1
v_max_f32_dpp v206,v206,v206 quad_perm:[1,0,3,2] row_mask:15 bank_mask:15
v_mov_b32 v219,v206
s_nop 1
v_permlane16_swap_b32 v206,v219
v_max_f32 v206,v206,v219
v_mov_b32 v219,v206
s_nop 1
v_permlane32_swap_b32 v206,v219
v_max_f32 v206,v206,v219
v_sub_f32 v217,v7,v206
v_exp_f32 v217,v217
s_nop 1
v_add_f32_dpp v207,v217,v217 row_half_mirror row_mask:15 bank_mask:15
v_mul_f32_dpp v216,v217,v208 row_newbcast:0 row_mask:15 bank_mask:15
v_fmac_f32_dpp v216,v217,v209 row_newbcast:1 row_mask:15 bank_mask:15
v_add_f32_dpp v207,v207,v207 quad_perm:[2,3,0,1] row_mask:15 bank_mask:15
v_fmac_f32_dpp v216,v217,v210 row_newbcast:2 row_mask:15 bank_mask:15
v_fmac_f32_dpp v216,v217,v211 row_newbcast:3 row_mask:15 bank_mask:15
v_add_f32_dpp v207,v207,v207 quad_perm:[1,0,3,2] row_mask:15 bank_mask:15
v_fmac_f32_dpp v216,v217,v212 row_newbcast:4 row_mask:15 bank_mask:15
v_fmac_f32_dpp v216,v217,v213 row_newbcast:5 row_mask:15 bank_mask:15
v_mov_b32_dpp v207,v207 row_newbcast:0 row_mask:15 bank_mask:15
v_fmac_f32_dpp v216,v217,v214 row_newbcast:6 row_mask:15 bank_mask:15
v_fmac_f32_dpp v216,v217,v215 row_newbcast:7 row_mask:15 bank_mask:15
v_mov_b32 v218,v207
v_mov_b32 v206,v216
s_nop 0
v_permlane16_swap_b32 v207,v218
v_permlane16_swap_b32 v216,v206
v_add_f32 v207,v207,v218
v_add_f32 v216,v216,v206
v_mov_b32 v218,v207
v_mov_b32 v206,v216
s_nop 0
v_permlane32_swap_b32 v207,v218
v_permlane32_swap_b32 v216,v206
v_add_f32 v207,v207,v218
v_add_f32 v216,v216,v206
v_rcp_f32 v207,v207
s_nop 0
v_mul_f32 v216,v216,v207
v_cmp_u_f32 vcc,v216,v216
s_cbranch_vccnz Lr_100048
Lo_100047:
v_mov_b32_dpp v219,v216 quad_perm:[1,1,3,3] row_mask:15 bank_mask:15
v_cvt_pk_bf16_f32 v216,v216,v219
s_cmp_lg_u32 s69,0
s_cbranch_scc0 Ls_100049
s_mov_b32 exec_lo,0x5555
s_mov_b32 exec_hi,0
buffer_store_dword v216,v32,s[12:15],s56 offen
Ls_100050:
s_mov_b64 exec,-1
s_waitcnt vmcnt(1)
Lc_100051:
v_cmp_u_f32 vcc,v112,v113
s_cbranch_vccnz Lr_100053
v_cmp_u_f32 vcc,v114,v115
s_cbranch_vccnz Lr_100053
Lo_100052:
v_mfma_f32_16x16x32_bf16 v[208:211],v[112:115],a[96:99],v[116:119]
v_mov_b32_dpp v216,v112 row_shl:1 row_mask:15 bank_mask:15
v_mov_b32_dpp v217,v113 row_shl:1 row_mask:15 bank_mask:15
v_mov_b32_dpp v218,v114 row_shl:1 row_mask:15 bank_mask:15
v_mov_b32_dpp v219,v115 row_shl:1 row_mask:15 bank_mask:15
v_mov_b32_dpp v212,v112 row_shl:2 row_mask:15 bank_mask:15
v_mov_b32_dpp v213,v113 row_shl:2 row_mask:15 bank_mask:15
v_mov_b32_dpp v214,v114 row_shl:2 row_mask:15 bank_mask:15
v_mov_b32_dpp v215,v115 row_shl:2 row_mask:15 bank_mask:15
v_mfma_f32_16x16x32_bf16 v[208:211],v[216:219],a[100:103],v[208:211]
v_mov_b32_dpp v216,v112 row_shl:3 row_mask:15 bank_mask:15
v_mov_b32_dpp v217,v113 row_shl:3 row_mask:15 bank_mask:15
v_mov_b32_dpp v218,v114 row_shl:3 row_mask:15 bank_mask:15
v_mov_b32_dpp v219,v115 row_shl:3 row_mask:15 bank_mask:15
v_mfma_f32_16x16x32_bf16 v[208:211],v[212:215],a[104:107],v[208:211]
v_mov_b32_dpp v212,v112 row_shl:4 row_mask:15 bank_mask:15
v_mov_b32_dpp v213,v113 row_shl:4 row_mask:15 bank_mask:15
v_mov_b32_dpp v214,v114 row_shl:4 row_mask:15 bank_mask:15
v_mov_b32_dpp v215,v115 row_shl:4 row_mask:15 bank_mask:15
v_mfma_f32_16x16x32_bf16 v[208:211],v[216:219],a[108:111],v[208:211]
v_mov_b32_dpp v216,v112 row_shl:5 row_mask:15 bank_mask:15
v_mov_b32_dpp v217,v113 row_shl:5 row_mask:15 bank_mask:15
v_mov_b32_dpp v218,v114 row_shl:5 row_mask:15 bank_mask:15
v_mov_b32_dpp v219,v115 row_shl:5 row_mask:15 bank_mask:15
v_mfma_f32_16x16x32_bf16 v[208:211],v[212:215],a[112:115],v[208:211]
v_mov_b32_dpp v212,v112 row_shl:6 row_mask:15 bank_mask:15
v_mov_b32_dpp v213,v113 row_shl:6 row_mask:15 bank_mask:15
v_mov_b32_dpp v214,v114 row_shl:6 row_mask:15 bank_mask:15
v_mov_b32_dpp v215,v115 row_shl:6 row_mask:15 bank_mask:15
v_mfma_f32_16x16x32_bf16 v[208:211],v[216:219],a[116:119],v[208:211]
s_nop 0
v_mfma_f32_16x16x32_bf16 v[208:211],v[212:215],a[120:123],v[208:211]
s_nop 7
v_mov_b32_dpp v89,v208 quad_perm:[1,0,3,2] row_mask:15 bank_mask:15
v_cvt_pk_bf16_f32 v88,v208,v89
v_lshlrev_b32 v90,16,v88
v_and_b32 v91,0xffff0000,v88
v_sub_f32 v90,v208,v90
v_sub_f32 v91,v89,v91
v_cvt_pk_bf16_f32 v89,v91,v90
v_cndmask_b32 v88,v88,v89,s[86:87]
s_add_u32 s72,s48,0x20000
s_mov_b32 exec_lo,0xffff
s_mov_b32 exec_hi,0
buffer_store_dword v88,v43,s[12:15],s72 offen sc1
ds_write_b32 v6,v208
s_mov_b64 exec,-1
s_mov_b32 s60,s47
s_lshl_b32 s62,s51,13
s_add_u32 s62,s62,s81
s_add_u32 s62,s62,0x10000
s_cmp_lt_i32 s44,0
s_cselect_b32 s62,s61,s62
s_mov_b32 s96,6
s_add_u32 s53,s24,0x124000
s_add_u32 s55,s25,0x124000
s_add_u32 s54,s26,0x124000
s_lshl_b32 s56,s96,13
s_add_u32 s56,s56,s27
s_cmp_lt_i32 s96,0
s_cselect_b32 s53,s61,s53
s_cselect_b32 s55,s61,s55
s_cselect_b32 s54,s61,s54
s_cselect_b32 s56,s61,s56
s_mov_b32 exec_lo,0xff00ff
s_mov_b32 exec_hi,0xf000f
buffer_load_dword v7,v33,s[12:15],s54 offen offset:0 sc1
s_mov_b32 exec_lo,0xff00ff
s_mov_b32 exec_hi,0xff00ff
buffer_load_dwordx4 v[136:139],v46,s[12:15],s55 offen offset:0 sc1
s_mov_b64 exec,-1
buffer_load_dwordx4 v[120:123],v3,s[12:15],s53 offen offset:0 sc1
v_mov_b32 v132,0
v_mov_b32 v133,0
v_mov_b32 v134,0
v_mov_b32 v135,0
s_waitcnt vmcnt(3)
s_add_u32 s73,s60,0x20000
buffer_load_dwordx4 v[184:187],v44,s[12:15],s73 offen offset:0 sc1
buffer_load_dwordx4 v[188:191],v44,s[12:15],s73 offen offset:1024 sc1
buffer_load_dwordx4 v[192:195],v44,s[12:15],s73 offen offset:2048 sc1
buffer_load_dwordx4 v[196:199],v44,s[12:15],s73 offen offset:3072 sc1
s_waitcnt vmcnt(4)
Lc_100054:
v_mfma_f32_16x16x32_bf16 v[208:211],v[120:123],v[56:59],0
v_mfma_f32_16x16x32_bf16 v[212:215],v[136:139],v[56:59],0
v_max_f32_dpp v206,v7,v7 row_half_mirror row_mask:15 bank_mask:15
s_nop 1
v_max_f32_dpp v206,v206,v206 quad_perm:[2,3,0,1] row_mask:15 bank_mask:15
s_nop 1
v_max_f32_dpp v206,v206,v206 quad_perm:[1,0,3,2] row_mask:15 bank_mask:15
v_mov_b32 v219,v206
s_nop 1
v_permlane16_swap_b32 v206,v219
v_max_f32 v206,v206,v219
v_mov_b32 v219,v206
s_nop 1
v_permlane32_swap_b32 v206,v219
v_max_f32 v206,v206,v219
v_sub_f32 v217,v7,v206
v_exp_f32 v217,v217
s_nop 1
v_add_f32_dpp v207,v217,v217 row_half_mirror row_mask:15 bank_mask:15
v_mul_f32_dpp v216,v217,v208 row_newbcast:0 row_mask:15 bank_mask:15
v_fmac_f32_dpp v216,v217,v209 row_newbcast:1 row_mask:15 bank_mask:15
v_add_f32_dpp v207,v207,v207 quad_perm:[2,3,0,1] row_mask:15 bank_mask:15
v_fmac_f32_dpp v216,v217,v210 row_newbcast:2 row_mask:15 bank_mask:15
v_fmac_f32_dpp v216,v217,v211 row_newbcast:3 row_mask:15 bank_mask:15
v_add_f32_dpp v207,v207,v207 quad_perm:[1,0,3,2] row_mask:15 bank_mask:15
v_fmac_f32_dpp v216,v217,v212 row_newbcast:4 row_mask:15 bank_mask:15
v_fmac_f32_dpp v216,v217,v213 row_newbcast:5 row_mask:15 bank_mask:15
v_mov_b32_dpp v207,v207 row_newbcast:0 row_mask:15 bank_mask:15
v_fmac_f32_dpp v216,v217,v214 row_newbcast:6 row_mask:15 bank_mask:15
v_fmac_f32_dpp v216,v217,v215 row_newbcast:7 row_mask:15 bank_mask:15
v_mov_b32 v218,v207
v_mov_b32 v206,v216
s_nop 0
v_permlane16_swap_b32 v207,v218
v_permlane16_swap_b32 v216,v206
v_add_f32 v207,v207,v218
v_add_f32 v216,v216,v206
v_mov_b32 v218,v207
v_mov_b32 v206,v216
s_nop 0
v_permlane32_swap_b32 v207,v218
v_permlane32_swap_b32 v216,v206
v_add_f32 v207,v207,v218
v_add_f32 v216,v216,v206
v_rcp_f32 v207,v207
s_nop 0
v_mul_f32 v216,v216,v207
v_cmp_u_f32 vcc,v216,v216
s_cbranch_vccnz Lr_100056
Lo_100055:
v_mov_b32_dpp v219,v216 quad_perm:[1,1,3,3] row_mask:15 bank_mask:15
v_cvt_pk_bf16_f32 v216,v216,v219
s_cmp_lg_u32 s69,0
s_cbranch_scc0 Ls_100057
s_mov_b32 exec_lo,0x5555
s_mov_b32 exec_hi,0
buffer_store_dword v216,v32,s[12:15],s56 offen
Ls_100058:
s_mov_b64 exec,-1
s_waitcnt vmcnt(4)
Lc_100059:
v_mfma_f32_16x16x32_bf16 v[208:211],v[184:187],v[184:187],0
v_mfma_f32_16x16x32_bf16 v[212:215],v[184:187],v[36:39],0
v_mfma_f32_16x16x32_bf16 v[216:219],v[184:187],a[0:3],0
v_mfma_f32_16x16x32_bf16 v[220:223],v[184:187],a[16:19],0
v_mfma_f32_16x16x32_bf16 v[224:227],v[184:187],a[32:35],0
v_mfma_f32_16x16x32_bf16 v[228:231],v[184:187],a[48:51],0
s_waitcnt vmcnt(3)
v_mfma_f32_16x16x32_bf16 v[208:211],v[188:191],v[188:191],v[208:211]
v_mfma_f32_16x16x32_bf16 v[212:215],v[188:191],v[36:39],v[212:215]
v_mfma_f32_16x16x32_bf16 v[216:219],v[188:191],a[4:7],v[216:219]
v_mfma_f32_16x16x32_bf16 v[220:223],v[188:191],a[20:23],v[220:223]
v_mfma_f32_16x16x32_bf16 v[224:227],v[188:191],a[36:39],v[224:227]
v_mfma_f32_16x16x32_bf16 v[228:231],v[188:191],a[52:55],v[228:231]
s_waitcnt vmcnt(2)
v_mfma_f32_16x16x32_bf16 v[208:211],v[192:195],v[192:195],v[208:211]
v_mfma_f32_16x16x32_bf16 v[212:215],v[192:195],v[36:39],v[212:215]
v_mfma_f32_16x16x32_bf16 v[216:219],v[192:195],a[8:11],v[216:219]
v_mfma_f32_16x16x32_bf16 v[220:223],v[192:195],a[24:27],v[220:223]
v_mfma_f32_16x16x32_bf16 v[224:227],v[192:195],a[40:43],v[224:227]
v_mfma_f32_16x16x32_bf16 v[228:231],v[192:195],a[56:59],v[228:231]
s_waitcnt vmcnt(1)
v_mfma_f32_16x16x32_bf16 v[208:211],v[196:199],v[196:199],v[208:211]
v_mfma_f32_16x16x32_bf16 v[212:215],v[196:199],v[36:39],v[212:215]
v_mfma_f32_16x16x32_bf16 v[216:219],v[196:199],a[12:15],v[216:219]
v_mfma_f32_16x16x32_bf16 v[220:223],v[196:199],a[28:31],v[220:223]
v_mfma_f32_16x16x32_bf16 v[224:227],v[196:199],a[44:47],v[224:227]
v_mfma_f32_16x16x32_bf16 v[228:231],v[196:199],a[60:63],v[228:231]
s_nop 2
v_add_f32 v208,v208,v209
v_add_f32 v210,v210,v211
v_add_f32 v208,v208,v210
v_add_f32 v212,v212,v213
v_add_f32 v214,v214,v215
v_add_f32_dpp v208,v208,v208 row_ror:8 row_mask:15 bank_mask:15
v_add_f32 v212,v212,v214
v_add_f32 v216,v216,v217
v_add_f32_dpp v208,v208,v208 row_ror:4 row_mask:15 bank_mask:15
v_add_f32 v218,v218,v219
v_add_f32 v216,v216,v218
v_add_f32_dpp v208,v208,v208 row_ror:2 row_mask:15 bank_mask:15
ds_write_b32 v26,v216 offset:20480
v_add_f32 v220,v220,v221
v_add_f32_dpp v208,v208,v208 row_ror:1 row_mask:15 bank_mask:15
v_cndmask_b32 v212,v212,v208,s[86:87]
ds_write_b32 v26,v212 offset:24576
v_add_f32 v222,v222,v223
v_add_f32 v220,v220,v222
ds_write_b32 v26,v220 offset:21504
v_add_f32 v224,v224,v225
v_add_f32 v226,v226,v227
v_add_f32 v224,v224,v226
ds_write_b32 v26,v224 offset:22528
v_add_f32 v228,v228,v229
v_add_f32 v230,v230,v231
v_add_f32 v228,v228,v230
ds_write_b32 v26,v228 offset:23552
v_cmp_u_f32 vcc,v208,v208
s_cbranch_vccnz Lr_100061
Lo_100060:
buffer_load_dwordx4 v[156:159],v205,s[12:15],s29 offen offset:0 sc1
buffer_load_dwordx4 v[160:163],v205,s[12:15],s29 offen offset:64 sc1
buffer_load_dwordx4 v[164:167],v205,s[12:15],s29 offen offset:128 sc1
buffer_load_dwordx4 v[168:171],v205,s[12:15],s29 offen offset:192 sc1
s_waitcnt lgkmcnt(0)
s_barrier
ds_read_b128 v[208:211],v3 offset:24576
ds_read_b128 v[216:219],v42 offset:20480
s_waitcnt lgkmcnt(1)
v_add_f32 v208,v208,v209
v_add_f32 v210,v210,v211
v_add_f32 v208,v208,v210
s_nop 1
v_mfma_f32_16x16x4_f32 v[212:215],v208,v25,0
s_waitcnt lgkmcnt(0)
v_add_f32 v216,v216,v217
v_add_f32 v218,v218,v219
v_add_f32 v216,v216,v218
v_mov_b32 v206,v216
s_nop 1
v_permlane16_swap_b32 v216,v206
v_add_f32 v216,v216,v206
v_mov_b32 v206,v216
s_nop 1
v_permlane32_swap_b32 v216,v206
v_add_f32 v216,v216,v206
v_mul_f32 v212,0x3b000000,v212
v_mul_f32 v213,0x3b000000,v213
v_fma_f32 v213,-v212,v212,v213
v_max_f32 v213,0,v213
v_add_f32 v213,0x3727c5ac,v213
v_rsq_f32 v213,v213
v_fma_f32 v216,-v212,v34,v216
v_mul_f32 v216,v216,v213
s_nop 1
v_mov_b32_dpp v206,v216 quad_perm:[1,1,3,3] row_mask:15 bank_mask:15
v_cvt_pk_bf16_f32 v216,v216,v206
s_cmp_lg_u32 s69,0
s_cbranch_scc0 Ls_100062
s_mov_b32 exec_lo,0x5555
s_mov_b32 exec_hi,0
buffer_store_dword v216,v32,s[12:15],s62 offen
Ls_100063:
s_mov_b64 exec,-1
s_waitcnt vmcnt(1)
Lc_100064:
v_mfma_f32_16x16x32_bf16 v[208:211],a[124:127],v[156:159],0
v_mfma_f32_16x16x32_bf16 v[212:215],a[140:143],v[156:159],0
v_mfma_f32_16x16x32_bf16 v[216:219],a[156:159],v[156:159],0
v_mfma_f32_16x16x32_bf16 v[220:223],a[172:175],v[156:159],0
v_mfma_f32_16x16x32_bf16 v[208:211],a[128:131],v[160:163],v[208:211]
v_mfma_f32_16x16x32_bf16 v[212:215],a[144:147],v[160:163],v[212:215]
v_mfma_f32_16x16x32_bf16 v[216:219],a[160:163],v[160:163],v[216:219]
v_mfma_f32_16x16x32_bf16 v[220:223],a[176:179],v[160:163],v[220:223]
v_mfma_f32_16x16x32_bf16 v[208:211],a[132:135],v[164:167],v[208:211]
v_mfma_f32_16x16x32_bf16 v[212:215],a[148:151],v[164:167],v[212:215]
v_mfma_f32_16x16x32_bf16 v[216:219],a[164:167],v[164:167],v[216:219]
v_mfma_f32_16x16x32_bf16 v[220:223],a[180:183],v[164:167],v[220:223]
v_mfma_f32_16x16x32_bf16 v[208:211],a[136:139],v[168:171],v[208:211]
v_mfma_f32_16x16x32_bf16 v[212:215],a[152:155],v[168:171],v[212:215]
v_mfma_f32_16x16x32_bf16 v[216:219],a[168:171],v[168:171],v[216:219]
v_mfma_f32_16x16x32_bf16 v[220:223],a[184:187],v[168:171],v[220:223]
s_nop 4
v_cmp_u_f32 vcc,v208,v208
s_cbranch_vccnz Lr_100066
Lo_100065:
ds_write_b128 v42,v[208:211] offset:49152
ds_write_b128 v42,v[212:215] offset:53248
ds_write_b128 v42,v[216:219] offset:57344
ds_write_b128 v42,v[220:223] offset:61440
s_lshl_b32 s72,s68,12
v_add_u32 v206,s72,v3
s_waitcnt lgkmcnt(0)
s_barrier
ds_read_b128 v[208:211],v206 offset:49152
ds_read_b128 v[212:215],v206 offset:50176
ds_read_b128 v[216:219],v206 offset:51200
ds_read_b128 v[220:223],v206 offset:52224
s_waitcnt lgkmcnt(0)
v_add_f32 v208,v208,v212
v_add_f32 v216,v216,v220
v_add_f32 v209,v209,v213
v_add_f32 v217,v217,v221
v_add_f32 v210,v210,v214
v_add_f32 v218,v218,v222
v_add_f32 v211,v211,v215
v_add_f32 v219,v219,v223
v_add_f32 v176,v176,v208
v_add_f32 v177,v177,v209
v_add_f32 v178,v178,v210
v_add_f32 v179,v179,v211
v_add_f32 v176,v176,v216
v_add_f32 v177,v177,v217
v_add_f32 v178,v178,v218
v_add_f32 v179,v179,v219
v_cvt_pk_bf16_f32 v152,v176,v177
v_cvt_pk_bf16_f32 v153,v178,v179
v_lshlrev_b32 v224,16,v152
v_and_b32 v225,0xffff0000,v152
v_lshlrev_b32 v226,16,v153
v_and_b32 v227,0xffff0000,v153
v_sub_f32 v224,v176,v224
v_sub_f32 v225,v177,v225
v_sub_f32 v226,v178,v226
v_sub_f32 v227,v179,v227
v_cvt_pk_bf16_f32 v154,v224,v225
v_cvt_pk_bf16_f32 v155,v226,v227
s_nop 0
v_permlane16_swap_b32 v152,v154
v_permlane16_swap_b32 v153,v155
s_mov_b32 s72,0x62000
s_mov_b32 exec_lo,0x7f007f
s_mov_b32 exec_hi,0x7f007f
buffer_store_dwordx4 v[152:155],v101,s[12:15],s72 offen sc1
s_mov_b64 exec,-1
s_add_u32 s45,s75,0x155000
s_add_u32 s46,s76,0x155000
s_mov_b32 s72,15
s_and_b32 s51,s72,7
s_lshl_b32 s73,s72,12
s_add_u32 s49,s78,s73
s_add_u32 s50,s79,s73
s_and_b32 s73,s72,8
s_add_u32 s73,s73,s72
s_lshl_b32 s73,s73,14
s_add_u32 s47,s77,s73
s_add_u32 s48,s73,0x22000
s_lshl_b32 s73,s51,8
v_add_u32 v6,s73,v45
ds_read_b32 v116,v6
s_waitcnt vmcnt(0)
s_lshl_b32 s52,s66,14
s_add_u32 s52,s52,s83
s_lshl_b32 s72,s98,5
s_lshl_b32 s64,s66,10
s_add_u32 s64,s64,s72
s_sub_u32 s52,s52,0x20000
s_add_u32 s64,s64,0x20000
s_cmp_lt_u32 s66,7
s_cselect_b32 s52,s52,s61
s_cselect_b32 s64,s64,s61
buffer_load_dwordx4 v[180:183],v44,s[12:15],s52 offen offset:0 sc1
s_waitcnt vmcnt(0)
Lc_100067:
v_cmp_u_f32 vcc,v180,v181
s_cbranch_vccnz Lr_100069
v_cmp_u_f32 vcc,v182,v183
s_cbranch_vccnz Lr_100069
Lo_100068:
v_mfma_f32_16x16x32_bf16 v[208:211],v[180:183],v[56:59],0
s_nop 7
v_add_f32 v208,v208,v209
v_add_f32 v210,v210,v211
v_add_f32 v208,v208,v210
s_nop 1
v_mfma_f32_16x16x4_f32 v[212:215],v25,v208,0
s_nop 9
v_mov_b32_dpp v206,v212 quad_perm:[1,1,3,3] row_mask:15 bank_mask:15
v_cvt_pk_bf16_f32 v212,v212,v206
s_mov_b32 exec_lo,0x5555
s_mov_b32 exec_hi,0
buffer_store_dword v212,v32,s[12:15],s64 offen sc1
s_mov_b64 exec,-1
s_mov_b32 exec_lo,0xff00ff
s_mov_b32 exec_hi,0xf000f
buffer_load_dword v5,v33,s[12:15],s46 offen offset:0 sc1
s_mov_b64 exec,-1
s_waitcnt vmcnt(0)
v_cmp_u_f32 vcc,v5,v5
s_nop 0
s_cmp_eq_u64 vcc,0
s_cselect_b32 s22,1,0
s_cbranch_scc0 Lw_100070
buffer_load_dwordx4 v[52:55],v3,s[12:15],s45 offen offset:0 sc1
buffer_load_dwordx4 v[60:63],v3,s[12:15],s45 offen offset:1024 sc1
buffer_load_dwordx4 v[64:67],v3,s[12:15],s45 offen offset:2048 sc1
buffer_load_dwordx4 v[68:71],v3,s[12:15],s45 offen offset:3072 sc1
s_add_u32 s73,s45,0x1000
s_mov_b32 exec_lo,0xff00ff
s_mov_b32 exec_hi,0xff00ff
buffer_load_dwordx4 v[72:75],v46,s[12:15],s73 offen offset:0 sc1
buffer_load_dwordx4 v[76:79],v46,s[12:15],s73 offen offset:512 sc1
buffer_load_dwordx4 v[80:83],v46,s[12:15],s73 offen offset:1024 sc1
buffer_load_dwordx4 v[84:87],v46,s[12:15],s73 offen offset:1536 sc1
s_mov_b64 exec,-1
Lw_100070:
Lc_100071:
v_cmp_u_f32 vcc,v5,v5
s_cbranch_vccnz Lr_100073
Lo_100072:
v_max_f32_dpp v206,v5,v5 row_half_mirror row_mask:15 bank_mask:15
s_nop 1
v_max_f32_dpp v206,v206,v206 quad_perm:[2,3,0,1] row_mask:15 bank_mask:15
s_nop 1
v_max_f32_dpp v206,v206,v206 quad_perm:[1,0,3,2] row_mask:15 bank_mask:15
s_waitcnt vmcnt(7)
v_mfma_f32_16x16x32_bf16 v[208:211],v[52:55],a[124:127],0
v_mov_b32 v245,v206
v_mfma_f32_16x16x32_bf16 v[216:219],v[52:55],a[140:143],0
s_nop 0
v_permlane16_swap_b32 v206,v245
v_max_f32 v206,v206,v245
v_mfma_f32_16x16x32_bf16 v[224:227],v[52:55],a[156:159],0
v_mov_b32 v245,v206
v_mfma_f32_16x16x32_bf16 v[232:235],v[52:55],a[172:175],0
s_nop 0
v_permlane32_swap_b32 v206,v245
v_max_f32 v206,v206,v245
s_waitcnt vmcnt(6)
v_mfma_f32_16x16x32_bf16 v[208:211],v[60:63],a[128:131],v[208:211]
v_sub_f32 v244,v5,v206
v_exp_f32 v244,v244
v_mfma_f32_16x16x32_bf16 v[216:219],v[60:63],a[144:147],v[216:219]
s_nop 0
v_add_f32_dpp v207,v244,v244 row_half_mirror row_mask:15 bank_mask:15
v_mfma_f32_16x16x32_bf16 v[224:227],v[60:63],a[160:163],v[224:227]
s_nop 0
v_add_f32_dpp v207,v207,v207 quad_perm:[2,3,0,1] row_mask:15 bank_mask:15
v_mfma_f32_16x16x32_bf16 v[232:235],v[60:63],a[176:179],v[232:235]
s_nop 0
v_add_f32_dpp v207,v207,v207 quad_perm:[1,0,3,2] row_mask:15 bank_mask:15
s_waitcnt vmcnt(5)
v_mfma_f32_16x16x32_bf16 v[208:211],v[64:67],a[132:135],v[208:211]
v_mov_b32 v245,v207
v_mfma_f32_16x16x32_bf16 v[216:219],v[64:67],a[148:151],v[216:219]
s_nop 0
v_permlane16_swap_b32 v207,v245
v_add_f32 v207,v207,v245
v_mfma_f32_16x16x32_bf16 v[224:227],v[64:67],a[164:167],v[224:227]
v_mov_b32 v245,v207
v_mfma_f32_16x16x32_bf16 v[232:235],v[64:67],a[180:183],v[232:235]
s_nop 0
v_permlane32_swap_b32 v207,v245
v_add_f32 v207,v207,v245
s_waitcnt vmcnt(4)
v_mfma_f32_16x16x32_bf16 v[208:211],v[68:71],a[136:139],v[208:211]
v_rcp_f32 v207,v207
v_mfma_f32_16x16x32_bf16 v[216:219],v[68:71],a[152:155],v[216:219]
v_mul_f32 v244,v244,v207
v_mfma_f32_16x16x32_bf16 v[224:227],v[68:71],a[168:171],v[224:227]
v_mfma_f32_16x16x32_bf16 v[232:235],v[68:71],a[184:187],v[232:235]
s_waitcnt vmcnt(3)
v_mfma_f32_16x16x32_bf16 v[212:215],v[72:75],a[124:127],0
s_nop 0
v_mul_f32_dpp v240,v244,v208 row_newbcast:0 row_mask:15 bank_mask:15
v_fmac_f32_dpp v240,v244,v209 row_newbcast:1 row_mask:15 bank_mask:15
v_mfma_f32_16x16x32_bf16 v[220:223],v[72:75],a[140:143],0
v_fmac_f32_dpp v240,v244,v210 row_newbcast:2 row_mask:15 bank_mask:15
v_fmac_f32_dpp v240,v244,v211 row_newbcast:3 row_mask:15 bank_mask:15
v_mfma_f32_16x16x32_bf16 v[228:231],v[72:75],a[156:159],0
v_mul_f32_dpp v241,v244,v216 row_newbcast:0 row_mask:15 bank_mask:15
v_fmac_f32_dpp v241,v244,v217 row_newbcast:1 row_mask:15 bank_mask:15
v_mfma_f32_16x16x32_bf16 v[236:239],v[72:75],a[172:175],0
v_fmac_f32_dpp v241,v244,v218 row_newbcast:2 row_mask:15 bank_mask:15
v_fmac_f32_dpp v241,v244,v219 row_newbcast:3 row_mask:15 bank_mask:15
s_waitcnt vmcnt(2)
v_mfma_f32_16x16x32_bf16 v[212:215],v[76:79],a[128:131],v[212:215]
v_mul_f32_dpp v242,v244,v224 row_newbcast:0 row_mask:15 bank_mask:15
v_fmac_f32_dpp v242,v244,v225 row_newbcast:1 row_mask:15 bank_mask:15
v_mfma_f32_16x16x32_bf16 v[220:223],v[76:79],a[144:147],v[220:223]
v_fmac_f32_dpp v242,v244,v226 row_newbcast:2 row_mask:15 bank_mask:15
v_fmac_f32_dpp v242,v244,v227 row_newbcast:3 row_mask:15 bank_mask:15
v_mfma_f32_16x16x32_bf16 v[228:231],v[76:79],a[160:163],v[228:231]
v_mul_f32_dpp v243,v244,v232 row_newbcast:0 row_mask:15 bank_mask:15
v_fmac_f32_dpp v243,v244,v233 row_newbcast:1 row_mask:15 bank_mask:15
v_mfma_f32_16x16x32_bf16 v[236:239],v[76:79],a[176:179],v[236:239]
v_fmac_f32_dpp v243,v244,v234 row_newbcast:2 row_mask:15 bank_mask:15
v_fmac_f32_dpp v243,v244,v235 row_newbcast:3 row_mask:15 bank_mask:15
s_waitcnt vmcnt(1)
v_mfma_f32_16x16x32_bf16 v[212:215],v[80:83],a[132:135],v[212:215]
s_waitcnt vmcnt(0)
v_mfma_f32_16x16x32_bf16 v[212:215],v[84:87],a[136:139],v[212:215]
v_mfma_f32_16x16x32_bf16 v[220:223],v[80:83],a[148:151],v[220:223]
v_mfma_f32_16x16x32_bf16 v[220:223],v[84:87],a[152:155],v[220:223]
v_mfma_f32_16x16x32_bf16 v[228:231],v[80:83],a[164:167],v[228:231]
s_nop 4
v_fmac_f32_dpp v240,v244,v212 row_newbcast:4 row_mask:15 bank_mask:15
v_fmac_f32_dpp v240,v244,v213 row_newbcast:5 row_mask:15 bank_mask:15
v_mfma_f32_16x16x32_bf16 v[228:231],v[84:87],a[168:171],v[228:231]
v_fmac_f32_dpp v240,v244,v214 row_newbcast:6 row_mask:15 bank_mask:15
v_fmac_f32_dpp v240,v244,v215 row_newbcast:7 row_mask:15 bank_mask:15
v_mfma_f32_16x16x32_bf16 v[236:239],v[80:83],a[180:183],v[236:239]
ds_write_b32 v26,v240 offset:0
v_fmac_f32_dpp v241,v244,v220 row_newbcast:4 row_mask:15 bank_mask:15
v_mfma_f32_16x16x32_bf16 v[236:239],v[84:87],a[184:187],v[236:239]
v_fmac_f32_dpp v241,v244,v221 row_newbcast:5 row_mask:15 bank_mask:15
v_fmac_f32_dpp v241,v244,v222 row_newbcast:6 row_mask:15 bank_mask:15
v_fmac_f32_dpp v241,v244,v223 row_newbcast:7 row_mask:15 bank_mask:15
ds_write_b32 v26,v241 offset:1024
v_fmac_f32_dpp v242,v244,v228 row_newbcast:4 row_mask:15 bank_mask:15
v_fmac_f32_dpp v242,v244,v229 row_newbcast:5 row_mask:15 bank_mask:15
v_fmac_f32_dpp v242,v244,v230 row_newbcast:6 row_mask:15 bank_mask:15
v_fmac_f32_dpp v242,v244,v231 row_newbcast:7 row_mask:15 bank_mask:15
ds_write_b32 v26,v242 offset:2048
v_fmac_f32_dpp v243,v244,v236 row_newbcast:4 row_mask:15 bank_mask:15
v_fmac_f32_dpp v243,v244,v237 row_newbcast:5 row_mask:15 bank_mask:15
v_fmac_f32_dpp v243,v244,v238 row_newbcast:6 row_mask:15 bank_mask:15
v_fmac_f32_dpp v243,v244,v239 row_newbcast:7 row_mask:15 bank_mask:15
ds_write_b32 v26,v243 offset:3072
v_cmp_u_f32 vcc,v243,v243
s_cbranch_vccnz Lr_100075
Lo_100074:
s_mov_b32 exec_lo,0x7f007f
s_mov_b32 exec_hi,0x7f007f
buffer_load_dwordx4 v[8:11],v24,s[12:15],s28 offen offset:0 sc1
buffer_load_dwordx4 v[12:15],v24,s[12:15],s28 offen offset:64 sc1
buffer_load_dwordx4 v[16:19],v24,s[12:15],s28 offen offset:128 sc1
buffer_load_dwordx4 v[20:23],v24,s[12:15],s28 offen offset:192 sc1
s_mov_b64 exec,-1
s_waitcnt lgkmcnt(0)
s_barrier
ds_read_b128 v[240:243],v42 offset:0
s_waitcnt lgkmcnt(0)
v_add_f32 v240,v240,v241
v_add_f32 v242,v242,v243
v_add_f32 v240,v240,v242
s_nop 1
v_mfma_f32_16x16x4_f32 v[116:119],v25,v240,v[116:119]
s_nop 9
v_mov_b32_dpp v89,v116 quad_perm:[1,0,3,2] row_mask:15 bank_mask:15
v_cvt_pk_bf16_f32 v88,v116,v89
v_lshlrev_b32 v90,16,v88
v_and_b32 v91,0xffff0000,v88
v_sub_f32 v90,v116,v90
v_sub_f32 v91,v89,v91
v_cvt_pk_bf16_f32 v89,v91,v90
v_cndmask_b32 v88,v88,v89,s[86:87]
s_mov_b32 exec_lo,0xffff
s_mov_b32 exec_hi,0
buffer_store_dword v88,v43,s[12:15],s48 offen sc1
s_mov_b64 exec,-1
s_waitcnt vmcnt(1)
Lc_100076:
v_mfma_f32_16x16x32_bf16 v[220:223],v[8:11],v[8:11],0
v_mfma_f32_16x16x32_bf16 v[220:223],v[12:15],v[12:15],v[220:223]
v_mfma_f32_16x16x32_bf16 v[220:223],v[16:19],v[16:19],v[220:223]
v_mfma_f32_16x16x32_bf16 v[220:223],v[20:23],v[20:23],v[220:223]
v_mfma_f32_16x16x32_bf16 v[216:219],v[36:39],v[8:11],0
v_mfma_f32_16x16x32_bf16 v[216:219],v[36:39],v[12:15],v[216:219]
v_mfma_f32_16x16x32_bf16 v[216:219],v[36:39],v[16:19],v[216:219]
v_mfma_f32_16x16x32_bf16 v[216:219],v[36:39],v[20:23],v[216:219]
v_mfma_f32_16x16x32_bf16 v[208:211],a[64:67],v[8:11],0
v_mfma_f32_16x16x32_bf16 v[208:211],a[68:71],v[12:15],v[208:211]
v_mfma_f32_16x16x32_bf16 v[208:211],a[72:75],v[16:19],v[208:211]
v_mfma_f32_16x16x32_bf16 v[208:211],a[76:79],v[20:23],v[208:211]
v_mov_b32 v207,0
v_cmp_eq_u32 vcc,0,v48
s_nop 1
v_cndmask_b32 v207,v207,v220,vcc
v_cmp_eq_u32 vcc,1,v48
s_nop 1
v_cndmask_b32 v207,v207,v221,vcc
v_cmp_eq_u32 vcc,2,v48
s_nop 1
v_cndmask_b32 v207,v207,v222,vcc
v_cmp_eq_u32 vcc,3,v48
s_nop 1
v_cndmask_b32 v207,v207,v223,vcc
v_mov_b32 v206,v216
v_cmp_u_f32 vcc,v206,v206
s_cbranch_vccnz Lr_100078
Lo_100077:
v_mov_b32 v226,v207
s_nop 1
v_permlane16_swap_b32 v207,v226
v_add_f32 v207,v207,v226
v_mov_b32 v226,v207
s_nop 1
v_permlane32_swap_b32 v207,v226
v_add_f32 v207,v207,v226
v_mfma_f32_16x16x32_bf16 v[212:215],a[80:83],v[8:11],0
v_mfma_f32_16x16x32_bf16 v[212:215],a[84:87],v[12:15],v[212:215]
v_mfma_f32_16x16x32_bf16 v[212:215],a[88:91],v[16:19],v[212:215]
v_mfma_f32_16x16x32_bf16 v[212:215],a[92:95],v[20:23],v[212:215]
s_lshl_b32 s72,s68,9
s_add_u32 s72,s72,0x23000
v_add_u32 v225,s72,v49
ds_write_b64 v225,v[206:207]
ds_write_b128 v42,v[208:211] offset:32768
s_nop 2
ds_write_b128 v42,v[212:215] offset:36864
s_waitcnt lgkmcnt(0)
s_barrier
v_add_u32 v225,0x23000,v49
s_lshl_b32 s72,s68,12
v_add_u32 v224,s72,v3
ds_read_b64 v[226:227],v225 offset:0
ds_read_b64 v[244:245],v225 offset:512
ds_read_b64 v[246:247],v225 offset:1024
ds_read_b64 v[248:249],v225 offset:1536
ds_read_b128 v[228:231],v224 offset:32768
ds_read_b128 v[232:235],v224 offset:33792
ds_read_b128 v[236:239],v224 offset:34816
ds_read_b128 v[240:243],v224 offset:35840
s_waitcnt lgkmcnt(4)
v_add_f32 v226,v226,v244
v_add_f32 v246,v246,v248
v_add_f32 v226,v226,v246
v_add_f32 v227,v227,v245
v_add_f32 v247,v247,v249
v_add_f32 v227,v227,v247
v_mul_f32 v226,0x3b000000,v226
v_mul_f32 v227,0x3b000000,v227
v_fma_f32 v227,-v226,v226,v227
v_max_f32 v227,0,v227
v_add_f32 v227,0x3727c5ac,v227
v_rsq_f32 v227,v227
v_sub_f32 v226,0,v226
s_waitcnt lgkmcnt(0)
v_add_f32 v228,v228,v232
v_add_f32 v236,v236,v240
v_add_f32 v229,v229,v233
v_add_f32 v237,v237,v241
v_add_f32 v230,v230,v234
v_add_f32 v238,v238,v242
v_add_f32 v231,v231,v235
v_add_f32 v239,v239,v243
v_add_f32 v232,v228,v236
v_add_f32 v228,v228,v236
v_add_f32 v233,v229,v237
v_add_f32 v229,v229,v237
v_add_f32 v234,v230,v238
v_add_f32 v230,v230,v238
v_add_f32 v235,v231,v239
v_add_f32 v231,v231,v239
v_fmac_f32_dpp v228,v232,v226 row_newbcast:8 row_mask:15 bank_mask:15
v_fmac_f32_dpp v229,v233,v226 row_newbcast:8 row_mask:15 bank_mask:15
v_fmac_f32_dpp v230,v234,v226 row_newbcast:8 row_mask:15 bank_mask:15
v_fmac_f32_dpp v231,v235,v226 row_newbcast:8 row_mask:15 bank_mask:15
v_mul_f32 v228,v228,v227
v_mul_f32 v229,v229,v227
v_mul_f32 v230,v230,v227
v_mul_f32 v231,v231,v227
buffer_load_dwordx4 v[92:95],v44,s[12:15],s47 offen offset:0 sc1
buffer_load_dwordx4 v[96:99],v44,s[12:15],s47 offen offset:1024 sc1
buffer_load_dwordx4 v[104:107],v44,s[12:15],s47 offen offset:2048 sc1
buffer_load_dwordx4 v[108:111],v44,s[12:15],s47 offen offset:3072 sc1
v_mul_f32 v232,0xbfb8aa3b,v228
v_mul_f32 v233,0xbfb8aa3b,v229
v_mul_f32 v234,0xbfb8aa3b,v230
v_mul_f32 v235,0xbfb8aa3b,v231
v_exp_f32 v232,v232
v_exp_f32 v233,v233
v_exp_f32 v234,v234
v_exp_f32 v235,v235
v_add_f32 v232,1.0,v232
v_add_f32 v233,1.0,v233
v_add_f32 v234,1.0,v234
v_add_f32 v235,1.0,v235
v_rcp_f32 v232,v232
v_rcp_f32 v233,v233
v_rcp_f32 v234,v234
v_rcp_f32 v235,v235
v_mul_f32 v228,v228,v232
v_mul_f32 v229,v229,v233
v_mul_f32 v230,v230,v234
v_mul_f32 v231,v231,v235
v_cvt_pk_bf16_f32 v250,v228,v229
v_cvt_pk_bf16_f32 v251,v230,v231
s_cmp_lg_u32 s69,0
s_cbranch_scc0 Ls_100079
s_mov_b32 exec_lo,0x7f007f
s_mov_b32 exec_hi,0x7f007f
buffer_store_dwordx2 v[250:251],v204,s[12:15],s63 offen
Ls_100080:
s_mov_b64 exec,-1
s_waitcnt vmcnt(4)
Lc_100081:
v_mfma_f32_16x16x32_bf16 v[208:211],v[92:95],v[92:95],0
v_mfma_f32_16x16x32_bf16 v[212:215],v[92:95],v[36:39],0
v_mfma_f32_16x16x32_bf16 v[216:219],v[92:95],a[64:67],0
v_mfma_f32_16x16x32_bf16 v[220:223],v[92:95],a[80:83],0
s_waitcnt vmcnt(3)
v_mfma_f32_16x16x32_bf16 v[208:211],v[96:99],v[96:99],v[208:211]
v_mfma_f32_16x16x32_bf16 v[212:215],v[96:99],v[36:39],v[212:215]
v_mfma_f32_16x16x32_bf16 v[216:219],v[96:99],a[68:71],v[216:219]
v_mfma_f32_16x16x32_bf16 v[220:223],v[96:99],a[84:87],v[220:223]
s_waitcnt vmcnt(2)
v_mfma_f32_16x16x32_bf16 v[208:211],v[104:107],v[104:107],v[208:211]
v_mfma_f32_16x16x32_bf16 v[212:215],v[104:107],v[36:39],v[212:215]
v_mfma_f32_16x16x32_bf16 v[216:219],v[104:107],a[72:75],v[216:219]
v_mfma_f32_16x16x32_bf16 v[220:223],v[104:107],a[88:91],v[220:223]
s_waitcnt vmcnt(1)
v_mfma_f32_16x16x32_bf16 v[208:211],v[108:111],v[108:111],v[208:211]
v_mfma_f32_16x16x32_bf16 v[212:215],v[108:111],v[36:39],v[212:215]
v_mfma_f32_16x16x32_bf16 v[216:219],v[108:111],a[76:79],v[216:219]
v_mfma_f32_16x16x32_bf16 v[220:223],v[108:111],a[92:95],v[220:223]
s_and_b32 s73,s98,2
s_lshl_b32 s73,s73,4
s_add_u32 s73,s73,s98
s_cmp_lt_u32 s73,28
s_cselect_b32 s95,s50,s61
v_add_f32 v208,v208,v209
v_add_f32 v210,v210,v211
v_add_f32 v208,v208,v210
v_add_f32 v212,v212,v213
v_add_f32 v214,v214,v215
v_add_f32_dpp v208,v208,v208 row_ror:8 row_mask:15 bank_mask:15
v_add_f32 v212,v212,v214
v_add_f32 v216,v216,v217
v_add_f32_dpp v208,v208,v208 row_ror:4 row_mask:15 bank_mask:15
v_add_f32 v218,v218,v219
v_add_f32 v216,v216,v218
v_add_f32_dpp v208,v208,v208 row_ror:2 row_mask:15 bank_mask:15
ds_write_b32 v26,v216 offset:10240
v_add_f32 v220,v220,v221
v_add_f32_dpp v208,v208,v208 row_ror:1 row_mask:15 bank_mask:15
v_cndmask_b32 v212,v212,v208,s[86:87]
ds_write_b32 v26,v212 offset:14336
v_add_f32 v222,v222,v223
v_add_f32 v220,v220,v222
ds_write_b32 v26,v220 offset:11264
v_cmp_u_f32 vcc,v208,v208
s_cbranch_vccnz Lr_100083
Lo_100082:
s_add_u32 s73,s78,0x8000
buffer_load_dwordx4 v[120:123],v100,s[12:15],s73 offen offset:0 sc1
buffer_load_dwordx4 v[124:127],v100,s[12:15],s73 offen offset:64 sc1
buffer_load_dwordx4 v[128:131],v100,s[12:15],s73 offen offset:128 sc1
s_mov_b32 exec_lo,0xff00ff
s_mov_b32 exec_hi,0xff00ff
buffer_load_dwordx4 v[132:135],v100,s[12:15],s73 offen offset:192 sc1
s_mov_b64 exec,-1
s_waitcnt lgkmcnt(0)
s_barrier
ds_read_b128 v[208:211],v3 offset:14336
ds_read_b128 v[216:219],v42 offset:10240
s_waitcnt lgkmcnt(1)
v_add_f32 v208,v208,v209
v_add_f32 v210,v210,v211
v_add_f32 v208,v208,v210
s_nop 1
v_mfma_f32_16x16x4_f32 v[212:215],v208,v25,0
s_waitcnt lgkmcnt(0)
v_add_f32 v216,v216,v217
v_add_f32 v218,v218,v219
v_add_f32 v216,v216,v218
v_mov_b32 v206,v216
s_nop 1
v_permlane16_swap_b32 v216,v206
v_add_f32 v216,v216,v206
v_mov_b32 v206,v216
s_nop 1
v_permlane32_swap_b32 v216,v206
v_add_f32 v216,v216,v206
v_mul_f32 v212,0x3b000000,v212
v_mul_f32 v213,0x3b000000,v213
v_fma_f32 v213,-v212,v212,v213
v_max_f32 v213,0,v213
v_add_f32 v213,0x3727c5ac,v213
v_rsq_f32 v213,v213
v_fma_f32 v216,-v212,v35,v216
v_mul_f32 v216,v216,v213
v_mul_f32 v221,0xbfb8aa3b,v216
v_exp_f32 v221,v221
s_nop 0
v_add_f32 v221,1.0,v221
v_rcp_f32 v221,v221
s_nop 0
v_mul_f32 v216,v216,v221
s_nop 1
v_mov_b32_dpp v206,v216 quad_perm:[1,1,3,3] row_mask:15 bank_mask:15
v_cvt_pk_bf16_f32 v216,v216,v206
s_cmp_lg_u32 s69,0
s_cbranch_scc0 Ls_100084
s_mov_b32 exec_lo,0x5555
s_mov_b32 exec_hi,0
buffer_store_dword v216,v32,s[12:15],s95 offen
Ls_100085:
s_mov_b64 exec,-1
s_waitcnt vmcnt(1)
Lc_100086:
v_mfma_f32_16x16x32_bf16 v[200:203],a[96:99],v[120:123],v[176:179]
v_mov_b32_dpp v136,v120 row_shl:8 row_mask:15 bank_mask:15 bound_ctrl:0
v_mov_b32_dpp v137,v121 row_shl:8 row_mask:15 bank_mask:15 bound_ctrl:0
v_mov_b32_dpp v138,v122 row_shl:8 row_mask:15 bank_mask:15 bound_ctrl:0
v_mov_b32_dpp v139,v123 row_shl:8 row_mask:15 bank_mask:15 bound_ctrl:0
v_mfma_f32_16x16x32_bf16 v[200:203],a[100:103],v[124:127],v[200:203]
v_mov_b32_dpp v140,v124 row_shl:8 row_mask:15 bank_mask:15 bound_ctrl:0
v_mov_b32_dpp v141,v125 row_shl:8 row_mask:15 bank_mask:15 bound_ctrl:0
v_mov_b32_dpp v142,v126 row_shl:8 row_mask:15 bank_mask:15 bound_ctrl:0
v_mov_b32_dpp v143,v127 row_shl:8 row_mask:15 bank_mask:15 bound_ctrl:0
v_mfma_f32_16x16x32_bf16 v[200:203],a[104:107],v[128:131],v[200:203]
v_mov_b32_dpp v144,v128 row_shl:8 row_mask:15 bank_mask:15 bound_ctrl:0
v_mov_b32_dpp v145,v129 row_shl:8 row_mask:15 bank_mask:15 bound_ctrl:0
v_mov_b32_dpp v146,v130 row_shl:8 row_mask:15 bank_mask:15 bound_ctrl:0
v_mov_b32_dpp v147,v131 row_shl:8 row_mask:15 bank_mask:15 bound_ctrl:0
v_mfma_f32_16x16x32_bf16 v[200:203],a[108:111],v[132:135],v[200:203]
v_mfma_f32_16x16x32_bf16 v[200:203],a[112:115],v[136:139],v[200:203]
v_mfma_f32_16x16x32_bf16 v[200:203],a[116:119],v[140:143],v[200:203]
v_mfma_f32_16x16x32_bf16 v[200:203],a[120:123],v[144:147],v[200:203]
s_nop 7
v_cmp_u_f32 vcc,v200,v200
s_cbranch_vccnz Lr_100088
Lo_100087:
buffer_load_dwordx4 v[112:115],v41,s[12:15],s49 offen offset:0 sc1
v_cvt_pk_bf16_f32 v152,v200,v201
v_cvt_pk_bf16_f32 v153,v202,v203
v_lshlrev_b32 v208,16,v152
v_and_b32 v209,0xffff0000,v152
v_lshlrev_b32 v210,16,v153
v_and_b32 v211,0xffff0000,v153
v_sub_f32 v208,v200,v208
v_sub_f32 v209,v201,v209
v_sub_f32 v210,v202,v210
v_sub_f32 v211,v203,v211
v_cvt_pk_bf16_f32 v154,v208,v209
v_cvt_pk_bf16_f32 v155,v210,v211
s_nop 0
v_permlane16_swap_b32 v152,v154
v_permlane16_swap_b32 v153,v155
s_waitcnt vmcnt(0)
Lc_100089:
v_cmp_u_f32 vcc,v112,v113
s_cbranch_vccnz Lr_100091
v_cmp_u_f32 vcc,v114,v115
s_cbranch_vccnz Lr_100091
Lo_100090:
v_mfma_f32_16x16x32_bf16 v[208:211],v[112:115],a[96:99],v[116:119]
v_mov_b32_dpp v216,v112 row_shl:1 row_mask:15 bank_mask:15
v_mov_b32_dpp v217,v113 row_shl:1 row_mask:15 bank_mask:15
v_mov_b32_dpp v218,v114 row_shl:1 row_mask:15 bank_mask:15
v_mov_b32_dpp v219,v115 row_shl:1 row_mask:15 bank_mask:15
v_mov_b32_dpp v212,v112 row_shl:2 row_mask:15 bank_mask:15
v_mov_b32_dpp v213,v113 row_shl:2 row_mask:15 bank_mask:15
v_mov_b32_dpp v214,v114 row_shl:2 row_mask:15 bank_mask:15
v_mov_b32_dpp v215,v115 row_shl:2 row_mask:15 bank_mask:15
v_mfma_f32_16x16x32_bf16 v[208:211],v[216:219],a[100:103],v[208:211]
v_mov_b32_dpp v216,v112 row_shl:3 row_mask:15 bank_mask:15
v_mov_b32_dpp v217,v113 row_shl:3 row_mask:15 bank_mask:15
v_mov_b32_dpp v218,v114 row_shl:3 row_mask:15 bank_mask:15
v_mov_b32_dpp v219,v115 row_shl:3 row_mask:15 bank_mask:15
v_mfma_f32_16x16x32_bf16 v[208:211],v[212:215],a[104:107],v[208:211]
v_mov_b32_dpp v212,v112 row_shl:4 row_mask:15 bank_mask:15
v_mov_b32_dpp v213,v113 row_shl:4 row_mask:15 bank_mask:15
v_mov_b32_dpp v214,v114 row_shl:4 row_mask:15 bank_mask:15
v_mov_b32_dpp v215,v115 row_shl:4 row_mask:15 bank_mask:15
v_mfma_f32_16x16x32_bf16 v[208:211],v[216:219],a[108:111],v[208:211]
v_mov_b32_dpp v216,v112 row_shl:5 row_mask:15 bank_mask:15
v_mov_b32_dpp v217,v113 row_shl:5 row_mask:15 bank_mask:15
v_mov_b32_dpp v218,v114 row_shl:5 row_mask:15 bank_mask:15
v_mov_b32_dpp v219,v115 row_shl:5 row_mask:15 bank_mask:15
v_mfma_f32_16x16x32_bf16 v[208:211],v[212:215],a[112:115],v[208:211]
v_mov_b32_dpp v212,v112 row_shl:6 row_mask:15 bank_mask:15
v_mov_b32_dpp v213,v113 row_shl:6 row_mask:15 bank_mask:15
v_mov_b32_dpp v214,v114 row_shl:6 row_mask:15 bank_mask:15
v_mov_b32_dpp v215,v115 row_shl:6 row_mask:15 bank_mask:15
v_mfma_f32_16x16x32_bf16 v[208:211],v[216:219],a[116:119],v[208:211]
s_nop 0
v_mfma_f32_16x16x32_bf16 v[208:211],v[212:215],a[120:123],v[208:211]
s_nop 7
v_mov_b32_dpp v89,v208 quad_perm:[1,0,3,2] row_mask:15 bank_mask:15
v_cvt_pk_bf16_f32 v88,v208,v89
v_lshlrev_b32 v90,16,v88
v_and_b32 v91,0xffff0000,v88
v_sub_f32 v90,v208,v90
v_sub_f32 v91,v89,v91
v_cvt_pk_bf16_f32 v89,v91,v90
v_cndmask_b32 v88,v88,v89,s[86:87]
s_add_u32 s72,s48,0x20000
s_mov_b32 exec_lo,0xffff
s_mov_b32 exec_hi,0
buffer_store_dword v88,v43,s[12:15],s72 offen sc1
ds_write_b32 v6,v208
s_mov_b64 exec,-1
s_mov_b32 s72,0x82000
s_mov_b32 exec_lo,0x7f007f
s_mov_b32 exec_hi,0x7f007f
buffer_store_dwordx4 v[152:155],v101,s[12:15],s72 offen sc1
s_mov_b64 exec,-1
s_waitcnt vmcnt(0)
s_lshl_b32 s52,s66,14
s_add_u32 s52,s52,s83
s_lshl_b32 s72,s98,5
s_lshl_b32 s64,s66,10
s_add_u32 s64,s64,s72
buffer_load_dwordx4 v[180:183],v44,s[12:15],s52 offen offset:0 sc1
s_waitcnt vmcnt(0)
Lc_100092:
v_cmp_u_f32 vcc,v180,v181
s_cbranch_vccnz Lr_100094
v_cmp_u_f32 vcc,v182,v183
s_cbranch_vccnz Lr_100094
Lo_100093:
v_mfma_f32_16x16x32_bf16 v[208:211],v[180:183],v[56:59],0
s_nop 7
v_add_f32 v208,v208,v209
v_add_f32 v210,v210,v211
v_add_f32 v208,v208,v210
s_nop 1
v_mfma_f32_16x16x4_f32 v[212:215],v25,v208,0
s_nop 9
v_mov_b32_dpp v206,v212 quad_perm:[1,1,3,3] row_mask:15 bank_mask:15
v_cvt_pk_bf16_f32 v212,v212,v206
s_mov_b32 exec_lo,0x5555
s_mov_b32 exec_hi,0
buffer_store_dword v212,v32,s[36:39],s64 offen
s_mov_b64 exec,-1
s_endpgm
Lr_100013:
s_cmp_eq_u32 s70,0
s_cbranch_scc1 Lo_100012
s_sub_u32 s70,s70,1
s_sleep 1
s_mov_b32 exec_lo,0xff00ff
s_mov_b32 exec_hi,0xf000f
buffer_load_dword v5,v33,s[12:15],s46 offen offset:0 sc1
s_mov_b64 exec,-1
s_waitcnt vmcnt(0)
v_cmp_u_f32 vcc,v5,v5
s_cbranch_vccnz Lr_100013
buffer_load_dwordx4 v[52:55],v3,s[12:15],s45 offen offset:0 sc1
buffer_load_dwordx4 v[60:63],v3,s[12:15],s45 offen offset:1024 sc1
buffer_load_dwordx4 v[64:67],v3,s[12:15],s45 offen offset:2048 sc1
buffer_load_dwordx4 v[68:71],v3,s[12:15],s45 offen offset:3072 sc1
s_add_u32 s73,s45,0x1000
s_mov_b32 exec_lo,0xff00ff
s_mov_b32 exec_hi,0xff00ff
buffer_load_dwordx4 v[72:75],v46,s[12:15],s73 offen offset:0 sc1
buffer_load_dwordx4 v[76:79],v46,s[12:15],s73 offen offset:512 sc1
buffer_load_dwordx4 v[80:83],v46,s[12:15],s73 offen offset:1024 sc1
buffer_load_dwordx4 v[84:87],v46,s[12:15],s73 offen offset:1536 sc1
s_mov_b64 exec,-1
s_branch Lo_100012
Lr_100015:
s_cmp_eq_u32 s70,0
s_cbranch_scc1 Lo_100014
s_sub_u32 s70,s70,1
s_mov_b32 exec_lo,0xff00ff
s_mov_b32 exec_hi,0xf000f
buffer_load_dword v5,v33,s[12:15],s46 offen offset:0 sc1
s_mov_b64 exec,-1
buffer_load_dwordx4 v[52:55],v3,s[12:15],s45 offen offset:0 sc1
buffer_load_dwordx4 v[60:63],v3,s[12:15],s45 offen offset:1024 sc1
buffer_load_dwordx4 v[64:67],v3,s[12:15],s45 offen offset:2048 sc1
buffer_load_dwordx4 v[68:71],v3,s[12:15],s45 offen offset:3072 sc1
s_add_u32 s73,s45,0x1000
s_mov_b32 exec_lo,0xff00ff
s_mov_b32 exec_hi,0xff00ff
buffer_load_dwordx4 v[72:75],v46,s[12:15],s73 offen offset:0 sc1
buffer_load_dwordx4 v[76:79],v46,s[12:15],s73 offen offset:512 sc1
buffer_load_dwordx4 v[80:83],v46,s[12:15],s73 offen offset:1024 sc1
buffer_load_dwordx4 v[84:87],v46,s[12:15],s73 offen offset:1536 sc1
s_mov_b64 exec,-1
s_waitcnt vmcnt(0)
s_branch Lc_100011
Lr_100018:
s_cmp_eq_u32 s70,0
s_cbranch_scc1 Lo_100017
s_sub_u32 s70,s70,1
s_sleep 2
s_add_u32 s73,s60,0x20000
buffer_load_dwordx4 v[184:187],v44,s[12:15],s73 offen offset:0 sc1
buffer_load_dwordx4 v[188:191],v44,s[12:15],s73 offen offset:1024 sc1
buffer_load_dwordx4 v[192:195],v44,s[12:15],s73 offen offset:2048 sc1
buffer_load_dwordx4 v[196:199],v44,s[12:15],s73 offen offset:3072 sc1
s_waitcnt vmcnt(0)
s_branch Lc_100016
Ls_100019:
s_mov_b32 exec_lo,0x5555
s_mov_b32 exec_hi,0
buffer_store_dword v208,v32,s[12:15],s62 offen sc1
s_nop 1
s_branch Ls_100020
Lr_100023:
s_cmp_eq_u32 s70,0
s_cbranch_scc1 Lo_100022
s_sub_u32 s70,s70,1
s_sleep 2
buffer_load_dwordx4 v[92:95],v44,s[12:15],s47 offen offset:0 sc1
buffer_load_dwordx4 v[96:99],v44,s[12:15],s47 offen offset:1024 sc1
buffer_load_dwordx4 v[104:107],v44,s[12:15],s47 offen offset:2048 sc1
buffer_load_dwordx4 v[108:111],v44,s[12:15],s47 offen offset:3072 sc1
s_waitcnt vmcnt(0)
s_branch Lc_100021
Ls_100024:
s_mov_b32 exec_lo,0x5555
s_mov_b32 exec_hi,0
buffer_store_dword v208,v32,s[12:15],s95 offen sc1
s_nop 1
s_branch Ls_100025
Ls_100026:
s_mov_b32 exec_lo,-1
s_mov_b32 exec_hi,0x1ffff
buffer_store_dwordx4 v[28:31],v3,s[12:15],s94 offen sc1
buffer_store_dwordx4 v[28:31],v3,s[12:15],s95 offen sc1
s_nop 1
s_branch Ls_100027
Lr_100030:
s_cmp_eq_u32 s70,0
s_cbranch_scc1 Lo_100029
s_sub_u32 s70,s70,1
buffer_load_dwordx4 v[112:115],v41,s[12:15],s49 offen offset:0 sc1
s_waitcnt vmcnt(0)
s_branch Lc_100028
Ls_100031:
s_mov_b32 exec_lo,s94
s_mov_b32 exec_hi,s94
buffer_store_dwordx2 v[102:103],v50,s[12:15],s72 offen sc1
s_nop 1
s_branch Ls_100032
Lr_100035:
s_cmp_eq_u32 s70,0
s_cbranch_scc1 Lo_100034
s_sub_u32 s70,s70,1
s_sleep 1
s_mov_b32 exec_lo,0xff00ff
s_mov_b32 exec_hi,0xf000f
buffer_load_dword v7,v33,s[12:15],s54 offen offset:0 sc1
s_mov_b32 exec_lo,0xff00ff
s_mov_b32 exec_hi,0xff00ff
buffer_load_dwordx4 v[136:139],v46,s[12:15],s55 offen offset:0 sc1
s_mov_b64 exec,-1
buffer_load_dwordx4 v[120:123],v3,s[12:15],s53 offen offset:0 sc1
s_waitcnt vmcnt(0)
s_branch Lc_100033
Ls_100036:
s_mov_b32 exec_lo,0x5555
s_mov_b32 exec_hi,0
buffer_store_dword v208,v32,s[12:15],s56 offen sc1
s_nop 1
s_branch Ls_100037
Lr_100041:
s_cmp_eq_u32 s70,0
s_cbranch_scc1 Lo_100040
s_sub_u32 s70,s70,1
s_sleep 2
buffer_load_dwordx4 v[92:95],v44,s[12:15],s47 offen offset:0 sc1
buffer_load_dwordx4 v[96:99],v44,s[12:15],s47 offen offset:1024 sc1
buffer_load_dwordx4 v[104:107],v44,s[12:15],s47 offen offset:2048 sc1
buffer_load_dwordx4 v[108:111],v44,s[12:15],s47 offen offset:3072 sc1
s_waitcnt vmcnt(0)
s_branch Lc_100039
Ls_100042:
s_mov_b32 exec_lo,0x5555
s_mov_b32 exec_hi,0
buffer_store_dword v216,v32,s[12:15],s95 offen sc1
s_nop 1
s_branch Ls_100043
Ls_100044:
s_mov_b32 exec_lo,-1
s_mov_b32 exec_hi,0x1ffff
buffer_store_dwordx4 v[28:31],v3,s[12:15],s94 offen sc1
buffer_store_dwordx4 v[28:31],v3,s[12:15],s95 offen sc1
s_nop 1
s_branch Ls_100045
Lr_100048:
s_cmp_eq_u32 s70,0
s_cbranch_scc1 Lo_100047
s_sub_u32 s70,s70,1
s_sleep 1
s_mov_b32 exec_lo,0xff00ff
s_mov_b32 exec_hi,0xf000f
buffer_load_dword v7,v33,s[12:15],s54 offen offset:0 sc1
s_mov_b32 exec_lo,0xff00ff
s_mov_b32 exec_hi,0xff00ff
buffer_load_dwordx4 v[136:139],v46,s[12:15],s55 offen offset:0 sc1
s_mov_b64 exec,-1
buffer_load_dwordx4 v[120:123],v3,s[12:15],s53 offen offset:0 sc1
s_waitcnt vmcnt(0)
s_branch Lc_100046
Ls_100049:
s_mov_b32 exec_lo,0x5555
s_mov_b32 exec_hi,0
buffer_store_dword v216,v32,s[12:15],s56 offen sc1
s_nop 1
s_branch Ls_100050
Lr_100053:
s_cmp_eq_u32 s70,0
s_cbranch_scc1 Lo_100052
s_sub_u32 s70,s70,1
buffer_load_dwordx4 v[112:115],v41,s[12:15],s49 offen offset:0 sc1
s_waitcnt vmcnt(0)
s_branch Lc_100051
Lr_100056:
s_cmp_eq_u32 s70,0
s_cbranch_scc1 Lo_100055
s_sub_u32 s70,s70,1
s_sleep 1
s_mov_b32 exec_lo,0xff00ff
s_mov_b32 exec_hi,0xf000f
buffer_load_dword v7,v33,s[12:15],s54 offen offset:0 sc1
s_mov_b32 exec_lo,0xff00ff
s_mov_b32 exec_hi,0xff00ff
buffer_load_dwordx4 v[136:139],v46,s[12:15],s55 offen offset:0 sc1
s_mov_b64 exec,-1
buffer_load_dwordx4 v[120:123],v3,s[12:15],s53 offen offset:0 sc1
s_waitcnt vmcnt(0)
s_branch Lc_100054
Ls_100057:
s_mov_b32 exec_lo,0x5555
s_mov_b32 exec_hi,0
buffer_store_dword v216,v32,s[12:15],s56 offen sc1
s_nop 1
s_branch Ls_100058
Lr_100061:
s_cmp_eq_u32 s70,0
s_cbranch_scc1 Lo_100060
s_sub_u32 s70,s70,1
s_sleep 2
s_add_u32 s73,s60,0x20000
buffer_load_dwordx4 v[184:187],v44,s[12:15],s73 offen offset:0 sc1
buffer_load_dwordx4 v[188:191],v44,s[12:15],s73 offen offset:1024 sc1
buffer_load_dwordx4 v[192:195],v44,s[12:15],s73 offen offset:2048 sc1
buffer_load_dwordx4 v[196:199],v44,s[12:15],s73 offen offset:3072 sc1
s_waitcnt vmcnt(0)
s_branch Lc_100059
Ls_100062:
s_mov_b32 exec_lo,0x5555
s_mov_b32 exec_hi,0
buffer_store_dword v216,v32,s[12:15],s62 offen sc1
s_nop 1
s_branch Ls_100063
Lr_100066:
s_cmp_eq_u32 s70,0
s_cbranch_scc1 Lo_100065
s_sub_u32 s70,s70,1
buffer_load_dwordx4 v[156:159],v205,s[12:15],s29 offen offset:0 sc1
buffer_load_dwordx4 v[160:163],v205,s[12:15],s29 offen offset:64 sc1
buffer_load_dwordx4 v[164:167],v205,s[12:15],s29 offen offset:128 sc1
buffer_load_dwordx4 v[168:171],v205,s[12:15],s29 offen offset:192 sc1
s_waitcnt vmcnt(0)
s_branch Lc_100064
Lr_100069:
s_cmp_eq_u32 s70,0
s_cbranch_scc1 Lo_100068
s_sub_u32 s70,s70,1
s_sleep 2
buffer_load_dwordx4 v[180:183],v44,s[12:15],s52 offen offset:0 sc1
s_waitcnt vmcnt(0)
s_branch Lc_100067
Lr_100073:
s_cmp_eq_u32 s70,0
s_cbranch_scc1 Lo_100072
s_sub_u32 s70,s70,1
s_sleep 1
s_mov_b32 exec_lo,0xff00ff
s_mov_b32 exec_hi,0xf000f
buffer_load_dword v5,v33,s[12:15],s46 offen offset:0 sc1
s_mov_b64 exec,-1
s_waitcnt vmcnt(0)
v_cmp_u_f32 vcc,v5,v5
s_cbranch_vccnz Lr_100073
buffer_load_dwordx4 v[52:55],v3,s[12:15],s45 offen offset:0 sc1
buffer_load_dwordx4 v[60:63],v3,s[12:15],s45 offen offset:1024 sc1
buffer_load_dwordx4 v[64:67],v3,s[12:15],s45 offen offset:2048 sc1
buffer_load_dwordx4 v[68:71],v3,s[12:15],s45 offen offset:3072 sc1
s_add_u32 s73,s45,0x1000
s_mov_b32 exec_lo,0xff00ff
s_mov_b32 exec_hi,0xff00ff
buffer_load_dwordx4 v[72:75],v46,s[12:15],s73 offen offset:0 sc1
buffer_load_dwordx4 v[76:79],v46,s[12:15],s73 offen offset:512 sc1
buffer_load_dwordx4 v[80:83],v46,s[12:15],s73 offen offset:1024 sc1
buffer_load_dwordx4 v[84:87],v46,s[12:15],s73 offen offset:1536 sc1
s_mov_b64 exec,-1
s_branch Lo_100072
Lr_100075:
s_cmp_eq_u32 s70,0
s_cbranch_scc1 Lo_100074
s_sub_u32 s70,s70,1
s_mov_b32 exec_lo,0xff00ff
s_mov_b32 exec_hi,0xf000f
buffer_load_dword v5,v33,s[12:15],s46 offen offset:0 sc1
s_mov_b64 exec,-1
buffer_load_dwordx4 v[52:55],v3,s[12:15],s45 offen offset:0 sc1
buffer_load_dwordx4 v[60:63],v3,s[12:15],s45 offen offset:1024 sc1
buffer_load_dwordx4 v[64:67],v3,s[12:15],s45 offen offset:2048 sc1
buffer_load_dwordx4 v[68:71],v3,s[12:15],s45 offen offset:3072 sc1
s_add_u32 s73,s45,0x1000
s_mov_b32 exec_lo,0xff00ff
s_mov_b32 exec_hi,0xff00ff
buffer_load_dwordx4 v[72:75],v46,s[12:15],s73 offen offset:0 sc1
buffer_load_dwordx4 v[76:79],v46,s[12:15],s73 offen offset:512 sc1
buffer_load_dwordx4 v[80:83],v46,s[12:15],s73 offen offset:1024 sc1
buffer_load_dwordx4 v[84:87],v46,s[12:15],s73 offen offset:1536 sc1
s_mov_b64 exec,-1
s_waitcnt vmcnt(0)
s_branch Lc_100071
Lr_100078:
s_cmp_eq_u32 s70,0
s_cbranch_scc1 Lo_100077
s_sub_u32 s70,s70,1
s_sleep 2
s_mov_b32 exec_lo,0x7f007f
s_mov_b32 exec_hi,0x7f007f
buffer_load_dwordx4 v[8:11],v24,s[12:15],s28 offen offset:0 sc1
buffer_load_dwordx4 v[12:15],v24,s[12:15],s28 offen offset:64 sc1
buffer_load_dwordx4 v[16:19],v24,s[12:15],s28 offen offset:128 sc1
buffer_load_dwordx4 v[20:23],v24,s[12:15],s28 offen offset:192 sc1
s_mov_b64 exec,-1
s_waitcnt vmcnt(0)
s_branch Lc_100076
Ls_100079:
s_mov_b32 exec_lo,0x7f007f
s_mov_b32 exec_hi,0x7f007f
buffer_store_dwordx2 v[250:251],v204,s[12:15],s63 offen sc1
s_nop 1
s_branch Ls_100080
Lr_100083:
s_cmp_eq_u32 s70,0
s_cbranch_scc1 Lo_100082
s_sub_u32 s70,s70,1
s_sleep 2
buffer_load_dwordx4 v[92:95],v44,s[12:15],s47 offen offset:0 sc1
buffer_load_dwordx4 v[96:99],v44,s[12:15],s47 offen offset:1024 sc1
buffer_load_dwordx4 v[104:107],v44,s[12:15],s47 offen offset:2048 sc1
buffer_load_dwordx4 v[108:111],v44,s[12:15],s47 offen offset:3072 sc1
s_waitcnt vmcnt(0)
s_branch Lc_100081
Ls_100084:
s_mov_b32 exec_lo,0x5555
s_mov_b32 exec_hi,0
buffer_store_dword v216,v32,s[12:15],s95 offen sc1
s_nop 1
s_branch Ls_100085
Lr_100088:
s_cmp_eq_u32 s70,0
s_cbranch_scc1 Lo_100087
s_sub_u32 s70,s70,1
s_add_u32 s73,s78,0x8000
buffer_load_dwordx4 v[120:123],v100,s[12:15],s73 offen offset:0 sc1
buffer_load_dwordx4 v[124:127],v100,s[12:15],s73 offen offset:64 sc1
buffer_load_dwordx4 v[128:131],v100,s[12:15],s73 offen offset:128 sc1
s_mov_b32 exec_lo,0xff00ff
s_mov_b32 exec_hi,0xff00ff
buffer_load_dwordx4 v[132:135],v100,s[12:15],s73 offen offset:192 sc1
s_mov_b64 exec,-1
s_waitcnt vmcnt(0)
s_branch Lc_100086
Lr_100091:
s_cmp_eq_u32 s70,0
s_cbranch_scc1 Lo_100090
s_sub_u32 s70,s70,1
buffer_load_dwordx4 v[112:115],v41,s[12:15],s49 offen offset:0 sc1
s_waitcnt vmcnt(0)
s_branch Lc_100089
Lr_100094:
s_cmp_eq_u32 s70,0
s_cbranch_scc1 Lo_100093
s_sub_u32 s70,s70,1
s_sleep 2
buffer_load_dwordx4 v[180:183],v44,s[12:15],s52 offen offset:0 sc1
s_waitcnt vmcnt(0)
s_branch Lc_100092
L_end:
s_endpgm
L_codeend:
.section .rodata,"a"
.p2align 6
.amdhsa_kernel interleave_layers__gqa_block_cached__dense_activation_silu__decode_kernel
  .amdhsa_next_free_vgpr 512
  .amdhsa_next_free_sgpr 102
  .amdhsa_accum_offset 256
  .amdhsa_group_segment_fixed_size 0
  .amdhsa_kernarg_size 88
  .amdhsa_user_sgpr_count 2
  .amdhsa_user_sgpr_kernarg_segment_ptr 1
  .amdhsa_system_sgpr_workgroup_id_x 1
.end_amdhsa_kernel
```
